```python
import torch

def _softmax(x, axis=-1):
    return torch.softmax(x, dim=axis)
def _gelu(x):
    return torch.nn.functional.gelu(x, approximate="tanh")
def _silu(x):
    return torch.nn.functional.silu(x)
def _sigmoid(x):
    return torch.sigmoid(x)
def _layernorm(x, axis=-1, eps=1e-5):
    m = x.mean(dim=axis, keepdim=True)
    v = x.var(dim=axis, keepdim=True, unbiased=False)
    return (x - m) / torch.sqrt(v + eps)
def _scatter_add(tgt, idx, src, axis=0):
    return tgt.clone().index_add_(axis, idx, src)
def _segment_sum(src, seg, n):
    out = torch.zeros((n,) + src.shape[1:], dtype=src.dtype)
    return out.index_add_(0, seg, src)
def _pad(x, pw):
    flat = tuple(v for pair in reversed(pw) for v in pair)
    return torch.nn.functional.pad(x, flat)

kernel_name = 'gated_mix__ssm_conv_s4d__ssm_conv_s5__prompt'

def setup_inputs():

    _w = (lambda a: (lambda t: t.to(torch.bfloat16) if t.is_floating_point() else t)(torch.as_tensor(a)))
    def _A_setup():
        Bsz, L, D, N = 1, 2048, 576, 128
        return {
            "u": _w((lambda *s: torch.randn(*s, dtype=torch.bfloat16) * 0.05)(Bsz, L, D)),
            "log_A_real": _w((lambda *s: torch.randn(*s, dtype=torch.bfloat16) * 3.2)(D, N) * 0.5),
            "A_imag": _w((lambda *s: torch.randn(*s, dtype=torch.bfloat16) * 0.05)(D, N) * 3.14),
            "C_real": _w((lambda *s: torch.randn(*s, dtype=torch.bfloat16) * 0.1)(D, N) / N ** 0.5),
            "C_imag": _w((lambda *s: torch.randn(*s, dtype=torch.bfloat16) * 0.1)(D, N) / N ** 0.5),
            "log_dt": _w((lambda *s: torch.randn(*s, dtype=torch.bfloat16) * 0.05)(D) * 0.5 - 4.0),
            "D_skip": _w((lambda *s: torch.randn(*s, dtype=torch.bfloat16) * 0.05)(D)),
        }
    _A_in = _A_setup()

    def _B_setup():
        B, S, D = 1, 2048, 576
        P = D
        Lambda_re = -0.5 * (lambda _x: torch.exp(torch.as_tensor(_x)))((lambda *s: torch.randn(*s, dtype=torch.bfloat16) * 0.2)(P))
        Lambda_im = (lambda *s: torch.randn(*s, dtype=torch.bfloat16) * 0.4)(P) * 1.0
        B_re = (lambda *s: torch.randn(*s, dtype=torch.bfloat16) * 0.2)(P, D) * (D ** -0.5)
        B_im = (lambda *s: torch.randn(*s, dtype=torch.bfloat16) * 0.2)(P, D) * (D ** -0.5)
        C_re = (lambda *s: torch.randn(*s, dtype=torch.bfloat16) * 0.2)(D, P) * (P ** -0.5)
        C_im = (lambda *s: torch.randn(*s, dtype=torch.bfloat16) * 0.2)(D, P) * (P ** -0.5)
        log_dt = (lambda *s: torch.randn(*s, dtype=torch.bfloat16) * 0.2)(P) * 0.3 - 2.0
        Dskip = (lambda *s: torch.randn(*s, dtype=torch.bfloat16) * 0.05)(D)
        return {
            "x": _w((lambda *s: torch.randn(*s, dtype=torch.bfloat16) * 0.05)(B, S, D)),
            "Lambda_re": _w(Lambda_re),
            "Lambda_im": _w(Lambda_im),
            "B_re": _w(B_re),
            "B_im": _w(B_im),
            "C_re": _w(C_re),
            "C_im": _w(C_im),
            "log_dt": _w(log_dt),
            "Dskip": _w(Dskip),
        }
    _B_in = _B_setup()

    return {
        "A_u": _A_in["u"],
        "A_log_A_real": _A_in["log_A_real"],
        "A_A_imag": _A_in["A_imag"],
        "A_C_real": _A_in["C_real"],
        "A_C_imag": _A_in["C_imag"],
        "A_log_dt": _A_in["log_dt"],
        "A_D_skip": _A_in["D_skip"],
        "B_x": _B_in["x"],
        "B_Lambda_re": _B_in["Lambda_re"],
        "B_Lambda_im": _B_in["Lambda_im"],
        "B_B_re": _B_in["B_re"],
        "B_B_im": _B_in["B_im"],
        "B_C_re": _B_in["C_re"],
        "B_C_im": _B_in["C_im"],
        "B_log_dt": _B_in["log_dt"],
        "B_Dskip": _B_in["Dskip"],
        "gate_w": _w((lambda *s: torch.randn(*s, dtype=torch.bfloat16) * 0.05)(576) * 16.0),
    }

def reference(A_u, A_log_A_real, A_A_imag, A_C_real, A_C_imag, A_log_dt, A_D_skip, B_x, B_Lambda_re, B_Lambda_im, B_B_re, B_B_im, B_C_re, B_C_im, B_log_dt, B_Dskip, gate_w):
    def _A_ref(u, log_A_real, A_imag, C_real, C_imag, log_dt, D_skip):
        L = u.shape[1]
        dt = torch.exp(log_dt)
        A = -torch.exp(log_A_real) + 1j * A_imag
        C = (C_real + 1j * C_imag) * dt[:, None]
        pos = (lambda x, dt: x.to(dt))(torch.arange(L), log_dt.dtype)
        P = torch.exp((A * dt[:, None])[:, :, None] * pos[None, None, :])
        K = 2.0 * torch.einsum("dn,dnl->dl", C, P).real
        L2 = 2 * L
        u_t = (lambda x, *d: x.permute(*d))(u, 0, 2, 1)
        Kf = (lambda x, *a, **k: torch.fft.rfft(x.float(), *a, **k))(K, L2)
        Uf = (lambda x, *a, **k: torch.fft.rfft(x.float(), *a, **k))(u_t, L2)
        y = (lambda x, *a, **k: torch.fft.irfft(x, *a, **k).to(torch.bfloat16))(Uf * Kf[None, :, :], L2)[:, :, :L]
        y = (lambda x, *d: x.permute(*d))(y, 0, 2, 1)
        return y + u * D_skip[None, None, :]

    def _B_ref(x, Lambda_re, Lambda_im, B_re, B_im, C_re, C_im, log_dt, Dskip):
        Bsz, L, H = x.shape
        Lam = Lambda_re + 1j * Lambda_im
        Bmat = B_re + 1j * B_im
        Cmat = C_re + 1j * C_im
        dt = torch.exp(log_dt)
        Lam_bar = torch.exp(dt * Lam)
        B_bar = ((Lam_bar - 1.0) / Lam)[:, None] * Bmat
        Bu = torch.einsum("bld,pd->blp", x + 0j, B_bar)
        h = torch.zeros_like(Bu[:, 0, :])
        hs = []
        for t in range(L):
            h = Lam_bar[None, :] * h + Bu[:, t, :]
            hs.append(h)
        hseq = torch.stack(hs, 1)
        y = 2.0 * torch.einsum("blp,dp->bld", hseq, Cmat).real + x * Dskip[None, None, :]
        return y

    x = A_u
    g = _sigmoid((x * gate_w).sum(-1, keepdims=True))
    a = _A_ref(x, A_log_A_real, A_A_imag, A_C_real, A_C_imag, A_log_dt, A_D_skip)
    b = _B_ref(x, B_Lambda_re, B_Lambda_im, B_B_re, B_B_im, B_C_re, B_C_im, B_log_dt, B_Dskip)
    return g * a + (1 - g) * b
```

```asm
; @launch grid=(256,1,1) block=(512,1,1) lds=163840
.amdgcn_target "amdgcn-amd-amdhsa--gfx950"
.text
.globl gated_mix__ssm_conv_s4d__ssm_conv_s5__prompt_kernel
.p2align 8
.type gated_mix__ssm_conv_s4d__ssm_conv_s5__prompt_kernel,@function
gated_mix__ssm_conv_s4d__ssm_conv_s5__prompt_kernel:
  s_load_dwordx16 s[16:31], s[0:1], 0
  s_load_dwordx16 s[32:47], s[0:1], 64
  s_load_dwordx8 s[48:55], s[0:1], 128
  v_lshrrev_b32 v4, 6, v0
  v_and_b32 v1, 63, v0
  s_cmp_ge_u32 s2, 256
  s_cbranch_scc1 L_exit
  v_readfirstlane_b32 s3, v4
  s_and_b32 s4, s2, 7
  s_lshr_b32 s5, s2, 3
  s_cmp_lg_u32 s3, 0
  s_cbranch_scc1 L_nopf
  s_getpc_b64 s[6:7]
L_pc:
  s_and_b32 s8, s5, 7
  s_lshl_b32 s8, s8, 13
  v_lshl_add_u32 v4, v1, 7, s8
  v_min_u32 v4, L_codeend-L_pc-4, v4
  global_load_dword v2, v4, s[6:7]
L_nopf:
  s_and_b32 s76, s3, 3
  s_and_b32 s77, s3, 1
  s_lshr_b32 s78, s76, 1
  s_mov_b32 s58, 2359296
  s_mov_b32 s59, 0x20000
  s_cmp_ge_u32 s5, 18
  s_cbranch_scc1 L_conv
  s_and_b32 s6, s4, 1
  s_mul_i32 s6, s6, 18
  s_add_u32 s6, s6, s5
  s_lshr_b32 s89, s6, 2
  s_and_b32 s6, s6, 3
  s_and_b32 s88, s4, 6
  s_lshl_b32 s88, s88, 1
  s_add_u32 s88, s88, s6
  s_cmp_ge_u32 s3, 4
  s_cbranch_scc0 L_GA
L_GB:
  s_add_u32 s14, s89, s6
  s_lshl_b32 s14, s14, 1
  s_and_b32 s14, s14, 2
  s_and_b32 s7, s4, 1
  s_add_u32 s14, s14, s7
  s_lshr_b32 s6, s4, 1
  s_lshl1_add_u32 s14, s14, s6
  s_cmp_ge_u32 s14, 9
  s_cselect_b32 s94, 0, s14
  s_lshl_b32 s14, s94, 7
  s_mul_i32 s90, s88, 147456
  s_lshl_b32 s15, s76, 10
  v_bfe_u32 v228, v0, 4, 3
  v_and_b32 v230, 7, v1
  v_xor_b32 v230, v230, v228
  v_lshlrev_b32 v230, 4, v230
  v_and_b32_e64 v228, 32, v1
  v_bfe_u32 v229, v1, 3, 1
  v_lshl_add_u32 v228, v229, 4, v228
  v_bfe_u32 v229, v1, 4, 1
  s_lshl_b32 s6, s76, 1
  v_add3_u32 v228, v228, v229, s6
  s_movk_i32 s6, 1152
  v_mad_u32_u24 v208, v228, s6, v230
  s_waitcnt lgkmcnt(0)
  s_mov_b64 s[56:57], s[16:17]
  s_add_u32 s8, s90, s14
  s_add_u32 m0, s15, 32768
  s_add_u32 s7, s8, 0
  buffer_load_dwordx4 v208, s[56:59], s7 offen lds
  s_add_u32 m0, s15, 36864
  s_add_u32 s7, s8, 9216
  buffer_load_dwordx4 v208, s[56:59], s7 offen lds
  s_add_u32 m0, s15, 40960
  s_add_u32 s7, s8, 73728
  buffer_load_dwordx4 v208, s[56:59], s7 offen lds
  s_add_u32 m0, s15, 45056
  s_add_u32 s7, s8, 82944
  buffer_load_dwordx4 v208, s[56:59], s7 offen lds
  s_mov_b32 s66, 663552
  s_mov_b32 s67, 0x20000
  s_mov_b32 s70, 663552
  s_mov_b32 s71, 0x20000
  s_mul_i32 s91, s89, 73728
  v_bfe_u32 v228, v0, 3, 5
  v_mad_u32_u24 v209, v228, s6, v230
  s_mov_b64 s[64:65], s[36:37]
  s_mov_b64 s[68:69], s[38:39]
  s_add_u32 s9, s91, s14
  s_add_u32 m0, s15, 49152
  s_add_u32 s7, s9, 0
  buffer_load_dwordx4 v209, s[64:67], s7 offen lds
  s_add_u32 m0, s15, 53248
  s_add_u32 s7, s9, 36864
  buffer_load_dwordx4 v209, s[64:67], s7 offen lds
  s_add_u32 m0, s15, 57344
  s_add_u32 s7, s9, 0
  buffer_load_dwordx4 v209, s[68:71], s7 offen lds
  s_add_u32 m0, s15, 61440
  s_add_u32 s7, s9, 36864
  buffer_load_dwordx4 v209, s[68:71], s7 offen lds
  s_add_u32 s14, s14, 128
  s_cmp_ge_u32 s14, 1152
  s_cselect_b32 s14, 0, s14
  s_bitcmp1_b32 s4, 0
  s_mov_b32 s8, 1225003008
  s_mov_b32 s9, 1190050
  s_cmov_b32 s8, 2300842048
  s_cmov_b32 s9, 1198242
  s_mul_i32 s7, s5, 3
  s_lshr_b64 s[8:9], s[8:9], s7
  s_and_b32 s79, s8, 7
  s_add_u32 s94, s94, s79
  s_waitcnt lgkmcnt(0)
  v_lshlrev_b32_e64 v3, 2, v1
  s_mul_i32 s8, s5, 43
  s_lshr_b32 s8, s8, 8
  s_mul_i32 s9, s8, 6
  s_sub_u32 s12, s5, s9
  s_lshl_b32 s11, s4, 2
  s_add_u32 s11, s11, s8
  s_and_b32 s13, s12, 1
  s_mul_i32 s13, s13, 0
  s_mul_i32 s8, s8, 0
  s_add_u32 s13, s13, s8
  s_add_u32 s13, s13, s4
  s_mul_i32 s8, s13, 57
  s_lshr_b32 s8, s8, 9
  s_mul_i32 s8, s8, 9
  s_sub_u32 s13, s13, s8
  s_mov_b64 s[60:61], s[54:55]
  s_mov_b32 s62, 16777216
  s_mov_b32 s63, 0x20000
  s_cmp_eq_u32 s78, 0
  s_cselect_b32 s72, s40, s42
  s_cselect_b32 s73, s41, s43
  s_mov_b32 s74, 663552
  s_mov_b32 s75, 0x20000
  s_mov_b32 s80, s50
  s_and_b32 s81, s51, 0xffff
  s_mov_b32 s82, 4718592
  s_mov_b32 s83, 0x20000
  v_lshrrev_b32 v228, 5, v1
  v_lshlrev_b32 v228, 4, v228
  s_cmp_ge_u32 s94, 9
  s_cselect_b32 s6, 9, 0
  s_sub_u32 s6, s94, s6
  s_lshl_b32 s6, s6, 7
  v_add_u32_e64 v228, s6, v228
  global_load_dwordx4 v[212:215], v228, s[48:49] offset:0
  global_load_dwordx4 v[216:219], v228, s[48:49] offset:32
  global_load_dwordx4 v[220:223], v228, s[48:49] offset:64
  global_load_dwordx4 v[224:227], v228, s[48:49] offset:96
  s_add_u32 s8, s90, s14
  s_add_u32 s9, s91, s14
  s_add_u32 m0, s15, 65536
  s_add_u32 s7, s8, 0
  buffer_load_dwordx4 v208, s[56:59], s7 offen lds
  s_add_u32 m0, s15, 69632
  s_add_u32 s7, s8, 9216
  buffer_load_dwordx4 v208, s[56:59], s7 offen lds
  s_add_u32 m0, s15, 73728
  s_add_u32 s7, s8, 73728
  buffer_load_dwordx4 v208, s[56:59], s7 offen lds
  s_add_u32 m0, s15, 77824
  s_add_u32 s7, s8, 82944
  buffer_load_dwordx4 v208, s[56:59], s7 offen lds
  s_add_u32 m0, s15, 81920
  s_add_u32 s7, s9, 0
  buffer_load_dwordx4 v209, s[64:67], s7 offen lds
  s_add_u32 m0, s15, 86016
  s_add_u32 s7, s9, 36864
  buffer_load_dwordx4 v209, s[64:67], s7 offen lds
  s_add_u32 m0, s15, 90112
  s_add_u32 s7, s9, 0
  buffer_load_dwordx4 v209, s[68:71], s7 offen lds
  s_add_u32 m0, s15, 94208
  s_add_u32 s7, s9, 36864
  buffer_load_dwordx4 v209, s[68:71], s7 offen lds
  s_add_u32 s14, s14, 128
  s_cmp_ge_u32 s14, 1152
  s_cselect_b32 s14, 0, s14
  v_and_b32_e64 v230, 31, v1
  v_bfe_u32 v232, v1, 1, 3
  v_lshlrev_b32 v230, 7, v230
  v_lshrrev_b32 v233, 5, v1
  v_xor_b32_e64 v232, v232, v233
  v_lshl_add_u32 v230, v232, 4, v230
  s_lshl_b32 s6, s76, 12
  v_add_u32 v230, s6, v230
  v_bfe_u32 v232, v1, 2, 1
  v_lshlrev_b32 v232, 5, v232
  v_and_b32 v233, 1, v1
  v_lshl_add_u32 v232, v233, 4, v232
  v_bfe_u32 v233, v1, 3, 2
  v_lshl_add_u32 v232, v233, 1, v232
  v_bfe_u32 v233, v1, 1, 1
  v_add_lshl_u32 v231, v232, v233, 2
  v_lshrrev_b32 v198, 4, v1
  v_and_b32 v199, 7, v1
  v_xor_b32 v198, v198, v199
  v_lshrrev_b32 v199, 3, v1
  v_mul_u32_u24 v199, 3456, v199
  v_lshl_add_u32 v196, v198, 4, v199
  v_xor_b32_e64 v198, 4, v198
  v_lshl_add_u32 v197, v198, 4, v199
  s_mul_i32 s93, s12, 110592
  s_mul_i32 s6, s77, 55296
  s_add_u32 s93, s93, s6
  s_mul_i32 s92, s76, 6144
  s_mul_i32 s6, s76, 6144
  v_and_b32 v206, 15, v1
  v_lshrrev_b32 v207, 1, v206
  v_lshlrev_b32 v206, 7, v206
  v_add_u32 v206, s6, v206
  v_lshrrev_b32 v200, 4, v1
  v_xor_b32_e64 v207, v207, v200
  v_lshl_add_u32 v200, v207, 4, v206
  v_xor_b32_e64 v201, 64, v200
  v_add_u32 v202, 0x10000, v200
  v_add_u32 v203, 0x10000, v201
  v_add_u32 v204, 0x20000, v200
  v_add_u32 v205, 0x20000, v201
  s_lshl_b32 s95, s11, 1
  s_add_u32 s95, s95, s78
  s_mul_i32 s95, s95, 36864
  s_mul_i32 s6, s12, 192
  s_mul_i32 s7, s77, 96
  s_add_u32 s6, s6, s7
  s_add_u32 s95, s95, s6
  v_and_b32_e64 v233, 15, v1
  v_mad_u32_u24 v232, v233, 6, s6
  global_load_ushort v44, v232, s[46:47] offset:0
  global_load_ushort v45, v232, s[46:47] offset:2
  global_load_ushort v46, v232, s[46:47] offset:4
  v_mad_u32_u24 v232, v233, 6, s92
  v_lshrrev_b32_e64 v233, 4, v1
  v_mul_u32_u24 v233, 384, v233
  v_add_u32 v50, v232, v233
  v_add_u32 v232, 0, v1
  v_mul_u32_u24 v233, 0x2aab, v232
  v_lshrrev_b32_e64 v233, 16, v233
  v_mul_u32_u24 v233, 1056, v233
  v_lshl_add_u32 v47, v232, 4, v233
  v_add_u32_e64 v232, 64, v1
  v_mul_u32_u24 v233, 0x2aab, v232
  v_lshrrev_b32_e64 v233, 16, v233
  v_mul_u32_u24 v233, 1056, v233
  v_lshl_add_u32 v48, v232, 4, v233
  v_add_u32 v232, 128, v1
  v_mul_u32_u24 v233, 0x2aab, v232
  v_lshrrev_b32_e64 v233, 16, v233
  v_mul_u32_u24 v233, 1056, v233
  v_lshl_add_u32 v49, v232, 4, v233
  v_mov_b32 v4, 0
  v_mov_b32 v5, 0
  v_mov_b32 v6, 0
  v_mov_b32 v7, 0
  v_mov_b32 v8, 0
  v_mov_b32 v9, 0
  v_mov_b32 v10, 0
  v_mov_b32 v11, 0
  v_mov_b32 v12, 0
  v_mov_b32 v13, 0
  v_mov_b32 v14, 0
  v_mov_b32 v15, 0
  v_mov_b32 v16, 0
  v_mov_b32 v17, 0
  v_mov_b32 v18, 0
  v_mov_b32 v19, 0
  v_mov_b32 v20, 0
  v_mov_b32 v21, 0
  v_mov_b32 v22, 0
  v_mov_b32 v23, 0
  v_mov_b32 v24, 0
  v_mov_b32 v25, 0
  v_mov_b32 v26, 0
  v_mov_b32 v27, 0
  v_xor_b32 v236, 0, v230
  v_xor_b32 v237, 32, v230
  v_xor_b32_e64 v238, 64, v230
  v_xor_b32 v239, 96, v230
  s_setprio 0
  s_waitcnt vmcnt(11)
  s_waitcnt lgkmcnt(0)
  s_barrier
  s_cmp_lg_u32 s79, 0
  s_cbranch_scc1 Lgt11
  ds_read_b128 v[180:183], v236 offset:32768
  ds_read_b128 v[184:187], v237 offset:32768
  ds_read_b128 v[188:191], v238 offset:32768
  ds_read_b128 v[192:195], v239 offset:32768
  s_setprio 1
  s_waitcnt lgkmcnt(0)
  v_mov_b32 v228, 0
  v_mov_b32 v229, 0
  v_dot2c_f32_bf16 v228, v180, v212
  v_dot2c_f32_bf16 v229, v181, v213
  v_dot2c_f32_bf16 v228, v182, v214
  v_dot2c_f32_bf16 v229, v183, v215
  v_dot2c_f32_bf16 v228, v184, v216
  v_dot2c_f32_bf16 v229, v185, v217
  v_dot2c_f32_bf16 v228, v186, v218
  v_dot2c_f32_bf16 v229, v187, v219
  v_dot2c_f32_bf16 v228, v188, v220
  v_dot2c_f32_bf16 v229, v189, v221
  v_dot2c_f32_bf16 v228, v190, v222
  v_dot2c_f32_bf16 v229, v191, v223
  v_dot2c_f32_bf16 v228, v192, v224
  v_dot2c_f32_bf16 v229, v193, v225
  v_dot2c_f32_bf16 v228, v194, v226
  v_dot2c_f32_bf16 v229, v195, v227
  s_nop 2
  v_add_f32 v228, v228, v229
  v_mov_b32 v229, v228
  s_mul_i32 s79, s88, 9
  s_add_u32 s79, s79, s89
  s_lshl_b32 s79, s79, 1
  s_add_u32 s79, s79, s78
  s_lshl_b32 s79, s79, 8
  s_lshl_b32 s7, s77, 5
  s_add_u32 s79, s79, s7
  s_add_u32 s79, s79, 156160
  v_permlane32_swap_b32 v228, v229
  v_add_f32 v228, v228, v229
  v_min_u32 v228, -2, v228
  s_setprio 0
Lgt11:
  s_add_u32 s8, s90, s14
  s_add_u32 s9, s91, s14
  s_add_u32 m0, s15, 0
  s_add_u32 s7, s8, 0
  buffer_load_dwordx4 v208, s[56:59], s7 offen lds
  s_add_u32 m0, s15, 4096
  s_add_u32 s7, s8, 9216
  buffer_load_dwordx4 v208, s[56:59], s7 offen lds
  s_add_u32 m0, s15, 8192
  s_add_u32 s7, s8, 73728
  buffer_load_dwordx4 v208, s[56:59], s7 offen lds
  s_add_u32 m0, s15, 12288
  s_add_u32 s7, s8, 82944
  buffer_load_dwordx4 v208, s[56:59], s7 offen lds
  s_add_u32 m0, s15, 16384
  s_add_u32 s7, s9, 0
  buffer_load_dwordx4 v209, s[64:67], s7 offen lds
  s_add_u32 m0, s15, 20480
  s_add_u32 s7, s9, 36864
  buffer_load_dwordx4 v209, s[64:67], s7 offen lds
  s_add_u32 m0, s15, 24576
  s_add_u32 s7, s9, 0
  buffer_load_dwordx4 v209, s[68:71], s7 offen lds
  s_add_u32 m0, s15, 28672
  s_add_u32 s7, s9, 36864
  buffer_load_dwordx4 v209, s[68:71], s7 offen lds
  s_add_u32 s14, s14, 128
  s_cmp_ge_u32 s14, 1152
  s_cselect_b32 s14, 0, s14
  s_waitcnt vmcnt(11)
  s_waitcnt lgkmcnt(0)
  s_barrier
  s_cmp_lg_u32 s79, 1
  s_cbranch_scc1 Lgt12
  v_add_u32 v236, 0x10000, v236
  v_add_u32 v237, 0x10000, v237
  v_add_u32 v238, 0x10000, v238
  v_add_u32 v239, 0x10000, v239
  ds_read_b128 v[180:183], v236 offset:0
  ds_read_b128 v[184:187], v237 offset:0
  ds_read_b128 v[188:191], v238 offset:0
  ds_read_b128 v[192:195], v239 offset:0
  s_setprio 1
  s_waitcnt lgkmcnt(0)
  v_mov_b32 v228, 0
  v_mov_b32 v229, 0
  v_dot2c_f32_bf16 v228, v180, v212
  v_dot2c_f32_bf16 v229, v181, v213
  v_dot2c_f32_bf16 v228, v182, v214
  v_dot2c_f32_bf16 v229, v183, v215
  v_dot2c_f32_bf16 v228, v184, v216
  v_dot2c_f32_bf16 v229, v185, v217
  v_dot2c_f32_bf16 v228, v186, v218
  v_dot2c_f32_bf16 v229, v187, v219
  v_dot2c_f32_bf16 v228, v188, v220
  v_dot2c_f32_bf16 v229, v189, v221
  v_dot2c_f32_bf16 v228, v190, v222
  v_dot2c_f32_bf16 v229, v191, v223
  v_dot2c_f32_bf16 v228, v192, v224
  v_dot2c_f32_bf16 v229, v193, v225
  v_dot2c_f32_bf16 v228, v194, v226
  v_dot2c_f32_bf16 v229, v195, v227
  s_nop 2
  v_add_f32 v228, v228, v229
  v_mov_b32 v229, v228
  s_mul_i32 s79, s88, 9
  s_add_u32 s79, s79, s89
  s_lshl_b32 s79, s79, 1
  s_add_u32 s79, s79, s78
  s_lshl_b32 s79, s79, 8
  s_lshl_b32 s7, s77, 5
  s_add_u32 s79, s79, s7
  s_add_u32 s79, s79, 156160
  v_permlane32_swap_b32 v228, v229
  v_add_f32 v228, v228, v229
  v_min_u32 v228, -2, v228
  s_setprio 0
Lgt12:
  s_add_u32 s8, s90, s14
  s_add_u32 s9, s91, s14
  s_add_u32 m0, s15, 32768
  s_add_u32 s7, s8, 0
  buffer_load_dwordx4 v208, s[56:59], s7 offen lds
  s_add_u32 m0, s15, 36864
  s_add_u32 s7, s8, 9216
  buffer_load_dwordx4 v208, s[56:59], s7 offen lds
  s_add_u32 m0, s15, 40960
  s_add_u32 s7, s8, 73728
  buffer_load_dwordx4 v208, s[56:59], s7 offen lds
  s_add_u32 m0, s15, 45056
  s_add_u32 s7, s8, 82944
  buffer_load_dwordx4 v208, s[56:59], s7 offen lds
  s_add_u32 m0, s15, 49152
  s_add_u32 s7, s9, 0
  buffer_load_dwordx4 v209, s[64:67], s7 offen lds
  s_add_u32 m0, s15, 53248
  s_add_u32 s7, s9, 36864
  buffer_load_dwordx4 v209, s[64:67], s7 offen lds
  s_add_u32 m0, s15, 57344
  s_add_u32 s7, s9, 0
  buffer_load_dwordx4 v209, s[68:71], s7 offen lds
  s_add_u32 m0, s15, 61440
  s_add_u32 s7, s9, 36864
  buffer_load_dwordx4 v209, s[68:71], s7 offen lds
  s_add_u32 s14, s14, 128
  s_cmp_ge_u32 s14, 1152
  s_cselect_b32 s14, 0, s14
  s_waitcnt vmcnt(8)
  s_waitcnt lgkmcnt(0)
  s_barrier
  s_cmp_lg_u32 s79, 2
  s_cbranch_scc1 Lgt13
  ds_read_b128 v[180:183], v236 offset:0
  ds_read_b128 v[184:187], v237 offset:0
  ds_read_b128 v[188:191], v238 offset:0
  ds_read_b128 v[192:195], v239 offset:0
  s_setprio 1
  s_waitcnt lgkmcnt(0)
  v_mov_b32 v228, 0
  v_mov_b32 v229, 0
  v_dot2c_f32_bf16 v228, v180, v212
  v_dot2c_f32_bf16 v229, v181, v213
  v_dot2c_f32_bf16 v228, v182, v214
  v_dot2c_f32_bf16 v229, v183, v215
  v_dot2c_f32_bf16 v228, v184, v216
  v_dot2c_f32_bf16 v229, v185, v217
  v_dot2c_f32_bf16 v228, v186, v218
  v_dot2c_f32_bf16 v229, v187, v219
  v_dot2c_f32_bf16 v228, v188, v220
  v_dot2c_f32_bf16 v229, v189, v221
  v_dot2c_f32_bf16 v228, v190, v222
  v_dot2c_f32_bf16 v229, v191, v223
  v_dot2c_f32_bf16 v228, v192, v224
  v_dot2c_f32_bf16 v229, v193, v225
  v_dot2c_f32_bf16 v228, v194, v226
  v_dot2c_f32_bf16 v229, v195, v227
  s_nop 2
  v_add_f32 v228, v228, v229
  v_mov_b32_e64 v229, v228
  s_mul_i32 s79, s88, 9
  s_add_u32 s79, s79, s89
  s_lshl_b32 s79, s79, 1
  s_add_u32 s79, s79, s78
  s_lshl_b32 s79, s79, 8
  s_lshl_b32 s7, s77, 5
  s_add_u32 s79, s79, s7
  s_add_u32 s79, s79, 156160
  v_permlane32_swap_b32 v228, v229
  v_add_f32 v228, v228, v229
  v_min_u32 v228, -2, v228
  s_setprio 0
Lgt13:
  s_add_u32 s8, s90, s14
  s_add_u32 s9, s91, s14
  s_add_u32 m0, s15, 65536
  s_add_u32 s7, s8, 0
  buffer_load_dwordx4 v208, s[56:59], s7 offen lds
  s_add_u32 m0, s15, 69632
  s_add_u32 s7, s8, 9216
  buffer_load_dwordx4 v208, s[56:59], s7 offen lds
  s_add_u32 m0, s15, 73728
  s_add_u32 s7, s8, 73728
  buffer_load_dwordx4 v208, s[56:59], s7 offen lds
  s_add_u32 m0, s15, 77824
  s_add_u32 s7, s8, 82944
  buffer_load_dwordx4 v208, s[56:59], s7 offen lds
  s_add_u32 m0, s15, 81920
  s_add_u32 s7, s9, 0
  buffer_load_dwordx4 v209, s[64:67], s7 offen lds
  s_add_u32 m0, s15, 86016
  s_add_u32 s7, s9, 36864
  buffer_load_dwordx4 v209, s[64:67], s7 offen lds
  s_add_u32 m0, s15, 90112
  s_add_u32 s7, s9, 0
  buffer_load_dwordx4 v209, s[68:71], s7 offen lds
  s_add_u32 m0, s15, 94208
  s_add_u32 s7, s9, 36864
  buffer_load_dwordx4 v209, s[68:71], s7 offen lds
  s_add_u32 s14, s14, 128
  s_cmp_ge_u32 s14, 1152
  s_cselect_b32 s14, 0, s14
  s_waitcnt vmcnt(8)
  s_waitcnt lgkmcnt(0)
  s_barrier
  s_add_u32 s8, s90, s14
  s_add_u32 s9, s91, s14
  s_add_u32 m0, s15, 0
  s_add_u32 s7, s8, 0
  buffer_load_dwordx4 v208, s[56:59], s7 offen lds
  s_add_u32 m0, s15, 4096
  s_add_u32 s7, s8, 9216
  buffer_load_dwordx4 v208, s[56:59], s7 offen lds
  s_add_u32 m0, s15, 8192
  s_add_u32 s7, s8, 73728
  buffer_load_dwordx4 v208, s[56:59], s7 offen lds
  s_add_u32 m0, s15, 12288
  s_add_u32 s7, s8, 82944
  buffer_load_dwordx4 v208, s[56:59], s7 offen lds
  s_add_u32 m0, s15, 16384
  s_add_u32 s7, s9, 0
  buffer_load_dwordx4 v209, s[64:67], s7 offen lds
  s_add_u32 m0, s15, 20480
  s_add_u32 s7, s9, 36864
  buffer_load_dwordx4 v209, s[64:67], s7 offen lds
  s_add_u32 m0, s15, 24576
  s_add_u32 s7, s9, 0
  buffer_load_dwordx4 v209, s[68:71], s7 offen lds
  s_add_u32 m0, s15, 28672
  s_add_u32 s7, s9, 36864
  buffer_load_dwordx4 v209, s[68:71], s7 offen lds
  s_add_u32 s14, s14, 128
  s_cmp_ge_u32 s14, 1152
  s_cselect_b32 s14, 0, s14
  s_waitcnt vmcnt(8)
  s_waitcnt lgkmcnt(0)
  s_barrier
  s_add_u32 s8, s90, s14
  s_add_u32 s9, s91, s14
  s_add_u32 m0, s15, 32768
  s_add_u32 s7, s8, 0
  buffer_load_dwordx4 v208, s[56:59], s7 offen lds
  s_add_u32 m0, s15, 36864
  s_add_u32 s7, s8, 9216
  buffer_load_dwordx4 v208, s[56:59], s7 offen lds
  s_add_u32 m0, s15, 40960
  s_add_u32 s7, s8, 73728
  buffer_load_dwordx4 v208, s[56:59], s7 offen lds
  s_add_u32 m0, s15, 45056
  s_add_u32 s7, s8, 82944
  buffer_load_dwordx4 v208, s[56:59], s7 offen lds
  s_add_u32 m0, s15, 49152
  s_add_u32 s7, s9, 0
  buffer_load_dwordx4 v209, s[64:67], s7 offen lds
  s_add_u32 m0, s15, 53248
  s_add_u32 s7, s9, 36864
  buffer_load_dwordx4 v209, s[64:67], s7 offen lds
  s_add_u32 m0, s15, 57344
  s_add_u32 s7, s9, 0
  buffer_load_dwordx4 v209, s[68:71], s7 offen lds
  s_add_u32 m0, s15, 61440
  s_add_u32 s7, s9, 36864
  buffer_load_dwordx4 v209, s[68:71], s7 offen lds
  s_add_u32 s14, s14, 128
  s_cmp_ge_u32 s14, 1152
  s_cselect_b32 s14, 0, s14
  s_waitcnt vmcnt(8)
  s_waitcnt lgkmcnt(0)
  s_barrier
  s_load_dwordx16 s[16:31], s[52:53], 0
  s_add_u32 s8, s90, s14
  s_add_u32 s9, s91, s14
  s_add_u32 m0, s15, 65536
  s_add_u32 s7, s8, 0
  buffer_load_dwordx4 v208, s[56:59], s7 offen lds
  s_add_u32 m0, s15, 69632
  s_add_u32 s7, s8, 9216
  buffer_load_dwordx4 v208, s[56:59], s7 offen lds
  s_add_u32 m0, s15, 73728
  s_add_u32 s7, s8, 73728
  buffer_load_dwordx4 v208, s[56:59], s7 offen lds
  s_add_u32 m0, s15, 77824
  s_add_u32 s7, s8, 82944
  buffer_load_dwordx4 v208, s[56:59], s7 offen lds
  s_add_u32 m0, s15, 81920
  s_add_u32 s7, s9, 0
  buffer_load_dwordx4 v209, s[64:67], s7 offen lds
  s_add_u32 m0, s15, 86016
  s_add_u32 s7, s9, 36864
  buffer_load_dwordx4 v209, s[64:67], s7 offen lds
  s_add_u32 m0, s15, 90112
  s_add_u32 s7, s9, 0
  buffer_load_dwordx4 v209, s[68:71], s7 offen lds
  s_add_u32 m0, s15, 94208
  s_add_u32 s7, s9, 36864
  buffer_load_dwordx4 v209, s[68:71], s7 offen lds
  s_add_u32 s14, s14, 128
  s_cmp_ge_u32 s14, 1152
  s_cselect_b32 s14, 0, s14
  s_waitcnt vmcnt(8)
  s_waitcnt lgkmcnt(0)
  s_barrier
  s_add_u32 s8, s90, s14
  s_add_u32 s9, s91, s14
  s_add_u32 m0, s15, 0
  s_add_u32 s7, s8, 0
  buffer_load_dwordx4 v208, s[56:59], s7 offen lds
  s_add_u32 m0, s15, 4096
  s_add_u32 s7, s8, 9216
  buffer_load_dwordx4 v208, s[56:59], s7 offen lds
  s_add_u32 m0, s15, 8192
  s_add_u32 s7, s8, 73728
  buffer_load_dwordx4 v208, s[56:59], s7 offen lds
  s_add_u32 m0, s15, 12288
  s_add_u32 s7, s8, 82944
  buffer_load_dwordx4 v208, s[56:59], s7 offen lds
  s_add_u32 m0, s15, 16384
  s_add_u32 s7, s9, 0
  buffer_load_dwordx4 v209, s[64:67], s7 offen lds
  s_add_u32 m0, s15, 20480
  s_add_u32 s7, s9, 36864
  buffer_load_dwordx4 v209, s[64:67], s7 offen lds
  s_add_u32 m0, s15, 24576
  s_add_u32 s7, s9, 0
  buffer_load_dwordx4 v209, s[68:71], s7 offen lds
  s_add_u32 m0, s15, 28672
  s_add_u32 s7, s9, 36864
  buffer_load_dwordx4 v209, s[68:71], s7 offen lds
  s_add_u32 s14, s14, 128
  s_cmp_ge_u32 s14, 1152
  s_cselect_b32 s14, 0, s14
  s_and_b64 s[16:17], s[16:17], s[18:19]
  s_and_b64 s[16:17], s[16:17], s[20:21]
  s_and_b64 s[16:17], s[16:17], s[22:23]
  s_and_b64 s[16:17], s[16:17], s[24:25]
  s_and_b64 s[16:17], s[16:17], s[26:27]
  s_and_b64 s[16:17], s[16:17], s[28:29]
  s_and_b64 s[16:17], s[16:17], s[30:31]
  s_and_b32 s16, s16, s17
  s_cmp_lg_u32 s16, 1
  s_cselect_b64 vcc, -1, 0
  s_cbranch_vccnz Len16
Lok14:
  s_waitcnt vmcnt(8)
  s_waitcnt lgkmcnt(0)
  s_barrier
  s_lshl_b32 s14, s13, 7
  s_add_u32 s6, s93, s14
  s_add_u32 m0, s92, 139264
  s_add_u32 s7, s6, 0
  buffer_load_dwordx4 v196, s[72:75], s7 offen lds
  s_add_u32 m0, s92, 140288
  s_add_u32 s7, s6, 27648
  buffer_load_dwordx4 v197, s[72:75], s7 offen lds
  s_add_u32 m0, s92, 141312
  s_add_u32 s7, s6, 1152
  buffer_load_dwordx4 v196, s[72:75], s7 offen lds
  s_add_u32 m0, s92, 142336
  s_add_u32 s7, s6, 28800
  buffer_load_dwordx4 v197, s[72:75], s7 offen lds
  s_add_u32 m0, s92, 143360
  s_add_u32 s7, s6, 2304
  buffer_load_dwordx4 v196, s[72:75], s7 offen lds
  s_add_u32 m0, s92, 144384
  s_add_u32 s7, s6, 29952
  buffer_load_dwordx4 v197, s[72:75], s7 offen lds
  s_add_u32 s14, s14, 128
  s_cmp_ge_u32 s14, 1152
  s_cselect_b32 s14, 0, s14
  s_waitcnt vmcnt(6)
  s_waitcnt lgkmcnt(0)
  s_barrier
  s_setprio 0
  s_add_u32 s6, s93, s14
  s_add_u32 m0, s92, 114688
  s_add_u32 s7, s6, 0
  buffer_load_dwordx4 v196, s[72:75], s7 offen lds
  s_add_u32 m0, s92, 115712
  s_add_u32 s7, s6, 27648
  buffer_load_dwordx4 v197, s[72:75], s7 offen lds
  s_add_u32 m0, s92, 116736
  s_add_u32 s7, s6, 1152
  buffer_load_dwordx4 v196, s[72:75], s7 offen lds
  s_add_u32 m0, s92, 117760
  s_add_u32 s7, s6, 28800
  buffer_load_dwordx4 v197, s[72:75], s7 offen lds
  s_add_u32 m0, s92, 118784
  s_add_u32 s7, s6, 2304
  buffer_load_dwordx4 v196, s[72:75], s7 offen lds
  s_add_u32 m0, s92, 119808
  s_add_u32 s7, s6, 29952
  buffer_load_dwordx4 v197, s[72:75], s7 offen lds
  s_add_u32 s14, s14, 128
  s_cmp_ge_u32 s14, 1152
  s_cselect_b32 s14, 0, s14
  s_add_u32 s6, s93, s14
  s_add_u32 m0, s92, 90112
  s_add_u32 s7, s6, 0
  buffer_load_dwordx4 v196, s[72:75], s7 offen lds
  s_add_u32 m0, s92, 91136
  s_add_u32 s7, s6, 27648
  buffer_load_dwordx4 v197, s[72:75], s7 offen lds
  s_add_u32 m0, s92, 92160
  s_add_u32 s7, s6, 1152
  buffer_load_dwordx4 v196, s[72:75], s7 offen lds
  s_add_u32 m0, s92, 93184
  s_add_u32 s7, s6, 28800
  buffer_load_dwordx4 v197, s[72:75], s7 offen lds
  s_add_u32 m0, s92, 94208
  s_add_u32 s7, s6, 2304
  buffer_load_dwordx4 v196, s[72:75], s7 offen lds
  s_add_u32 m0, s92, 95232
  s_add_u32 s7, s6, 29952
  buffer_load_dwordx4 v197, s[72:75], s7 offen lds
  s_add_u32 s14, s14, 128
  s_cmp_ge_u32 s14, 1152
  s_cselect_b32 s14, 0, s14
  s_waitcnt vmcnt(12)
  ds_read_b128 v[52:55], v204 offset:8192
  ds_read_b128 v[56:59], v204 offset:10240
  ds_read_b128 v[60:63], v204 offset:12288
  ds_read_b128 v[64:67], v205 offset:8192
  ds_read_b128 v[68:71], v205 offset:10240
  ds_read_b128 v[72:75], v205 offset:12288
  s_waitcnt lgkmcnt(0)
  s_waitcnt vmcnt(6)
  ds_read_b128 v[76:79], v202 offset:49152
  ds_read_b128 v[80:83], v202 offset:51200
  ds_read_b128 v[84:87], v202 offset:53248
  ds_read_b128 v[88:91], v203 offset:49152
  ds_read_b128 v[92:95], v203 offset:51200
  ds_read_b128 v[96:99], v203 offset:53248
  s_waitcnt lgkmcnt(0)
  s_barrier
  s_mov_b32 exec_hi, 0
  buffer_store_dword v228, v231, s[60:63], s79 offen sc1
  s_mov_b32 exec_hi, -1
  s_add_u32 s6, s93, s14
  s_add_u32 m0, s92, 65536
  s_add_u32 s7, s6, 0
  buffer_load_dwordx4 v196, s[72:75], s7 offen lds
  s_add_u32 m0, s92, 66560
  s_add_u32 s7, s6, 27648
  buffer_load_dwordx4 v197, s[72:75], s7 offen lds
  s_add_u32 m0, s92, 67584
  s_add_u32 s7, s6, 1152
  buffer_load_dwordx4 v196, s[72:75], s7 offen lds
  s_add_u32 m0, s92, 68608
  s_add_u32 s7, s6, 28800
  buffer_load_dwordx4 v197, s[72:75], s7 offen lds
  s_add_u32 m0, s92, 69632
  s_add_u32 s7, s6, 2304
  buffer_load_dwordx4 v196, s[72:75], s7 offen lds
  s_add_u32 m0, s92, 70656
  s_add_u32 s7, s6, 29952
  buffer_load_dwordx4 v197, s[72:75], s7 offen lds
  s_add_u32 s14, s14, 128
  s_cmp_ge_u32 s14, 1152
  s_cselect_b32 s14, 0, s14
  s_waitcnt vmcnt(7)
  ds_read_b128 v[100:103], v202 offset:24576
  ds_read_b128 v[104:107], v202 offset:26624
  ds_read_b128 v[108:111], v202 offset:28672
  ds_read_b128 v[112:115], v203 offset:24576
  ds_read_b128 v[116:119], v203 offset:26624
  ds_read_b128 v[120:123], v203 offset:28672
  s_waitcnt lgkmcnt(0)
  v_bfe_u32 v212, v1, 1, 1
  v_lshrrev_b32 v213, 4, v1
  v_lshlrev_b32 v213, 3, v213
  v_bfe_u32 v214, v1, 2, 2
  v_add_u32_e64 v213, v213, v214
  v_lshl_add_u32 v213, v212, 2, v213
  v_lshlrev_b32_e64 v213, 4, v213
  v_lshl_add_u32 v213, v212, 10, v213
  v_and_b32_e64 v212, 1, v1
  v_lshl_add_u32 v213, v212, 3, v213
  s_mul_i32 s6, s78, 8704
  v_add_u32 v228, s6, v213
  v_xor_b32 v229, 64, v228
  v_xor_b32 v230, 512, v228
  v_xor_b32 v231, 512, v229
  v_add_u32 v232, 139264, v228
  v_add_u32 v233, 139264, v229
  v_add_u32 v234, 139264, v230
  v_add_u32 v235, 139264, v231
  s_mul_i32 s6, s76, 6144
  s_add_u32 s6, s6, 90112
  v_lshl_add_u32 v236, v1, 4, s6
  s_xor_b32 s6, s76, 2
  s_mul_i32 s6, s6, 6144
  s_add_u32 s6, s6, 90112
  v_lshl_add_u32 v237, v1, 4, s6
  s_lshl_b32 s6, s78, 7
  s_add_u32 s6, s6, 159744
  v_lshrrev_b32_e64 v212, 4, v1
  v_lshl_add_u32 v238, v212, 4, s6
  v_mul_u32_u24 v242, 9216, v212
  v_and_b32_e64 v213, 15, v1
  v_mad_u32_u24 v242, v213, 12, v242
  s_lshl_b32 s91, s11, 1
  s_add_u32 s91, s91, s78
  s_mul_i32 s91, s91, 73728
  s_mul_i32 s7, s12, 384
  s_add_u32 s91, s91, s7
  s_mul_i32 s7, s77, 192
  s_add_u32 s91, s91, s7
  s_mul_i32 s6, s77, 6144
  s_add_u32 s6, s6, 114688
  s_lshl_b32 s7, s78, 2
  v_lshrrev_b32 v214, 5, v1
  v_add_u32_e64 v214, s7, v214
  v_bfe_u32 v212, v1, 3, 1
  v_mul_u32_u24 v212, 12288, v212
  v_bfe_u32 v213, v1, 4, 1
  v_lshlrev_b32_e64 v213, 3, v213
  v_add3_u32 v212, v212, v213, s6
  v_and_b32 v213, 7, v1
  v_mul_u32_u24 v213, 3, v213
  v_add_u32_e64 v215, 0, v213
  v_bfe_u32 v216, v215, 1, 1
  v_and_or_b32 v216, v215, 4, v216
  v_xor_b32_e64 v216, v216, v214
  v_lshl_add_u32 v215, v215, 7, v212
  v_lshl_add_u32 v239, v216, 4, v215
  v_add_u32_e64 v215, 1, v213
  v_bfe_u32 v216, v215, 1, 1
  v_and_or_b32 v216, v215, 4, v216
  v_xor_b32_e64 v216, v216, v214
  v_lshl_add_u32 v215, v215, 7, v212
  v_lshl_add_u32 v240, v216, 4, v215
  v_add_u32_e64 v215, 2, v213
  v_bfe_u32 v216, v215, 1, 1
  v_and_or_b32 v216, v215, 4, v216
  v_xor_b32_e64 v216, v216, v214
  v_lshl_add_u32 v215, v215, 7, v212
  v_lshl_add_u32 v241, v216, 4, v215
  s_mul_i32 s6, s76, 6144
  v_and_b32 v218, 15, v1
  v_lshrrev_b32 v219, 1, v218
  v_lshlrev_b32 v218, 7, v218
  v_add_u32 v218, s6, v218
  v_lshrrev_b32 v212, 4, v1
  v_xor_b32 v219, v219, v212
  v_lshl_add_u32 v212, v219, 4, v218
  v_xor_b32_e64 v213, 64, v212
  v_add_u32 v214, 0x10000, v212
  v_add_u32 v215, 0x10000, v213
  v_add_u32 v216, 0x20000, v212
  v_add_u32 v217, 0x20000, v213
  v_mov_b32 v244, v214
  v_mov_b32_e64 v245, v215
  s_add_u32 s16, s91, 0
  s_add_u32 s17, s91, 4608
  s_add_u32 s18, s91, 36864
  s_add_u32 s19, s91, 41472
  s_barrier
  s_add_u32 s6, s93, s14
  s_add_u32 m0, s92, 40960
  s_add_u32 s7, s6, 0
  buffer_load_dwordx4 v196, s[72:75], s7 offen lds
  s_add_u32 m0, s92, 41984
  s_add_u32 s7, s6, 27648
  buffer_load_dwordx4 v197, s[72:75], s7 offen lds
  s_add_u32 m0, s92, 43008
  s_add_u32 s7, s6, 1152
  buffer_load_dwordx4 v196, s[72:75], s7 offen lds
  s_add_u32 m0, s92, 44032
  s_add_u32 s7, s6, 28800
  buffer_load_dwordx4 v197, s[72:75], s7 offen lds
  s_add_u32 m0, s92, 45056
  s_add_u32 s7, s6, 2304
  buffer_load_dwordx4 v196, s[72:75], s7 offen lds
  s_add_u32 m0, s92, 46080
  s_add_u32 s7, s6, 29952
  buffer_load_dwordx4 v197, s[72:75], s7 offen lds
  s_add_u32 s14, s14, 128
  s_cmp_ge_u32 s14, 1152
  s_cselect_b32 s14, 0, s14
  s_add_u32 s6, s93, s14
  s_add_u32 m0, s92, 139264
  s_add_u32 s7, s6, 0
  buffer_load_dwordx4 v196, s[72:75], s7 offen lds
  s_add_u32 m0, s92, 140288
  s_add_u32 s7, s6, 27648
  buffer_load_dwordx4 v197, s[72:75], s7 offen lds
  s_add_u32 m0, s92, 141312
  s_add_u32 s7, s6, 1152
  buffer_load_dwordx4 v196, s[72:75], s7 offen lds
  s_add_u32 m0, s92, 142336
  s_add_u32 s7, s6, 28800
  buffer_load_dwordx4 v197, s[72:75], s7 offen lds
  s_add_u32 m0, s92, 143360
  s_add_u32 s7, s6, 2304
  buffer_load_dwordx4 v196, s[72:75], s7 offen lds
  s_add_u32 m0, s92, 144384
  s_add_u32 s7, s6, 29952
  buffer_load_dwordx4 v197, s[72:75], s7 offen lds
  s_add_u32 s14, s14, 128
  s_cmp_ge_u32 s14, 1152
  s_cselect_b32 s14, 0, s14
  s_waitcnt vmcnt(12)
  ds_read_b128 v[124:127], v202 offset:0
  ds_read_b128 v[128:131], v202 offset:2048
  ds_read_b128 v[132:135], v202 offset:4096
  ds_read_b128 v[136:139], v203 offset:0
  ds_read_b128 v[140:143], v203 offset:2048
  ds_read_b128 v[144:147], v203 offset:4096
  s_waitcnt lgkmcnt(0)
  s_waitcnt vmcnt(6)
  ds_read_b128 v[148:151], v200 offset:40960
  ds_read_b128 v[152:155], v200 offset:43008
  ds_read_b128 v[156:159], v200 offset:45056
  ds_read_b128 v[160:163], v201 offset:40960
  ds_read_b128 v[164:167], v201 offset:43008
  ds_read_b128 v[168:171], v201 offset:45056
  s_waitcnt lgkmcnt(0)
  s_barrier
  s_add_u32 m0, s92, 0
  s_nop 0
  buffer_load_dwordx4 v47, s[56:59], s95 offen lds
  s_add_u32 m0, s92, 1024
  s_nop 0
  buffer_load_dwordx4 v48, s[56:59], s95 offen lds
  s_add_u32 m0, s92, 2048
  s_nop 0
  buffer_load_dwordx4 v49, s[56:59], s95 offen lds
  s_lshr_b32 s8, s11, 1
  s_mul_i32 s8, s8, 4608
  s_and_b32 s7, s11, 1
  s_lshl_b32 s7, s7, 8
  s_add_u32 s8, s8, s7
  s_add_u32 s8, s8, 156160
  s_add_u32 s9, s8, 4096
  s_cmp_lg_u32 s76, 0
  s_cbranch_scc1 Lq017
  buffer_load_dword v28, v3, s[60:63], s8 offen offset:0 sc1
  buffer_load_dword v29, v3, s[60:63], s8 offen offset:512 sc1
  buffer_load_dword v30, v3, s[60:63], s8 offen offset:1024 sc1
  buffer_load_dword v31, v3, s[60:63], s8 offen offset:1536 sc1
  buffer_load_dword v32, v3, s[60:63], s8 offen offset:2048 sc1
  buffer_load_dword v33, v3, s[60:63], s8 offen offset:2560 sc1
  buffer_load_dword v34, v3, s[60:63], s8 offen offset:3072 sc1
  buffer_load_dword v35, v3, s[60:63], s8 offen offset:3584 sc1
  buffer_load_dword v36, v3, s[60:63], s9 offen offset:0 sc1
Lq017:
  s_add_u32 s6, s93, s14
  s_add_u32 m0, s92, 114688
  s_add_u32 s7, s6, 0
  buffer_load_dwordx4 v196, s[72:75], s7 offen lds
  s_add_u32 m0, s92, 115712
  s_add_u32 s7, s6, 27648
  buffer_load_dwordx4 v197, s[72:75], s7 offen lds
  s_add_u32 m0, s92, 116736
  s_add_u32 s7, s6, 1152
  buffer_load_dwordx4 v196, s[72:75], s7 offen lds
  s_add_u32 m0, s92, 117760
  s_add_u32 s7, s6, 28800
  buffer_load_dwordx4 v197, s[72:75], s7 offen lds
  s_add_u32 m0, s92, 118784
  s_add_u32 s7, s6, 2304
  buffer_load_dwordx4 v196, s[72:75], s7 offen lds
  s_add_u32 m0, s92, 119808
  s_add_u32 s7, s6, 29952
  buffer_load_dwordx4 v197, s[72:75], s7 offen lds
  s_add_u32 s14, s14, 128
  s_cmp_ge_u32 s14, 1152
  s_cselect_b32 s14, 0, s14
  s_waitcnt vmcnt(6)
  ds_read_u16_d16_hi v4, v50 offset:0
  ds_read_u16_d16_hi v5, v50 offset:96
  ds_read_u16_d16_hi v6, v50 offset:192
  ds_read_u16_d16_hi v7, v50 offset:288
  ds_read_u16_d16_hi v8, v50 offset:2
  ds_read_u16_d16_hi v9, v50 offset:98
  ds_read_u16_d16_hi v10, v50 offset:194
  ds_read_u16_d16_hi v11, v50 offset:290
  ds_read_u16_d16_hi v12, v50 offset:4
  ds_read_u16_d16_hi v13, v50 offset:100
  ds_read_u16_d16_hi v14, v50 offset:196
  ds_read_u16_d16_hi v15, v50 offset:292
  ds_read_u16_d16_hi v16, v50 offset:1536
  ds_read_u16_d16_hi v17, v50 offset:1632
  ds_read_u16_d16_hi v18, v50 offset:1728
  ds_read_u16_d16_hi v19, v50 offset:1824
  ds_read_u16_d16_hi v20, v50 offset:1538
  ds_read_u16_d16_hi v21, v50 offset:1634
  ds_read_u16_d16_hi v22, v50 offset:1730
  ds_read_u16_d16_hi v23, v50 offset:1826
  ds_read_u16_d16_hi v24, v50 offset:1540
  ds_read_u16_d16_hi v25, v50 offset:1636
  ds_read_u16_d16_hi v26, v50 offset:1732
  ds_read_u16_d16_hi v27, v50 offset:1828
  ds_read_b128 v[172:175], v204 offset:8192
  ds_read_b128 v[176:179], v204 offset:10240
  ds_read_b128 v[180:183], v204 offset:12288
  ds_read_b128 v[184:187], v205 offset:8192
  ds_read_b128 v[188:191], v205 offset:10240
  ds_read_b128 v[192:195], v205 offset:12288
  s_waitcnt lgkmcnt(0)
  s_waitcnt lgkmcnt(0)
  s_barrier
  s_add_u32 s6, s93, s14
  s_add_u32 m0, s92, 90112
  s_add_u32 s7, s6, 0
  buffer_load_dwordx4 v196, s[72:75], s7 offen lds
  s_add_u32 m0, s92, 91136
  s_add_u32 s7, s6, 27648
  buffer_load_dwordx4 v197, s[72:75], s7 offen lds
  s_add_u32 m0, s92, 92160
  s_add_u32 s7, s6, 1152
  buffer_load_dwordx4 v196, s[72:75], s7 offen lds
  s_add_u32 m0, s92, 93184
  s_add_u32 s7, s6, 28800
  buffer_load_dwordx4 v197, s[72:75], s7 offen lds
  s_add_u32 m0, s92, 94208
  s_add_u32 s7, s6, 2304
  buffer_load_dwordx4 v196, s[72:75], s7 offen lds
  s_add_u32 m0, s92, 95232
  s_add_u32 s7, s6, 29952
  buffer_load_dwordx4 v197, s[72:75], s7 offen lds
  s_add_u32 s14, s14, 128
  s_cmp_ge_u32 s14, 1152
  s_cselect_b32 s14, 0, s14
  s_add_u32 s6, s93, s14
  s_add_u32 m0, s92, 65536
  s_add_u32 s7, s6, 0
  buffer_load_dwordx4 v196, s[72:75], s7 offen lds
  s_add_u32 m0, s92, 66560
  s_add_u32 s7, s6, 27648
  buffer_load_dwordx4 v197, s[72:75], s7 offen lds
  s_add_u32 m0, s92, 67584
  s_add_u32 s7, s6, 1152
  buffer_load_dwordx4 v196, s[72:75], s7 offen lds
  s_add_u32 m0, s92, 68608
  s_add_u32 s7, s6, 28800
  buffer_load_dwordx4 v197, s[72:75], s7 offen lds
  s_add_u32 m0, s92, 69632
  s_add_u32 s7, s6, 2304
  buffer_load_dwordx4 v196, s[72:75], s7 offen lds
  s_add_u32 m0, s92, 70656
  s_add_u32 s7, s6, 29952
  buffer_load_dwordx4 v197, s[72:75], s7 offen lds
  s_add_u32 s14, s14, 128
  s_cmp_ge_u32 s14, 1152
  s_cselect_b32 s14, 0, s14
  s_waitcnt lgkmcnt(0)
  s_branch L_B2
L_GA:
  s_waitcnt lgkmcnt(0)
  v_lshlrev_b32_e64 v3, 2, v1
  s_mul_i32 s8, s5, 43
  s_lshr_b32 s8, s8, 8
  s_mul_i32 s9, s8, 6
  s_sub_u32 s12, s5, s9
  s_lshl_b32 s11, s4, 2
  s_add_u32 s11, s11, s8
  s_and_b32 s13, s12, 1
  s_mul_i32 s13, s13, 0
  s_mul_i32 s8, s8, 0
  s_add_u32 s13, s13, s8
  s_add_u32 s13, s13, s4
  s_mul_i32 s8, s13, 57
  s_lshr_b32 s8, s8, 9
  s_mul_i32 s8, s8, 9
  s_sub_u32 s13, s13, s8
  s_mov_b64 s[60:61], s[54:55]
  s_mov_b32 s62, 16777216
  s_mov_b32 s63, 0x20000
  s_cmp_eq_u32 s78, 0
  s_cselect_b32 s72, s40, s42
  s_cselect_b32 s73, s41, s43
  s_mov_b32 s74, 663552
  s_mov_b32 s75, 0x20000
  s_mov_b32 s80, s50
  s_and_b32 s81, s51, 0xffff
  s_mov_b32 s82, 4718592
  s_mov_b32 s83, 0x20000
  s_cmp_gt_u32 s89, 4
  s_subb_u32 s95, s89, 0
  s_lshl_b32 s95, s95, 1
  s_add_u32 s95, s95, s88
  s_sub_u32 s95, s95, 14
  s_cmp_lt_u32 s88, 14
  s_cselect_b32 s95, 99, s95
  s_cmp_eq_u32 s89, 4
  s_cselect_b32 s95, 99, s95
  s_cmp_ge_u32 s95, 16
  s_cbranch_scc1 L_noclr
  s_cmp_lg_u32 s3, 0
  s_cbranch_scc1 L_noclr
  s_mul_i32 s6, s95, 15360
  v_lshlrev_b32 v4, 4, v1
  v_mov_b32 v8, -1
  v_mov_b32 v9, -1
  v_mov_b32 v10, -1
  v_mov_b32 v11, -1
  buffer_store_dwordx4 v[8:11], v4, s[60:63], s6 offen offset:0 sc1
  buffer_store_dwordx4 v[8:11], v4, s[60:63], s6 offen offset:1024 sc1
  buffer_store_dwordx4 v[8:11], v4, s[60:63], s6 offen offset:2048 sc1
  buffer_store_dwordx4 v[8:11], v4, s[60:63], s6 offen offset:3072 sc1
  s_add_u32 s6, s6, 4096
  buffer_store_dwordx4 v[8:11], v4, s[60:63], s6 offen offset:0 sc1
  buffer_store_dwordx4 v[8:11], v4, s[60:63], s6 offen offset:1024 sc1
  buffer_store_dwordx4 v[8:11], v4, s[60:63], s6 offen offset:2048 sc1
  buffer_store_dwordx4 v[8:11], v4, s[60:63], s6 offen offset:3072 sc1
  s_add_u32 s6, s6, 4096
  buffer_store_dwordx4 v[8:11], v4, s[60:63], s6 offen offset:0 sc1
  buffer_store_dwordx4 v[8:11], v4, s[60:63], s6 offen offset:1024 sc1
  buffer_store_dwordx4 v[8:11], v4, s[60:63], s6 offen offset:2048 sc1
  buffer_store_dwordx4 v[8:11], v4, s[60:63], s6 offen offset:3072 sc1
  s_add_u32 s6, s6, 4096
  buffer_store_dwordx4 v[8:11], v4, s[60:63], s6 offen offset:0 sc1
  buffer_store_dwordx4 v[8:11], v4, s[60:63], s6 offen offset:1024 sc1
  buffer_store_dwordx4 v[8:11], v4, s[60:63], s6 offen offset:2048 sc1
  s_mul_i32 s6, s95, 4608
  s_add_u32 s6, s6, 327680
  v_min_u32 v4, 35, v1
  v_lshlrev_b32 v4, 7, v4
  v_cmp_gt_u32_e64 vcc, 36, v1
  s_nop 0
  s_mov_b64 exec, vcc
  buffer_store_dword v8, v4, s[60:63], s6 offen sc1
  s_mov_b64 exec, -1
L_noclr:
  s_lshl_b32 s6, s89, 1
  s_add_u32 s6, s6, s77
  s_lshl_b32 s6, s6, 6
  v_and_b32_e64 v7, 31, v1
  v_lshl_add_u32 v7, v7, 1, s6
  global_load_ushort v4, v7, s[32:33]
  global_load_ushort v5, v7, s[34:35]
  global_load_ushort v6, v7, s[44:45]
  v_and_b32_e64 v24, 31, v1
  v_bfe_u32 v25, v1, 1, 3
  v_lshlrev_b32 v24, 7, v24
  v_lshrrev_b32 v8, 5, v1
  v_xor_b32_e64 v25, v25, v8
  v_lshl_add_u32 v24, v25, 4, v24
  s_lshl_b32 s6, s78, 13
  s_lshl_b32 s7, s77, 12
  s_add_u32 s7, s7, 16384
  v_xor_b32 v25, 0, v24
  v_add_u32 v8, s6, v25
  v_add_u32_e64 v16, s7, v25
  v_add_u32 v12, 0x10000, v8
  v_add_u32 v20, 0x10000, v16
  v_xor_b32 v25, 32, v24
  v_add_u32 v9, s6, v25
  v_add_u32_e64 v17, s7, v25
  v_add_u32 v13, 0x10000, v9
  v_add_u32 v21, 0x10000, v17
  v_xor_b32 v25, 64, v24
  v_add_u32 v10, s6, v25
  v_add_u32_e64 v18, s7, v25
  v_add_u32 v14, 0x10000, v10
  v_add_u32 v22, 0x10000, v18
  v_xor_b32 v25, 96, v24
  v_add_u32 v11, s6, v25
  v_add_u32 v19, s7, v25
  v_add_u32 v15, 0x10000, v11
  v_add_u32 v23, 0x10000, v19
  s_lshl_b32 s6, s89, 1
  s_add_u32 s6, s6, s77
  s_lshl_b32 s6, s6, 13
  s_add_u32 s84, s54, s6
  s_addc_u32 s85, s55, 0
  s_and_b32 s85, s85, 0xffff
  s_mov_b32 s86, 8192
  s_mov_b32 s87, 0x20000
  s_lshl_b32 s90, s88, 1
  s_add_u32 s90, s90, s78
  v_and_b32 v24, 31, v1
  v_lshlrev_b32 v24, 4, v24
  s_lshl_b32 s6, s88, 9
  v_add_u32 v24, s6, v24
  v_lshrrev_b32 v48, 5, v1
  v_lshlrev_b32 v48, 12, v48
  v_sub_u32 v48, v24, v48
  s_lshl_b32 s6, s78, 3
  v_add_u32_e64 v24, s6, v24
  s_lshl_b32 s6, s76, 9
  v_lshl_add_u32 v44, v1, 3, s6
  s_lshl_b32 s6, s77, 9
  v_lshl_add_u32 v45, v1, 3, s6
  v_lshlrev_b32 v36, 4, v1
  v_xor_b32_e64 v37, 64, v36
  s_mul_i32 s91, s90, 147456
  s_lshl_b32 s7, s89, 14
  s_add_u32 s91, s91, s7
  s_lshl_b32 s7, s77, 12
  s_add_u32 s91, s91, s7
  s_add_u32 s91, s91, 1048576
  s_add_u32 s92, s91, 8192
  v_mov_b32 v40, 0
  v_mov_b32 v41, 1
  v_mov_b32 v42, 2
  v_mov_b32_e64 v43, 3
  s_mul_i32 s93, s90, 18
  s_lshl_b32 s7, s89, 1
  s_add_u32 s93, s93, s7
  s_add_u32 s93, s93, s77
  s_lshl_b32 s93, s93, 7
  s_add_u32 s93, s93, 327680
  v_subrev_u32 v28, 512, v48
  v_min_u32 v28, 0x10000, v28
  v_subrev_u32 v29, 1024, v48
  v_min_u32 v29, 0x10000, v29
  v_subrev_u32 v30, 1536, v48
  v_min_u32 v30, 0x10000, v30
  v_subrev_u32 v31, 2048, v48
  v_min_u32 v31, 0x10000, v31
  v_subrev_u32 v32, 2560, v48
  v_min_u32 v32, 0x10000, v32
  v_subrev_u32 v33, 3072, v48
  v_min_u32 v33, 0x10000, v33
  v_subrev_u32 v34, 3584, v48
  v_min_u32 v34, 0x10000, v34
  v_subrev_u32 v35, 4096, v48
  v_min_u32 v35, 0x10000, v35
  s_waitcnt vmcnt(2)
  v_lshlrev_b32 v4, 16, v4
  s_waitcnt vmcnt(1)
  v_lshlrev_b32 v5, 16, v5
  s_waitcnt vmcnt(0)
  v_lshlrev_b32 v6, 16, v6
  v_mul_f32 v70, 0x3fb8aa3b, v6
  v_exp_f32 v70, v70
  s_nop 0
  v_cvt_pk_bf16_f32 v70, 0, v70
  v_mul_f32 v68, v70, v4
  v_mul_f32 v69, v70, v5
  v_mul_f32 v68, 0x3fb8aa3b, v68
  v_mul_f32 v69, 0.15915494, v69
  v_exp_f32 v64, v68
  v_fract_f32 v65, v69
  v_cos_f32 v48, v65
  v_sin_f32 v49, v65
  v_mul_f32 v48, v48, v64
  v_mul_f32 v49, v49, v64
  v_mul_f32 v68, v4, v4
  v_fma_f32 v68, v5, v5, v68
  v_rcp_f32 v68, v68
  v_add_f32 v64, -1.0, v48
  v_mov_b32 v65, v49
  v_add_f32 v68, v68, v68
  v_mul_f32_e64 v66, v4, v68
  v_mul_f32 v67, -v5, v68
  v_pk_mul_f32 v[58:59], v[64:65], v[66:67] op_sel_hi:[1,0]
  v_pk_fma_f32 v[58:59], v[64:65], v[66:67], v[58:59] op_sel:[1,1,0] op_sel_hi:[0,1,1] neg_lo:[1,0,0]
  v_pk_mul_f32 v[64:65], v[48:49], v[48:49] op_sel_hi:[1,0]
  v_pk_fma_f32 v[64:65], v[48:49], v[48:49], v[64:65] op_sel:[1,1,0] op_sel_hi:[0,1,1] neg_lo:[1,0,0]
  v_pk_mul_f32 v[66:67], v[64:65], v[64:65] op_sel_hi:[1,0]
  v_pk_fma_f32 v[66:67], v[64:65], v[64:65], v[66:67] op_sel:[1,1,0] op_sel_hi:[0,1,1] neg_lo:[1,0,0]
  v_pk_mul_f32 v[64:65], v[66:67], v[66:67] op_sel_hi:[1,0]
  v_pk_fma_f32 v[64:65], v[66:67], v[66:67], v[64:65] op_sel:[1,1,0] op_sel_hi:[0,1,1] neg_lo:[1,0,0]
  v_pk_mul_f32 v[50:51], v[64:65], v[64:65] op_sel_hi:[1,0]
  v_pk_fma_f32 v[50:51], v[64:65], v[64:65], v[50:51] op_sel:[1,1,0] op_sel_hi:[0,1,1] neg_lo:[1,0,0]
  v_pk_mul_f32 v[52:53], v[50:51], v[50:51] op_sel_hi:[1,0]
  v_pk_fma_f32 v[52:53], v[50:51], v[50:51], v[52:53] op_sel:[1,1,0] op_sel_hi:[0,1,1] neg_lo:[1,0,0]
  v_pk_mul_f32 v[54:55], v[52:53], v[52:53] op_sel_hi:[1,0]
  v_pk_fma_f32 v[54:55], v[52:53], v[52:53], v[54:55] op_sel:[1,1,0] op_sel_hi:[0,1,1] neg_lo:[1,0,0]
  v_pk_mul_f32 v[64:65], v[54:55], v[54:55] op_sel_hi:[1,0]
  v_pk_fma_f32 v[64:65], v[54:55], v[54:55], v[64:65] op_sel:[1,1,0] op_sel_hi:[0,1,1] neg_lo:[1,0,0]
  v_pk_mul_f32 v[66:67], v[64:65], v[64:65] op_sel_hi:[1,0]
  v_pk_fma_f32 v[66:67], v[64:65], v[64:65], v[66:67] op_sel:[1,1,0] op_sel_hi:[0,1,1] neg_lo:[1,0,0]
  v_pk_mul_f32 v[64:65], v[66:67], v[66:67] op_sel_hi:[1,0]
  v_pk_fma_f32 v[64:65], v[66:67], v[66:67], v[64:65] op_sel:[1,1,0] op_sel_hi:[0,1,1] neg_lo:[1,0,0]
  v_pk_mul_f32 v[56:57], v[64:65], v[64:65] op_sel_hi:[1,0]
  v_pk_fma_f32 v[56:57], v[64:65], v[64:65], v[56:57] op_sel:[1,1,0] op_sel_hi:[0,1,1] neg_lo:[1,0,0]
  s_cmp_lg_u32 s78, 0
  s_cselect_b64 vcc, -1, 0
  v_cndmask_b32 v46, 1.0, v54, vcc
  v_cndmask_b32 v47, 0, v55, vcc
  v_pk_mul_f32 v[64:65], v[58:59], v[52:53] op_sel_hi:[1,0]
  v_pk_fma_f32 v[64:65], v[58:59], v[52:53], v[64:65] op_sel:[1,1,0] op_sel_hi:[0,1,1] neg_lo:[1,0,0]
  v_cmp_gt_u32 vcc, 32, v1
  s_nop 1
  v_cndmask_b32 v64, v64, v58, vcc
  v_cndmask_b32 v65, v65, v59, vcc
  v_pk_mul_f32 v[66:67], v[64:65], v[50:51] op_sel_hi:[1,0]
  v_pk_fma_f32 v[66:67], v[64:65], v[50:51], v[66:67] op_sel:[1,1,0] op_sel_hi:[0,1,1] neg_lo:[1,0,0]
  v_mov_b32 v60, v64
  v_mov_b32 v61, v66
  v_mov_b32 v62, v65
  v_mov_b32 v63, v67
  s_cmp_ge_u32 s95, 16
  s_cbranch_scc1 L_noclr2
  s_cmp_lg_u32 s3, 0
  s_cbranch_scc1 L_noclr2
  s_lshl_b32 s6, s95, 2
  v_mov_b32 v64, s6
  v_mov_b32_e64 v65, 1
  s_waitcnt vmcnt(0)
  s_mov_b64 exec, 1
  global_store_dword v64, v65, s[52:53] sc1
  s_mov_b64 exec, -1
L_noclr2:
  s_barrier
  s_cmp_lg_u32 s76, 0
  s_cbranch_scc1 Lq01
  v_lshlrev_b32_e64 v193, 21, v1
  v_add_u32 v193, 2097024, v193
  s_mov_b64 exec, 31
  buffer_load_dword v2, v193, s[60:63], 0 offen sc1
  v_lshlrev_b32_e64 v193, 21, v1
  s_mov_b64 exec, 1
  global_load_dword v2, v193, s[40:41]
  global_load_dword v2, v193, s[42:43]
  s_mov_b64 exec, -1
Lq01:
  ds_read_b128 v[128:131], v8 offset:32768
  ds_read_b128 v[136:139], v16 offset:32768
  ds_read_b128 v[132:135], v8 offset:36864
  ds_read_b128 v[140:143], v16 offset:40960
  ds_read_b128 v[144:147], v9 offset:32768
  ds_read_b128 v[152:155], v17 offset:32768
  ds_read_b128 v[148:151], v9 offset:36864
  ds_read_b128 v[156:159], v17 offset:40960
  s_waitcnt lgkmcnt(6)
  v_mfma_f32_32x32x16_bf16 v[64:79], v[128:131], v[136:139], 0
  ds_read_b128 v[160:163], v10 offset:32768
  s_waitcnt lgkmcnt(6)
  v_mfma_f32_32x32x16_bf16 v[80:95], v[132:135], v[136:139], 0
  ds_read_b128 v[168:171], v18 offset:32768
  s_waitcnt lgkmcnt(6)
  v_mfma_f32_32x32x16_bf16 v[96:111], v[128:131], v[140:143], 0
  ds_read_b128 v[164:167], v10 offset:36864
  v_mfma_f32_32x32x16_bf16 v[112:127], v[132:135], v[140:143], 0
  ds_read_b128 v[172:175], v18 offset:40960
  s_waitcnt lgkmcnt(6)
  v_mfma_f32_32x32x16_bf16 v[64:79], v[144:147], v[152:155], v[64:79]
  ds_read_b128 v[176:179], v11 offset:32768
  s_waitcnt lgkmcnt(6)
  v_mfma_f32_32x32x16_bf16 v[80:95], v[148:151], v[152:155], v[80:95]
  ds_read_b128 v[184:187], v19 offset:32768
  s_waitcnt lgkmcnt(6)
  v_mfma_f32_32x32x16_bf16 v[96:111], v[144:147], v[156:159], v[96:111]
  ds_read_b128 v[180:183], v11 offset:36864
  v_mfma_f32_32x32x16_bf16 v[112:127], v[148:151], v[156:159], v[112:127]
  ds_read_b128 v[188:191], v19 offset:40960
  s_waitcnt lgkmcnt(6)
  v_mfma_f32_32x32x16_bf16 v[64:79], v[160:163], v[168:171], v[64:79]
  s_waitcnt lgkmcnt(5)
  v_mfma_f32_32x32x16_bf16 v[80:95], v[164:167], v[168:171], v[80:95]
  s_waitcnt lgkmcnt(4)
  v_mfma_f32_32x32x16_bf16 v[96:111], v[160:163], v[172:175], v[96:111]
  v_mfma_f32_32x32x16_bf16 v[112:127], v[164:167], v[172:175], v[112:127]
  s_waitcnt lgkmcnt(0)
  s_barrier
  v_mfma_f32_32x32x16_bf16 v[64:79], v[176:179], v[184:187], v[64:79]
  ds_read_b128 v[128:131], v12 offset:0
  ds_read_b128 v[136:139], v20 offset:0
  ds_read_b128 v[132:135], v12 offset:4096
  ds_read_b128 v[140:143], v20 offset:8192
  v_mfma_f32_32x32x16_bf16 v[80:95], v[180:183], v[184:187], v[80:95]
  ds_read_b128 v[144:147], v13 offset:0
  ds_read_b128 v[152:155], v21 offset:0
  v_mfma_f32_32x32x16_bf16 v[96:111], v[176:179], v[188:191], v[96:111]
  ds_read_b128 v[148:151], v13 offset:4096
  ds_read_b128 v[156:159], v21 offset:8192
  v_mfma_f32_32x32x16_bf16 v[112:127], v[180:183], v[188:191], v[112:127]
  ds_read_b128 v[160:163], v14 offset:0
  ds_read_b128 v[168:171], v22 offset:0
  s_waitcnt lgkmcnt(8)
  v_mfma_f32_32x32x16_bf16 v[64:79], v[128:131], v[136:139], v[64:79]
  ds_read_b128 v[164:167], v14 offset:4096
  s_waitcnt lgkmcnt(8)
  v_mfma_f32_32x32x16_bf16 v[80:95], v[132:135], v[136:139], v[80:95]
  ds_read_b128 v[172:175], v22 offset:8192
  s_waitcnt lgkmcnt(8)
  v_mfma_f32_32x32x16_bf16 v[96:111], v[128:131], v[140:143], v[96:111]
  ds_read_b128 v[176:179], v15 offset:0
  v_mfma_f32_32x32x16_bf16 v[112:127], v[132:135], v[140:143], v[112:127]
  ds_read_b128 v[184:187], v23 offset:0
  s_waitcnt lgkmcnt(8)
  v_mfma_f32_32x32x16_bf16 v[64:79], v[144:147], v[152:155], v[64:79]
  ds_read_b128 v[180:183], v15 offset:4096
  s_waitcnt lgkmcnt(8)
  v_mfma_f32_32x32x16_bf16 v[80:95], v[148:151], v[152:155], v[80:95]
  ds_read_b128 v[188:191], v23 offset:8192
  s_waitcnt lgkmcnt(8)
  v_mfma_f32_32x32x16_bf16 v[96:111], v[144:147], v[156:159], v[96:111]
  v_mfma_f32_32x32x16_bf16 v[112:127], v[148:151], v[156:159], v[112:127]
  s_waitcnt lgkmcnt(6)
  v_mfma_f32_32x32x16_bf16 v[64:79], v[160:163], v[168:171], v[64:79]
  s_waitcnt lgkmcnt(5)
  v_mfma_f32_32x32x16_bf16 v[80:95], v[164:167], v[168:171], v[80:95]
  s_waitcnt lgkmcnt(4)
  v_mfma_f32_32x32x16_bf16 v[96:111], v[160:163], v[172:175], v[96:111]
  v_mfma_f32_32x32x16_bf16 v[112:127], v[164:167], v[172:175], v[112:127]
  s_waitcnt lgkmcnt(0)
  s_barrier
  v_mfma_f32_32x32x16_bf16 v[64:79], v[176:179], v[184:187], v[64:79]
  ds_read_b128 v[128:131], v8 offset:0
  ds_read_b128 v[136:139], v16 offset:0
  ds_read_b128 v[132:135], v8 offset:4096
  ds_read_b128 v[140:143], v16 offset:8192
  v_mfma_f32_32x32x16_bf16 v[80:95], v[180:183], v[184:187], v[80:95]
  ds_read_b128 v[144:147], v9 offset:0
  ds_read_b128 v[152:155], v17 offset:0
  v_mfma_f32_32x32x16_bf16 v[96:111], v[176:179], v[188:191], v[96:111]
  ds_read_b128 v[148:151], v9 offset:4096
  ds_read_b128 v[156:159], v17 offset:8192
  v_mfma_f32_32x32x16_bf16 v[112:127], v[180:183], v[188:191], v[112:127]
  ds_read_b128 v[160:163], v10 offset:0
  ds_read_b128 v[168:171], v18 offset:0
  s_waitcnt lgkmcnt(8)
  v_mfma_f32_32x32x16_bf16 v[64:79], v[128:131], v[136:139], v[64:79]
  ds_read_b128 v[164:167], v10 offset:4096
  s_waitcnt lgkmcnt(8)
  v_mfma_f32_32x32x16_bf16 v[80:95], v[132:135], v[136:139], v[80:95]
  ds_read_b128 v[172:175], v18 offset:8192
  s_waitcnt lgkmcnt(8)
  v_mfma_f32_32x32x16_bf16 v[96:111], v[128:131], v[140:143], v[96:111]
  ds_read_b128 v[176:179], v11 offset:0
  v_mfma_f32_32x32x16_bf16 v[112:127], v[132:135], v[140:143], v[112:127]
  ds_read_b128 v[184:187], v19 offset:0
  s_waitcnt lgkmcnt(8)
  v_mfma_f32_32x32x16_bf16 v[64:79], v[144:147], v[152:155], v[64:79]
  ds_read_b128 v[180:183], v11 offset:4096
  s_waitcnt lgkmcnt(8)
  v_mfma_f32_32x32x16_bf16 v[80:95], v[148:151], v[152:155], v[80:95]
  ds_read_b128 v[188:191], v19 offset:8192
  s_waitcnt lgkmcnt(8)
  v_mfma_f32_32x32x16_bf16 v[96:111], v[144:147], v[156:159], v[96:111]
  v_mfma_f32_32x32x16_bf16 v[112:127], v[148:151], v[156:159], v[112:127]
  s_waitcnt lgkmcnt(6)
  v_mfma_f32_32x32x16_bf16 v[64:79], v[160:163], v[168:171], v[64:79]
  s_waitcnt lgkmcnt(5)
  v_mfma_f32_32x32x16_bf16 v[80:95], v[164:167], v[168:171], v[80:95]
  s_waitcnt lgkmcnt(4)
  v_mfma_f32_32x32x16_bf16 v[96:111], v[160:163], v[172:175], v[96:111]
  v_mfma_f32_32x32x16_bf16 v[112:127], v[164:167], v[172:175], v[112:127]
  s_waitcnt lgkmcnt(0)
  s_barrier
  v_mfma_f32_32x32x16_bf16 v[64:79], v[176:179], v[184:187], v[64:79]
  ds_read_b128 v[128:131], v8 offset:32768
  ds_read_b128 v[136:139], v16 offset:32768
  ds_read_b128 v[132:135], v8 offset:36864
  ds_read_b128 v[140:143], v16 offset:40960
  v_mfma_f32_32x32x16_bf16 v[80:95], v[180:183], v[184:187], v[80:95]
  ds_read_b128 v[144:147], v9 offset:32768
  ds_read_b128 v[152:155], v17 offset:32768
  v_mfma_f32_32x32x16_bf16 v[96:111], v[176:179], v[188:191], v[96:111]
  ds_read_b128 v[148:151], v9 offset:36864
  ds_read_b128 v[156:159], v17 offset:40960
  v_mfma_f32_32x32x16_bf16 v[112:127], v[180:183], v[188:191], v[112:127]
  ds_read_b128 v[160:163], v10 offset:32768
  ds_read_b128 v[168:171], v18 offset:32768
  s_waitcnt lgkmcnt(8)
  v_mfma_f32_32x32x16_bf16 v[64:79], v[128:131], v[136:139], v[64:79]
  ds_read_b128 v[164:167], v10 offset:36864
  s_waitcnt lgkmcnt(8)
  v_mfma_f32_32x32x16_bf16 v[80:95], v[132:135], v[136:139], v[80:95]
  ds_read_b128 v[172:175], v18 offset:40960
  s_waitcnt lgkmcnt(8)
  v_mfma_f32_32x32x16_bf16 v[96:111], v[128:131], v[140:143], v[96:111]
  ds_read_b128 v[176:179], v11 offset:32768
  v_mfma_f32_32x32x16_bf16 v[112:127], v[132:135], v[140:143], v[112:127]
  ds_read_b128 v[184:187], v19 offset:32768
  s_waitcnt lgkmcnt(8)
  v_mfma_f32_32x32x16_bf16 v[64:79], v[144:147], v[152:155], v[64:79]
  ds_read_b128 v[180:183], v11 offset:36864
  s_waitcnt lgkmcnt(8)
  v_mfma_f32_32x32x16_bf16 v[80:95], v[148:151], v[152:155], v[80:95]
  ds_read_b128 v[188:191], v19 offset:40960
  s_waitcnt lgkmcnt(8)
  v_mfma_f32_32x32x16_bf16 v[96:111], v[144:147], v[156:159], v[96:111]
  v_mfma_f32_32x32x16_bf16 v[112:127], v[148:151], v[156:159], v[112:127]
  s_waitcnt lgkmcnt(6)
  v_mfma_f32_32x32x16_bf16 v[64:79], v[160:163], v[168:171], v[64:79]
  s_waitcnt lgkmcnt(5)
  v_mfma_f32_32x32x16_bf16 v[80:95], v[164:167], v[168:171], v[80:95]
  s_waitcnt lgkmcnt(4)
  v_mfma_f32_32x32x16_bf16 v[96:111], v[160:163], v[172:175], v[96:111]
  v_mfma_f32_32x32x16_bf16 v[112:127], v[164:167], v[172:175], v[112:127]
  s_waitcnt lgkmcnt(0)
  s_barrier
  v_mfma_f32_32x32x16_bf16 v[64:79], v[176:179], v[184:187], v[64:79]
  ds_read_b128 v[128:131], v12 offset:0
  ds_read_b128 v[136:139], v20 offset:0
  ds_read_b128 v[132:135], v12 offset:4096
  ds_read_b128 v[140:143], v20 offset:8192
  v_mfma_f32_32x32x16_bf16 v[80:95], v[180:183], v[184:187], v[80:95]
  ds_read_b128 v[144:147], v13 offset:0
  ds_read_b128 v[152:155], v21 offset:0
  v_mfma_f32_32x32x16_bf16 v[96:111], v[176:179], v[188:191], v[96:111]
  ds_read_b128 v[148:151], v13 offset:4096
  ds_read_b128 v[156:159], v21 offset:8192
  v_mfma_f32_32x32x16_bf16 v[112:127], v[180:183], v[188:191], v[112:127]
  ds_read_b128 v[160:163], v14 offset:0
  ds_read_b128 v[168:171], v22 offset:0
  s_waitcnt lgkmcnt(8)
  v_mfma_f32_32x32x16_bf16 v[64:79], v[128:131], v[136:139], v[64:79]
  ds_read_b128 v[164:167], v14 offset:4096
  s_waitcnt lgkmcnt(8)
  v_mfma_f32_32x32x16_bf16 v[80:95], v[132:135], v[136:139], v[80:95]
  ds_read_b128 v[172:175], v22 offset:8192
  s_waitcnt lgkmcnt(8)
  v_mfma_f32_32x32x16_bf16 v[96:111], v[128:131], v[140:143], v[96:111]
  ds_read_b128 v[176:179], v15 offset:0
  v_mfma_f32_32x32x16_bf16 v[112:127], v[132:135], v[140:143], v[112:127]
  ds_read_b128 v[184:187], v23 offset:0
  s_waitcnt lgkmcnt(8)
  v_mfma_f32_32x32x16_bf16 v[64:79], v[144:147], v[152:155], v[64:79]
  ds_read_b128 v[180:183], v15 offset:4096
  s_waitcnt lgkmcnt(8)
  v_mfma_f32_32x32x16_bf16 v[80:95], v[148:151], v[152:155], v[80:95]
  ds_read_b128 v[188:191], v23 offset:8192
  s_waitcnt lgkmcnt(8)
  v_mfma_f32_32x32x16_bf16 v[96:111], v[144:147], v[156:159], v[96:111]
  v_mfma_f32_32x32x16_bf16 v[112:127], v[148:151], v[156:159], v[112:127]
  s_waitcnt lgkmcnt(6)
  v_mfma_f32_32x32x16_bf16 v[64:79], v[160:163], v[168:171], v[64:79]
  s_waitcnt lgkmcnt(5)
  v_mfma_f32_32x32x16_bf16 v[80:95], v[164:167], v[168:171], v[80:95]
  s_waitcnt lgkmcnt(4)
  v_mfma_f32_32x32x16_bf16 v[96:111], v[160:163], v[172:175], v[96:111]
  v_mfma_f32_32x32x16_bf16 v[112:127], v[164:167], v[172:175], v[112:127]
  s_waitcnt lgkmcnt(0)
  s_barrier
  v_mfma_f32_32x32x16_bf16 v[64:79], v[176:179], v[184:187], v[64:79]
  ds_read_b128 v[128:131], v8 offset:0
  ds_read_b128 v[136:139], v16 offset:0
  ds_read_b128 v[132:135], v8 offset:4096
  ds_read_b128 v[140:143], v16 offset:8192
  v_mfma_f32_32x32x16_bf16 v[80:95], v[180:183], v[184:187], v[80:95]
  ds_read_b128 v[144:147], v9 offset:0
  ds_read_b128 v[152:155], v17 offset:0
  v_mfma_f32_32x32x16_bf16 v[96:111], v[176:179], v[188:191], v[96:111]
  ds_read_b128 v[148:151], v9 offset:4096
  ds_read_b128 v[156:159], v17 offset:8192
  v_mfma_f32_32x32x16_bf16 v[112:127], v[180:183], v[188:191], v[112:127]
  ds_read_b128 v[160:163], v10 offset:0
  ds_read_b128 v[168:171], v18 offset:0
  s_waitcnt lgkmcnt(8)
  v_mfma_f32_32x32x16_bf16 v[64:79], v[128:131], v[136:139], v[64:79]
  ds_read_b128 v[164:167], v10 offset:4096
  s_waitcnt lgkmcnt(8)
  v_mfma_f32_32x32x16_bf16 v[80:95], v[132:135], v[136:139], v[80:95]
  ds_read_b128 v[172:175], v18 offset:8192
  s_waitcnt lgkmcnt(8)
  v_mfma_f32_32x32x16_bf16 v[96:111], v[128:131], v[140:143], v[96:111]
  ds_read_b128 v[176:179], v11 offset:0
  v_mfma_f32_32x32x16_bf16 v[112:127], v[132:135], v[140:143], v[112:127]
  ds_read_b128 v[184:187], v19 offset:0
  s_waitcnt lgkmcnt(8)
  v_mfma_f32_32x32x16_bf16 v[64:79], v[144:147], v[152:155], v[64:79]
  ds_read_b128 v[180:183], v11 offset:4096
  s_waitcnt lgkmcnt(8)
  v_mfma_f32_32x32x16_bf16 v[80:95], v[148:151], v[152:155], v[80:95]
  ds_read_b128 v[188:191], v19 offset:8192
  s_waitcnt lgkmcnt(8)
  v_mfma_f32_32x32x16_bf16 v[96:111], v[144:147], v[156:159], v[96:111]
  v_mfma_f32_32x32x16_bf16 v[112:127], v[148:151], v[156:159], v[112:127]
  s_waitcnt lgkmcnt(6)
  v_mfma_f32_32x32x16_bf16 v[64:79], v[160:163], v[168:171], v[64:79]
  s_waitcnt lgkmcnt(5)
  v_mfma_f32_32x32x16_bf16 v[80:95], v[164:167], v[168:171], v[80:95]
  s_waitcnt lgkmcnt(4)
  v_mfma_f32_32x32x16_bf16 v[96:111], v[160:163], v[172:175], v[96:111]
  v_mfma_f32_32x32x16_bf16 v[112:127], v[164:167], v[172:175], v[112:127]
  s_waitcnt lgkmcnt(0)
  s_barrier
  v_mfma_f32_32x32x16_bf16 v[64:79], v[176:179], v[184:187], v[64:79]
  ds_read_b128 v[128:131], v8 offset:32768
  ds_read_b128 v[136:139], v16 offset:32768
  ds_read_b128 v[132:135], v8 offset:36864
  ds_read_b128 v[140:143], v16 offset:40960
  v_mfma_f32_32x32x16_bf16 v[80:95], v[180:183], v[184:187], v[80:95]
  ds_read_b128 v[144:147], v9 offset:32768
  ds_read_b128 v[152:155], v17 offset:32768
  v_mfma_f32_32x32x16_bf16 v[96:111], v[176:179], v[188:191], v[96:111]
  ds_read_b128 v[148:151], v9 offset:36864
  ds_read_b128 v[156:159], v17 offset:40960
  v_mfma_f32_32x32x16_bf16 v[112:127], v[180:183], v[188:191], v[112:127]
  ds_read_b128 v[160:163], v10 offset:32768
  ds_read_b128 v[168:171], v18 offset:32768
  s_waitcnt lgkmcnt(8)
  v_mfma_f32_32x32x16_bf16 v[64:79], v[128:131], v[136:139], v[64:79]
  ds_read_b128 v[164:167], v10 offset:36864
  s_waitcnt lgkmcnt(8)
  v_mfma_f32_32x32x16_bf16 v[80:95], v[132:135], v[136:139], v[80:95]
  ds_read_b128 v[172:175], v18 offset:40960
  s_waitcnt lgkmcnt(8)
  v_mfma_f32_32x32x16_bf16 v[96:111], v[128:131], v[140:143], v[96:111]
  ds_read_b128 v[176:179], v11 offset:32768
  v_mfma_f32_32x32x16_bf16 v[112:127], v[132:135], v[140:143], v[112:127]
  ds_read_b128 v[184:187], v19 offset:32768
  s_waitcnt lgkmcnt(8)
  v_mfma_f32_32x32x16_bf16 v[64:79], v[144:147], v[152:155], v[64:79]
  ds_read_b128 v[180:183], v11 offset:36864
  s_waitcnt lgkmcnt(8)
  v_mfma_f32_32x32x16_bf16 v[80:95], v[148:151], v[152:155], v[80:95]
  ds_read_b128 v[188:191], v19 offset:40960
  s_waitcnt lgkmcnt(8)
  v_mfma_f32_32x32x16_bf16 v[96:111], v[144:147], v[156:159], v[96:111]
  v_mfma_f32_32x32x16_bf16 v[112:127], v[148:151], v[156:159], v[112:127]
  s_waitcnt lgkmcnt(6)
  v_mfma_f32_32x32x16_bf16 v[64:79], v[160:163], v[168:171], v[64:79]
  s_waitcnt lgkmcnt(5)
  v_mfma_f32_32x32x16_bf16 v[80:95], v[164:167], v[168:171], v[80:95]
  s_waitcnt lgkmcnt(4)
  v_mfma_f32_32x32x16_bf16 v[96:111], v[160:163], v[172:175], v[96:111]
  v_mfma_f32_32x32x16_bf16 v[112:127], v[164:167], v[172:175], v[112:127]
  s_waitcnt lgkmcnt(0)
  s_barrier
  v_mfma_f32_32x32x16_bf16 v[64:79], v[176:179], v[184:187], v[64:79]
  ds_read_b128 v[128:131], v12 offset:0
  ds_read_b128 v[136:139], v20 offset:0
  ds_read_b128 v[132:135], v12 offset:4096
  ds_read_b128 v[140:143], v20 offset:8192
  v_mfma_f32_32x32x16_bf16 v[80:95], v[180:183], v[184:187], v[80:95]
  ds_read_b128 v[144:147], v13 offset:0
  ds_read_b128 v[152:155], v21 offset:0
  v_mfma_f32_32x32x16_bf16 v[96:111], v[176:179], v[188:191], v[96:111]
  ds_read_b128 v[148:151], v13 offset:4096
  ds_read_b128 v[156:159], v21 offset:8192
  v_mfma_f32_32x32x16_bf16 v[112:127], v[180:183], v[188:191], v[112:127]
  ds_read_b128 v[160:163], v14 offset:0
  ds_read_b128 v[168:171], v22 offset:0
  s_waitcnt lgkmcnt(8)
  v_mfma_f32_32x32x16_bf16 v[64:79], v[128:131], v[136:139], v[64:79]
  ds_read_b128 v[164:167], v14 offset:4096
  s_waitcnt lgkmcnt(8)
  v_mfma_f32_32x32x16_bf16 v[80:95], v[132:135], v[136:139], v[80:95]
  ds_read_b128 v[172:175], v22 offset:8192
  s_waitcnt lgkmcnt(8)
  v_mfma_f32_32x32x16_bf16 v[96:111], v[128:131], v[140:143], v[96:111]
  ds_read_b128 v[176:179], v15 offset:0
  v_mfma_f32_32x32x16_bf16 v[112:127], v[132:135], v[140:143], v[112:127]
  ds_read_b128 v[184:187], v23 offset:0
  s_waitcnt lgkmcnt(8)
  v_mfma_f32_32x32x16_bf16 v[64:79], v[144:147], v[152:155], v[64:79]
  ds_read_b128 v[180:183], v15 offset:4096
  s_waitcnt lgkmcnt(8)
  v_mfma_f32_32x32x16_bf16 v[80:95], v[148:151], v[152:155], v[80:95]
  ds_read_b128 v[188:191], v23 offset:8192
  s_waitcnt lgkmcnt(8)
  v_mfma_f32_32x32x16_bf16 v[96:111], v[144:147], v[156:159], v[96:111]
  v_mfma_f32_32x32x16_bf16 v[112:127], v[148:151], v[156:159], v[112:127]
  s_waitcnt lgkmcnt(6)
  v_mfma_f32_32x32x16_bf16 v[64:79], v[160:163], v[168:171], v[64:79]
  s_waitcnt lgkmcnt(5)
  v_mfma_f32_32x32x16_bf16 v[80:95], v[164:167], v[168:171], v[80:95]
  s_waitcnt lgkmcnt(4)
  v_mfma_f32_32x32x16_bf16 v[96:111], v[160:163], v[172:175], v[96:111]
  v_mfma_f32_32x32x16_bf16 v[112:127], v[164:167], v[172:175], v[112:127]
  s_waitcnt lgkmcnt(0)
  s_barrier
  v_mfma_f32_32x32x16_bf16 v[64:79], v[176:179], v[184:187], v[64:79]
  ds_read_b128 v[128:131], v8 offset:0
  ds_read_b128 v[136:139], v16 offset:0
  ds_read_b128 v[132:135], v8 offset:4096
  ds_read_b128 v[140:143], v16 offset:8192
  v_mfma_f32_32x32x16_bf16 v[80:95], v[180:183], v[184:187], v[80:95]
  ds_read_b128 v[144:147], v9 offset:0
  ds_read_b128 v[152:155], v17 offset:0
  v_mfma_f32_32x32x16_bf16 v[96:111], v[176:179], v[188:191], v[96:111]
  ds_read_b128 v[148:151], v9 offset:4096
  ds_read_b128 v[156:159], v17 offset:8192
  v_mfma_f32_32x32x16_bf16 v[112:127], v[180:183], v[188:191], v[112:127]
  ds_read_b128 v[160:163], v10 offset:0
  ds_read_b128 v[168:171], v18 offset:0
  s_waitcnt lgkmcnt(8)
  v_mfma_f32_32x32x16_bf16 v[64:79], v[128:131], v[136:139], v[64:79]
  ds_read_b128 v[164:167], v10 offset:4096
  s_waitcnt lgkmcnt(8)
  v_mfma_f32_32x32x16_bf16 v[80:95], v[132:135], v[136:139], v[80:95]
  ds_read_b128 v[172:175], v18 offset:8192
  s_waitcnt lgkmcnt(8)
  v_mfma_f32_32x32x16_bf16 v[96:111], v[128:131], v[140:143], v[96:111]
  ds_read_b128 v[176:179], v11 offset:0
  v_mfma_f32_32x32x16_bf16 v[112:127], v[132:135], v[140:143], v[112:127]
  ds_read_b128 v[184:187], v19 offset:0
  s_waitcnt lgkmcnt(8)
  v_mfma_f32_32x32x16_bf16 v[64:79], v[144:147], v[152:155], v[64:79]
  ds_read_b128 v[180:183], v11 offset:4096
  s_waitcnt lgkmcnt(8)
  v_mfma_f32_32x32x16_bf16 v[80:95], v[148:151], v[152:155], v[80:95]
  ds_read_b128 v[188:191], v19 offset:8192
  s_waitcnt lgkmcnt(8)
  v_mfma_f32_32x32x16_bf16 v[96:111], v[144:147], v[156:159], v[96:111]
  v_mfma_f32_32x32x16_bf16 v[112:127], v[148:151], v[156:159], v[112:127]
  s_waitcnt lgkmcnt(6)
  v_mfma_f32_32x32x16_bf16 v[64:79], v[160:163], v[168:171], v[64:79]
  s_waitcnt lgkmcnt(5)
  v_mfma_f32_32x32x16_bf16 v[80:95], v[164:167], v[168:171], v[80:95]
  s_waitcnt lgkmcnt(4)
  v_mfma_f32_32x32x16_bf16 v[96:111], v[160:163], v[172:175], v[96:111]
  v_mfma_f32_32x32x16_bf16 v[112:127], v[164:167], v[172:175], v[112:127]
  s_waitcnt lgkmcnt(2)
  v_mfma_f32_32x32x16_bf16 v[64:79], v[176:179], v[184:187], v[64:79]
  s_waitcnt lgkmcnt(1)
  v_mfma_f32_32x32x16_bf16 v[80:95], v[180:183], v[184:187], v[80:95]
  s_waitcnt lgkmcnt(0)
  v_mfma_f32_32x32x16_bf16 v[96:111], v[176:179], v[188:191], v[96:111]
  v_mfma_f32_32x32x16_bf16 v[112:127], v[180:183], v[188:191], v[112:127]
  s_nop 6
  v_pk_fma_f32 v[198:199], v[64:65], v[48:49], v[66:67] op_sel_hi:[1,0,1]
  s_nop 2
  s_nop 0
  v_pk_fma_f32 v[200:201], v[96:97], v[48:49], v[98:99] op_sel_hi:[1,0,1]
  v_pk_fma_f32 v[198:199], v[96:97], v[48:49], v[198:199] op_sel:[0,1,0] neg_lo:[0,1,0] neg_hi:[0,1,0]
  v_pk_fma_f32 v[200:201], v[64:65], v[48:49], v[200:201] op_sel:[0,1,0]
  v_pk_fma_f32 v[194:195], v[198:199], v[48:49], v[68:69] op_sel_hi:[1,0,1]
  v_pk_fma_f32 v[196:197], v[200:201], v[48:49], v[100:101] op_sel_hi:[1,0,1]
  v_pk_fma_f32 v[194:195], v[200:201], v[48:49], v[194:195] op_sel:[0,1,0] neg_lo:[0,1,0] neg_hi:[0,1,0]
  v_pk_fma_f32 v[196:197], v[198:199], v[48:49], v[196:197] op_sel:[0,1,0]
  v_pk_fma_f32 v[198:199], v[194:195], v[48:49], v[70:71] op_sel_hi:[1,0,1]
  v_pk_fma_f32 v[200:201], v[196:197], v[48:49], v[102:103] op_sel_hi:[1,0,1]
  v_pk_fma_f32 v[198:199], v[196:197], v[48:49], v[198:199] op_sel:[0,1,0] neg_lo:[0,1,0] neg_hi:[0,1,0]
  v_pk_fma_f32 v[200:201], v[194:195], v[48:49], v[200:201] op_sel:[0,1,0]
  v_pk_fma_f32 v[194:195], v[198:199], v[48:49], v[72:73] op_sel_hi:[1,0,1]
  v_pk_fma_f32 v[196:197], v[200:201], v[48:49], v[104:105] op_sel_hi:[1,0,1]
  v_pk_fma_f32 v[194:195], v[200:201], v[48:49], v[194:195] op_sel:[0,1,0] neg_lo:[0,1,0] neg_hi:[0,1,0]
  v_pk_fma_f32 v[196:197], v[198:199], v[48:49], v[196:197] op_sel:[0,1,0]
  v_pk_fma_f32 v[198:199], v[194:195], v[48:49], v[74:75] op_sel_hi:[1,0,1]
  v_pk_fma_f32 v[200:201], v[196:197], v[48:49], v[106:107] op_sel_hi:[1,0,1]
  v_pk_fma_f32 v[198:199], v[196:197], v[48:49], v[198:199] op_sel:[0,1,0] neg_lo:[0,1,0] neg_hi:[0,1,0]
  v_pk_fma_f32 v[200:201], v[194:195], v[48:49], v[200:201] op_sel:[0,1,0]
  v_pk_fma_f32 v[194:195], v[198:199], v[48:49], v[76:77] op_sel_hi:[1,0,1]
  v_pk_fma_f32 v[196:197], v[200:201], v[48:49], v[108:109] op_sel_hi:[1,0,1]
  v_pk_fma_f32 v[194:195], v[200:201], v[48:49], v[194:195] op_sel:[0,1,0] neg_lo:[0,1,0] neg_hi:[0,1,0]
  v_pk_fma_f32 v[196:197], v[198:199], v[48:49], v[196:197] op_sel:[0,1,0]
  v_pk_fma_f32 v[198:199], v[194:195], v[48:49], v[78:79] op_sel_hi:[1,0,1]
  v_pk_fma_f32 v[200:201], v[196:197], v[48:49], v[110:111] op_sel_hi:[1,0,1]
  v_pk_fma_f32 v[198:199], v[196:197], v[48:49], v[198:199] op_sel:[0,1,0] neg_lo:[0,1,0] neg_hi:[0,1,0]
  v_pk_fma_f32 v[200:201], v[194:195], v[48:49], v[200:201] op_sel:[0,1,0]
  v_pk_fma_f32 v[194:195], v[198:199], v[48:49], v[80:81] op_sel_hi:[1,0,1]
  v_pk_fma_f32 v[196:197], v[200:201], v[48:49], v[112:113] op_sel_hi:[1,0,1]
  v_pk_fma_f32 v[194:195], v[200:201], v[48:49], v[194:195] op_sel:[0,1,0] neg_lo:[0,1,0] neg_hi:[0,1,0]
  v_pk_fma_f32 v[196:197], v[198:199], v[48:49], v[196:197] op_sel:[0,1,0]
  v_pk_fma_f32 v[198:199], v[194:195], v[48:49], v[82:83] op_sel_hi:[1,0,1]
  v_pk_fma_f32 v[200:201], v[196:197], v[48:49], v[114:115] op_sel_hi:[1,0,1]
  v_pk_fma_f32 v[198:199], v[196:197], v[48:49], v[198:199] op_sel:[0,1,0] neg_lo:[0,1,0] neg_hi:[0,1,0]
  v_pk_fma_f32 v[200:201], v[194:195], v[48:49], v[200:201] op_sel:[0,1,0]
  v_pk_fma_f32 v[194:195], v[198:199], v[48:49], v[84:85] op_sel_hi:[1,0,1]
  v_pk_fma_f32 v[196:197], v[200:201], v[48:49], v[116:117] op_sel_hi:[1,0,1]
  v_pk_fma_f32 v[194:195], v[200:201], v[48:49], v[194:195] op_sel:[0,1,0] neg_lo:[0,1,0] neg_hi:[0,1,0]
  v_pk_fma_f32 v[196:197], v[198:199], v[48:49], v[196:197] op_sel:[0,1,0]
  v_pk_fma_f32 v[198:199], v[194:195], v[48:49], v[86:87] op_sel_hi:[1,0,1]
  v_pk_fma_f32 v[200:201], v[196:197], v[48:49], v[118:119] op_sel_hi:[1,0,1]
  v_pk_fma_f32 v[198:199], v[196:197], v[48:49], v[198:199] op_sel:[0,1,0] neg_lo:[0,1,0] neg_hi:[0,1,0]
  v_pk_fma_f32 v[200:201], v[194:195], v[48:49], v[200:201] op_sel:[0,1,0]
  v_pk_fma_f32 v[194:195], v[198:199], v[48:49], v[88:89] op_sel_hi:[1,0,1]
  v_pk_fma_f32 v[196:197], v[200:201], v[48:49], v[120:121] op_sel_hi:[1,0,1]
  v_pk_fma_f32 v[194:195], v[200:201], v[48:49], v[194:195] op_sel:[0,1,0] neg_lo:[0,1,0] neg_hi:[0,1,0]
  v_pk_fma_f32 v[196:197], v[198:199], v[48:49], v[196:197] op_sel:[0,1,0]
  v_pk_fma_f32 v[198:199], v[194:195], v[48:49], v[90:91] op_sel_hi:[1,0,1]
  v_pk_fma_f32 v[200:201], v[196:197], v[48:49], v[122:123] op_sel_hi:[1,0,1]
  v_pk_fma_f32 v[198:199], v[196:197], v[48:49], v[198:199] op_sel:[0,1,0] neg_lo:[0,1,0] neg_hi:[0,1,0]
  v_pk_fma_f32 v[200:201], v[194:195], v[48:49], v[200:201] op_sel:[0,1,0]
  v_pk_fma_f32 v[194:195], v[198:199], v[48:49], v[92:93] op_sel_hi:[1,0,1]
  v_pk_fma_f32 v[196:197], v[200:201], v[48:49], v[124:125] op_sel_hi:[1,0,1]
  v_pk_fma_f32 v[194:195], v[200:201], v[48:49], v[194:195] op_sel:[0,1,0] neg_lo:[0,1,0] neg_hi:[0,1,0]
  v_pk_fma_f32 v[196:197], v[198:199], v[48:49], v[196:197] op_sel:[0,1,0]
  v_pk_fma_f32 v[198:199], v[194:195], v[48:49], v[94:95] op_sel_hi:[1,0,1]
  v_pk_fma_f32 v[200:201], v[196:197], v[48:49], v[126:127] op_sel_hi:[1,0,1]
  v_pk_fma_f32 v[198:199], v[196:197], v[48:49], v[198:199] op_sel:[0,1,0] neg_lo:[0,1,0] neg_hi:[0,1,0]
  v_pk_fma_f32 v[200:201], v[194:195], v[48:49], v[200:201] op_sel:[0,1,0]
  v_fma_f32 v204, v198, v50, v199
  v_fma_f32 v205, v200, v50, v201
  v_fma_f32 v204, -v200, v51, v204
  v_fma_f32 v205, v198, v51, v205
  v_mov_b32 v206, v204
  v_mov_b32_e64 v207, v205
  s_nop 0
  v_permlane32_swap_b32 v204, v206
  v_permlane32_swap_b32 v205, v207
  v_pk_fma_f32 v[208:209], v[204:205], v[52:53], v[206:207] op_sel_hi:[1,0,1]
  v_pk_fma_f32 v[208:209], v[204:205], v[52:53], v[208:209] op_sel:[1,1,0] op_sel_hi:[0,1,1] neg_lo:[1,0,0]
  v_min_u32 v208, -2, v208
  v_min_u32_e64 v209, -2, v209
  s_mov_b32 exec_hi, 0
  buffer_store_dwordx2 v[208:209], v24, s[84:87], 0 offen sc1
  s_mov_b32 exec_hi, -1
  ds_write_b64 v44, v[208:209] offset:32768
  s_waitcnt lgkmcnt(0)
  s_barrier
  v_mov_b32 v202, v198
  v_mov_b32 v203, v200
  v_cmp_gt_u32_e64 vcc, 32, v1
  s_nop 1
  v_cndmask_b32 v204, v204, 0, vcc
  v_cndmask_b32 v205, v205, 0, vcc
  v_pk_fma_f32 v[202:203], v[204:205], v[50:51], v[202:203] op_sel_hi:[1,0,1]
  v_pk_fma_f32 v[202:203], v[204:205], v[50:51], v[202:203] op_sel:[1,1,0] op_sel_hi:[0,1,1] neg_lo:[1,0,0]
  v_pk_mul_f32 v[206:207], v[204:205], v[58:59] op_sel_hi:[1,0]
  v_pk_fma_f32 v[206:207], v[204:205], v[58:59], v[206:207] op_sel:[1,1,0] op_sel_hi:[0,1,1] neg_lo:[1,0,0]
  v_pk_mul_f32 v[208:209], v[202:203], v[58:59] op_sel_hi:[1,0]
  v_pk_fma_f32 v[208:209], v[202:203], v[58:59], v[208:209] op_sel:[1,1,0] op_sel_hi:[0,1,1] neg_lo:[1,0,0]
  v_mov_b32 v210, v206
  v_mov_b32 v211, v208
  v_mov_b32 v212, v207
  v_mov_b32 v213, v209
  v_pk_mul_f32 v[128:129], v[64:65], v[58:59] op_sel_hi:[1,0]
  v_pk_mul_f32 v[160:161], v[96:97], v[58:59] op_sel_hi:[1,0]
  v_pk_fma_f32 v[128:129], v[96:97], v[58:59], v[128:129] op_sel:[0,1,0] neg_lo:[0,1,0] neg_hi:[0,1,0]
  v_pk_fma_f32 v[160:161], v[64:65], v[58:59], v[160:161] op_sel:[0,1,0]
  v_pk_mul_f32 v[130:131], v[66:67], v[58:59] op_sel_hi:[1,0]
  v_pk_mul_f32 v[162:163], v[98:99], v[58:59] op_sel_hi:[1,0]
  v_pk_fma_f32 v[130:131], v[98:99], v[58:59], v[130:131] op_sel:[0,1,0] neg_lo:[0,1,0] neg_hi:[0,1,0]
  v_pk_fma_f32 v[162:163], v[66:67], v[58:59], v[162:163] op_sel:[0,1,0]
  v_pk_mul_f32 v[132:133], v[68:69], v[58:59] op_sel_hi:[1,0]
  v_pk_mul_f32 v[164:165], v[100:101], v[58:59] op_sel_hi:[1,0]
  v_pk_fma_f32 v[132:133], v[100:101], v[58:59], v[132:133] op_sel:[0,1,0] neg_lo:[0,1,0] neg_hi:[0,1,0]
  v_pk_fma_f32 v[164:165], v[68:69], v[58:59], v[164:165] op_sel:[0,1,0]
  v_pk_mul_f32 v[134:135], v[70:71], v[58:59] op_sel_hi:[1,0]
  v_pk_mul_f32 v[166:167], v[102:103], v[58:59] op_sel_hi:[1,0]
  v_pk_fma_f32 v[134:135], v[102:103], v[58:59], v[134:135] op_sel:[0,1,0] neg_lo:[0,1,0] neg_hi:[0,1,0]
  v_pk_fma_f32 v[166:167], v[70:71], v[58:59], v[166:167] op_sel:[0,1,0]
  v_pk_mul_f32 v[136:137], v[72:73], v[58:59] op_sel_hi:[1,0]
  v_pk_mul_f32 v[168:169], v[104:105], v[58:59] op_sel_hi:[1,0]
  v_pk_fma_f32 v[136:137], v[104:105], v[58:59], v[136:137] op_sel:[0,1,0] neg_lo:[0,1,0] neg_hi:[0,1,0]
  v_pk_fma_f32 v[168:169], v[72:73], v[58:59], v[168:169] op_sel:[0,1,0]
  v_pk_mul_f32 v[138:139], v[74:75], v[58:59] op_sel_hi:[1,0]
  v_pk_mul_f32 v[170:171], v[106:107], v[58:59] op_sel_hi:[1,0]
  v_pk_fma_f32 v[138:139], v[106:107], v[58:59], v[138:139] op_sel:[0,1,0] neg_lo:[0,1,0] neg_hi:[0,1,0]
  v_pk_fma_f32 v[170:171], v[74:75], v[58:59], v[170:171] op_sel:[0,1,0]
  v_pk_mul_f32 v[140:141], v[76:77], v[58:59] op_sel_hi:[1,0]
  v_pk_mul_f32 v[172:173], v[108:109], v[58:59] op_sel_hi:[1,0]
  v_pk_fma_f32 v[140:141], v[108:109], v[58:59], v[140:141] op_sel:[0,1,0] neg_lo:[0,1,0] neg_hi:[0,1,0]
  v_pk_fma_f32 v[172:173], v[76:77], v[58:59], v[172:173] op_sel:[0,1,0]
  v_pk_mul_f32 v[142:143], v[78:79], v[58:59] op_sel_hi:[1,0]
  v_pk_mul_f32 v[174:175], v[110:111], v[58:59] op_sel_hi:[1,0]
  v_pk_fma_f32 v[142:143], v[110:111], v[58:59], v[142:143] op_sel:[0,1,0] neg_lo:[0,1,0] neg_hi:[0,1,0]
  v_pk_fma_f32 v[174:175], v[78:79], v[58:59], v[174:175] op_sel:[0,1,0]
  v_pk_mul_f32 v[144:145], v[80:81], v[58:59] op_sel_hi:[1,0]
  v_pk_mul_f32 v[176:177], v[112:113], v[58:59] op_sel_hi:[1,0]
  v_pk_fma_f32 v[144:145], v[112:113], v[58:59], v[144:145] op_sel:[0,1,0] neg_lo:[0,1,0] neg_hi:[0,1,0]
  v_pk_fma_f32 v[176:177], v[80:81], v[58:59], v[176:177] op_sel:[0,1,0]
  v_pk_mul_f32 v[146:147], v[82:83], v[58:59] op_sel_hi:[1,0]
  v_pk_mul_f32 v[178:179], v[114:115], v[58:59] op_sel_hi:[1,0]
  v_pk_fma_f32 v[146:147], v[114:115], v[58:59], v[146:147] op_sel:[0,1,0] neg_lo:[0,1,0] neg_hi:[0,1,0]
  v_pk_fma_f32 v[178:179], v[82:83], v[58:59], v[178:179] op_sel:[0,1,0]
  v_pk_mul_f32 v[148:149], v[84:85], v[58:59] op_sel_hi:[1,0]
  v_pk_mul_f32 v[180:181], v[116:117], v[58:59] op_sel_hi:[1,0]
  v_pk_fma_f32 v[148:149], v[116:117], v[58:59], v[148:149] op_sel:[0,1,0] neg_lo:[0,1,0] neg_hi:[0,1,0]
  v_pk_fma_f32 v[180:181], v[84:85], v[58:59], v[180:181] op_sel:[0,1,0]
  v_pk_mul_f32 v[150:151], v[86:87], v[58:59] op_sel_hi:[1,0]
  v_pk_mul_f32 v[182:183], v[118:119], v[58:59] op_sel_hi:[1,0]
  v_pk_fma_f32 v[150:151], v[118:119], v[58:59], v[150:151] op_sel:[0,1,0] neg_lo:[0,1,0] neg_hi:[0,1,0]
  v_pk_fma_f32 v[182:183], v[86:87], v[58:59], v[182:183] op_sel:[0,1,0]
  v_pk_mul_f32 v[152:153], v[88:89], v[58:59] op_sel_hi:[1,0]
  v_pk_mul_f32 v[184:185], v[120:121], v[58:59] op_sel_hi:[1,0]
  v_pk_fma_f32 v[152:153], v[120:121], v[58:59], v[152:153] op_sel:[0,1,0] neg_lo:[0,1,0] neg_hi:[0,1,0]
  v_pk_fma_f32 v[184:185], v[88:89], v[58:59], v[184:185] op_sel:[0,1,0]
  v_pk_mul_f32 v[154:155], v[90:91], v[58:59] op_sel_hi:[1,0]
  v_pk_mul_f32 v[186:187], v[122:123], v[58:59] op_sel_hi:[1,0]
  v_pk_fma_f32 v[154:155], v[122:123], v[58:59], v[154:155] op_sel:[0,1,0] neg_lo:[0,1,0] neg_hi:[0,1,0]
  v_pk_fma_f32 v[186:187], v[90:91], v[58:59], v[186:187] op_sel:[0,1,0]
  v_pk_mul_f32 v[156:157], v[92:93], v[58:59] op_sel_hi:[1,0]
  v_pk_mul_f32 v[188:189], v[124:125], v[58:59] op_sel_hi:[1,0]
  v_pk_fma_f32 v[156:157], v[124:125], v[58:59], v[156:157] op_sel:[0,1,0] neg_lo:[0,1,0] neg_hi:[0,1,0]
  v_pk_fma_f32 v[188:189], v[92:93], v[58:59], v[188:189] op_sel:[0,1,0]
  v_pk_mul_f32 v[158:159], v[94:95], v[58:59] op_sel_hi:[1,0]
  v_pk_mul_f32 v[190:191], v[126:127], v[58:59] op_sel_hi:[1,0]
  v_pk_fma_f32 v[158:159], v[126:127], v[58:59], v[158:159] op_sel:[0,1,0] neg_lo:[0,1,0] neg_hi:[0,1,0]
  v_pk_fma_f32 v[190:191], v[94:95], v[58:59], v[190:191] op_sel:[0,1,0]
  buffer_load_dwordx4 v[244:247], v35, s[84:87], 0 offen sc1
  buffer_load_dwordx4 v[240:243], v34, s[84:87], 0 offen sc1
  buffer_load_dwordx4 v[236:239], v33, s[84:87], 0 offen sc1
  buffer_load_dwordx4 v[232:235], v32, s[84:87], 0 offen sc1
  buffer_load_dwordx4 v[228:231], v31, s[84:87], 0 offen sc1
  buffer_load_dwordx4 v[224:227], v30, s[84:87], 0 offen sc1
  buffer_load_dwordx4 v[220:223], v29, s[84:87], 0 offen sc1
  buffer_load_dwordx4 v[216:219], v28, s[84:87], 0 offen sc1
  s_barrier
  ds_read_b64 v[248:249], v45 offset:32768
  s_cmp_lg_u32 s78, 0
  s_cselect_b64 vcc, -1, 0
  s_waitcnt lgkmcnt(0)
  v_cndmask_b32 v248, 0, v248, vcc
  v_cndmask_b32_e64 v249, 0, v249, vcc
  s_waitcnt vmcnt(7)
  v_pk_fma_f32 v[202:203], v[244:245], v[54:55], v[246:247] op_sel_hi:[1,0,1]
  v_pk_fma_f32 v[202:203], v[244:245], v[54:55], v[202:203] op_sel:[1,1,0] op_sel_hi:[0,1,1] neg_lo:[1,0,0]
  s_waitcnt vmcnt(6)
  s_nop 0
  v_pk_fma_f32 v[208:209], v[202:203], v[54:55], v[240:241] op_sel_hi:[1,0,1]
  v_pk_fma_f32 v[208:209], v[202:203], v[54:55], v[208:209] op_sel:[1,1,0] op_sel_hi:[0,1,1] neg_lo:[1,0,0]
  v_pk_fma_f32 v[202:203], v[208:209], v[54:55], v[242:243] op_sel_hi:[1,0,1]
  v_pk_fma_f32 v[202:203], v[208:209], v[54:55], v[202:203] op_sel:[1,1,0] op_sel_hi:[0,1,1] neg_lo:[1,0,0]
  s_waitcnt vmcnt(5)
  s_nop 0
  v_pk_fma_f32 v[208:209], v[202:203], v[54:55], v[236:237] op_sel_hi:[1,0,1]
  v_pk_fma_f32 v[208:209], v[202:203], v[54:55], v[208:209] op_sel:[1,1,0] op_sel_hi:[0,1,1] neg_lo:[1,0,0]
  v_pk_fma_f32 v[202:203], v[208:209], v[54:55], v[238:239] op_sel_hi:[1,0,1]
  v_pk_fma_f32 v[202:203], v[208:209], v[54:55], v[202:203] op_sel:[1,1,0] op_sel_hi:[0,1,1] neg_lo:[1,0,0]
  s_waitcnt vmcnt(4)
  s_nop 0
  v_pk_fma_f32 v[208:209], v[202:203], v[54:55], v[232:233] op_sel_hi:[1,0,1]
  v_pk_fma_f32 v[208:209], v[202:203], v[54:55], v[208:209] op_sel:[1,1,0] op_sel_hi:[0,1,1] neg_lo:[1,0,0]
  v_pk_fma_f32 v[202:203], v[208:209], v[54:55], v[234:235] op_sel_hi:[1,0,1]
  v_pk_fma_f32 v[202:203], v[208:209], v[54:55], v[202:203] op_sel:[1,1,0] op_sel_hi:[0,1,1] neg_lo:[1,0,0]
  s_waitcnt vmcnt(3)
  s_nop 0
  v_pk_fma_f32 v[208:209], v[202:203], v[54:55], v[228:229] op_sel_hi:[1,0,1]
  v_pk_fma_f32 v[208:209], v[202:203], v[54:55], v[208:209] op_sel:[1,1,0] op_sel_hi:[0,1,1] neg_lo:[1,0,0]
  v_pk_fma_f32 v[202:203], v[208:209], v[54:55], v[230:231] op_sel_hi:[1,0,1]
  v_pk_fma_f32 v[202:203], v[208:209], v[54:55], v[202:203] op_sel:[1,1,0] op_sel_hi:[0,1,1] neg_lo:[1,0,0]
  s_waitcnt vmcnt(2)
  s_nop 0
  v_pk_fma_f32 v[208:209], v[202:203], v[54:55], v[224:225] op_sel_hi:[1,0,1]
  v_pk_fma_f32 v[208:209], v[202:203], v[54:55], v[208:209] op_sel:[1,1,0] op_sel_hi:[0,1,1] neg_lo:[1,0,0]
  v_pk_fma_f32 v[202:203], v[208:209], v[54:55], v[226:227] op_sel_hi:[1,0,1]
  v_pk_fma_f32 v[202:203], v[208:209], v[54:55], v[202:203] op_sel:[1,1,0] op_sel_hi:[0,1,1] neg_lo:[1,0,0]
  s_waitcnt vmcnt(1)
  s_nop 0
  v_pk_fma_f32 v[208:209], v[202:203], v[54:55], v[220:221] op_sel_hi:[1,0,1]
  v_pk_fma_f32 v[208:209], v[202:203], v[54:55], v[208:209] op_sel:[1,1,0] op_sel_hi:[0,1,1] neg_lo:[1,0,0]
  v_pk_fma_f32 v[202:203], v[208:209], v[54:55], v[222:223] op_sel_hi:[1,0,1]
  v_pk_fma_f32 v[202:203], v[208:209], v[54:55], v[202:203] op_sel:[1,1,0] op_sel_hi:[0,1,1] neg_lo:[1,0,0]
  s_waitcnt vmcnt(0)
  s_nop 0
  v_pk_fma_f32 v[208:209], v[202:203], v[54:55], v[216:217] op_sel_hi:[1,0,1]
  v_pk_fma_f32 v[208:209], v[202:203], v[54:55], v[208:209] op_sel:[1,1,0] op_sel_hi:[0,1,1] neg_lo:[1,0,0]
  v_pk_fma_f32 v[202:203], v[208:209], v[54:55], v[218:219] op_sel_hi:[1,0,1]
  v_pk_fma_f32 v[202:203], v[208:209], v[54:55], v[202:203] op_sel:[1,1,0] op_sel_hi:[0,1,1] neg_lo:[1,0,0]
  v_mov_b32 v206, v202
  v_mov_b32 v207, v203
  v_cmp_u_f32_e64 vcc, v202, v203
  s_nop 0
  s_cbranch_vccnz L_lb_cold
L_lb_ok:
  v_permlane32_swap_b32 v202, v206
  v_permlane32_swap_b32 v203, v207
  v_pk_fma_f32 v[202:203], v[206:207], v[56:57], v[202:203] op_sel_hi:[1,0,1]
  v_pk_fma_f32 v[202:203], v[206:207], v[56:57], v[202:203] op_sel:[1,1,0] op_sel_hi:[0,1,1] neg_lo:[1,0,0]
  v_pk_fma_f32 v[216:217], v[202:203], v[46:47], v[248:249] op_sel_hi:[1,0,1]
  v_pk_fma_f32 v[216:217], v[202:203], v[46:47], v[216:217] op_sel:[1,1,0] op_sel_hi:[0,1,1] neg_lo:[1,0,0]
  v_pk_fma_f32 v[210:211], v[60:61], v[216:217], v[210:211] op_sel_hi:[1,0,1]
  v_pk_fma_f32 v[212:213], v[62:63], v[216:217], v[212:213] op_sel_hi:[1,0,1]
  v_pk_fma_f32 v[210:211], v[62:63], v[216:217], v[210:211] op_sel:[0,1,0] neg_lo:[0,1,0] neg_hi:[0,1,0]
  v_pk_fma_f32 v[212:213], v[60:61], v[216:217], v[212:213] op_sel:[0,1,0]
  v_pk_fma_f32 v[128:129], v[210:211], v[48:49], v[128:129] op_sel_hi:[1,0,1]
  v_pk_fma_f32 v[160:161], v[212:213], v[48:49], v[160:161] op_sel_hi:[1,0,1]
  v_pk_fma_f32 v[128:129], v[212:213], v[48:49], v[128:129] op_sel:[0,1,0] neg_lo:[0,1,0] neg_hi:[0,1,0]
  v_pk_fma_f32 v[160:161], v[210:211], v[48:49], v[160:161] op_sel:[0,1,0]
  v_pk_fma_f32 v[130:131], v[128:129], v[48:49], v[130:131] op_sel_hi:[1,0,1]
  v_pk_fma_f32 v[162:163], v[160:161], v[48:49], v[162:163] op_sel_hi:[1,0,1]
  v_pk_fma_f32 v[130:131], v[160:161], v[48:49], v[130:131] op_sel:[0,1,0] neg_lo:[0,1,0] neg_hi:[0,1,0]
  v_pk_fma_f32 v[162:163], v[128:129], v[48:49], v[162:163] op_sel:[0,1,0]
  v_pk_fma_f32 v[132:133], v[130:131], v[48:49], v[132:133] op_sel_hi:[1,0,1]
  v_pk_fma_f32 v[164:165], v[162:163], v[48:49], v[164:165] op_sel_hi:[1,0,1]
  v_pk_fma_f32 v[132:133], v[162:163], v[48:49], v[132:133] op_sel:[0,1,0] neg_lo:[0,1,0] neg_hi:[0,1,0]
  v_pk_fma_f32 v[164:165], v[130:131], v[48:49], v[164:165] op_sel:[0,1,0]
  v_pk_fma_f32 v[134:135], v[132:133], v[48:49], v[134:135] op_sel_hi:[1,0,1]
  v_pk_fma_f32 v[166:167], v[164:165], v[48:49], v[166:167] op_sel_hi:[1,0,1]
  v_pk_fma_f32 v[134:135], v[164:165], v[48:49], v[134:135] op_sel:[0,1,0] neg_lo:[0,1,0] neg_hi:[0,1,0]
  v_pk_fma_f32 v[166:167], v[132:133], v[48:49], v[166:167] op_sel:[0,1,0]
  v_pk_fma_f32 v[136:137], v[134:135], v[48:49], v[136:137] op_sel_hi:[1,0,1]
  v_pk_fma_f32 v[168:169], v[166:167], v[48:49], v[168:169] op_sel_hi:[1,0,1]
  v_pk_fma_f32 v[136:137], v[166:167], v[48:49], v[136:137] op_sel:[0,1,0] neg_lo:[0,1,0] neg_hi:[0,1,0]
  v_pk_fma_f32 v[168:169], v[134:135], v[48:49], v[168:169] op_sel:[0,1,0]
  v_pk_fma_f32 v[138:139], v[136:137], v[48:49], v[138:139] op_sel_hi:[1,0,1]
  v_pk_fma_f32 v[170:171], v[168:169], v[48:49], v[170:171] op_sel_hi:[1,0,1]
  v_pk_fma_f32 v[138:139], v[168:169], v[48:49], v[138:139] op_sel:[0,1,0] neg_lo:[0,1,0] neg_hi:[0,1,0]
  v_pk_fma_f32 v[170:171], v[136:137], v[48:49], v[170:171] op_sel:[0,1,0]
  v_pk_fma_f32 v[140:141], v[138:139], v[48:49], v[140:141] op_sel_hi:[1,0,1]
  v_pk_fma_f32 v[172:173], v[170:171], v[48:49], v[172:173] op_sel_hi:[1,0,1]
  v_pk_fma_f32 v[140:141], v[170:171], v[48:49], v[140:141] op_sel:[0,1,0] neg_lo:[0,1,0] neg_hi:[0,1,0]
  v_pk_fma_f32 v[172:173], v[138:139], v[48:49], v[172:173] op_sel:[0,1,0]
  v_pk_fma_f32 v[142:143], v[140:141], v[48:49], v[142:143] op_sel_hi:[1,0,1]
  v_pk_fma_f32 v[174:175], v[172:173], v[48:49], v[174:175] op_sel_hi:[1,0,1]
  v_pk_fma_f32 v[142:143], v[172:173], v[48:49], v[142:143] op_sel:[0,1,0] neg_lo:[0,1,0] neg_hi:[0,1,0]
  v_pk_fma_f32 v[174:175], v[140:141], v[48:49], v[174:175] op_sel:[0,1,0]
  v_cvt_pk_bf16_f32 v64, v128, v130
  v_cvt_pk_bf16_f32 v65, v132, v134
  v_cvt_pk_bf16_f32 v66, v136, v138
  v_cvt_pk_bf16_f32 v67, v140, v142
  buffer_store_dwordx4 v[64:67], v36, s[60:63], s91 offen offset:0 sc1
  v_pk_fma_f32 v[144:145], v[142:143], v[48:49], v[144:145] op_sel_hi:[1,0,1]
  v_pk_fma_f32 v[176:177], v[174:175], v[48:49], v[176:177] op_sel_hi:[1,0,1]
  v_pk_fma_f32 v[144:145], v[174:175], v[48:49], v[144:145] op_sel:[0,1,0] neg_lo:[0,1,0] neg_hi:[0,1,0]
  v_pk_fma_f32 v[176:177], v[142:143], v[48:49], v[176:177] op_sel:[0,1,0]
  v_cvt_pk_bf16_f32 v68, v129, v131
  v_cvt_pk_bf16_f32 v69, v133, v135
  v_cvt_pk_bf16_f32 v70, v137, v139
  v_cvt_pk_bf16_f32 v71, v141, v143
  buffer_store_dwordx4 v[68:71], v36, s[60:63], s91 offen offset:2048 sc1
  v_pk_fma_f32 v[146:147], v[144:145], v[48:49], v[146:147] op_sel_hi:[1,0,1]
  v_pk_fma_f32 v[178:179], v[176:177], v[48:49], v[178:179] op_sel_hi:[1,0,1]
  v_pk_fma_f32 v[146:147], v[176:177], v[48:49], v[146:147] op_sel:[0,1,0] neg_lo:[0,1,0] neg_hi:[0,1,0]
  v_pk_fma_f32 v[178:179], v[144:145], v[48:49], v[178:179] op_sel:[0,1,0]
  v_cvt_pk_bf16_f32 v72, -v160, -v162
  v_cvt_pk_bf16_f32 v73, -v164, -v166
  v_cvt_pk_bf16_f32 v74, -v168, -v170
  v_cvt_pk_bf16_f32 v75, -v172, -v174
  buffer_store_dwordx4 v[72:75], v36, s[60:63], s92 offen offset:0 sc1
  v_pk_fma_f32 v[148:149], v[146:147], v[48:49], v[148:149] op_sel_hi:[1,0,1]
  v_pk_fma_f32 v[180:181], v[178:179], v[48:49], v[180:181] op_sel_hi:[1,0,1]
  v_pk_fma_f32 v[148:149], v[178:179], v[48:49], v[148:149] op_sel:[0,1,0] neg_lo:[0,1,0] neg_hi:[0,1,0]
  v_pk_fma_f32 v[180:181], v[146:147], v[48:49], v[180:181] op_sel:[0,1,0]
  v_cvt_pk_bf16_f32 v76, -v161, -v163
  v_cvt_pk_bf16_f32 v77, -v165, -v167
  v_cvt_pk_bf16_f32 v78, -v169, -v171
  v_cvt_pk_bf16_f32 v79, -v173, -v175
  buffer_store_dwordx4 v[76:79], v36, s[60:63], s92 offen offset:2048 sc1
  v_pk_fma_f32 v[150:151], v[148:149], v[48:49], v[150:151] op_sel_hi:[1,0,1]
  v_pk_fma_f32 v[182:183], v[180:181], v[48:49], v[182:183] op_sel_hi:[1,0,1]
  v_pk_fma_f32 v[150:151], v[180:181], v[48:49], v[150:151] op_sel:[0,1,0] neg_lo:[0,1,0] neg_hi:[0,1,0]
  v_pk_fma_f32 v[182:183], v[148:149], v[48:49], v[182:183] op_sel:[0,1,0]
  v_pk_fma_f32 v[152:153], v[150:151], v[48:49], v[152:153] op_sel_hi:[1,0,1]
  v_pk_fma_f32 v[184:185], v[182:183], v[48:49], v[184:185] op_sel_hi:[1,0,1]
  v_pk_fma_f32 v[152:153], v[182:183], v[48:49], v[152:153] op_sel:[0,1,0] neg_lo:[0,1,0] neg_hi:[0,1,0]
  v_pk_fma_f32 v[184:185], v[150:151], v[48:49], v[184:185] op_sel:[0,1,0]
  v_pk_fma_f32 v[154:155], v[152:153], v[48:49], v[154:155] op_sel_hi:[1,0,1]
  v_pk_fma_f32 v[186:187], v[184:185], v[48:49], v[186:187] op_sel_hi:[1,0,1]
  v_pk_fma_f32 v[154:155], v[184:185], v[48:49], v[154:155] op_sel:[0,1,0] neg_lo:[0,1,0] neg_hi:[0,1,0]
  v_pk_fma_f32 v[186:187], v[152:153], v[48:49], v[186:187] op_sel:[0,1,0]
  v_pk_fma_f32 v[156:157], v[154:155], v[48:49], v[156:157] op_sel_hi:[1,0,1]
  v_pk_fma_f32 v[188:189], v[186:187], v[48:49], v[188:189] op_sel_hi:[1,0,1]
  v_pk_fma_f32 v[156:157], v[186:187], v[48:49], v[156:157] op_sel:[0,1,0] neg_lo:[0,1,0] neg_hi:[0,1,0]
  v_pk_fma_f32 v[188:189], v[154:155], v[48:49], v[188:189] op_sel:[0,1,0]
  v_pk_fma_f32 v[158:159], v[156:157], v[48:49], v[158:159] op_sel_hi:[1,0,1]
  v_pk_fma_f32 v[190:191], v[188:189], v[48:49], v[190:191] op_sel_hi:[1,0,1]
  v_pk_fma_f32 v[158:159], v[188:189], v[48:49], v[158:159] op_sel:[0,1,0] neg_lo:[0,1,0] neg_hi:[0,1,0]
  v_pk_fma_f32 v[190:191], v[156:157], v[48:49], v[190:191] op_sel:[0,1,0]
  v_cvt_pk_bf16_f32 v80, v144, v146
  v_cvt_pk_bf16_f32 v81, v148, v150
  v_cvt_pk_bf16_f32 v82, v152, v154
  v_cvt_pk_bf16_f32 v83, v156, v158
  buffer_store_dwordx4 v[80:83], v37, s[60:63], s91 offen offset:1024 sc1
  v_cvt_pk_bf16_f32 v84, v145, v147
  v_cvt_pk_bf16_f32 v85, v149, v151
  v_cvt_pk_bf16_f32 v86, v153, v155
  v_cvt_pk_bf16_f32 v87, v157, v159
  buffer_store_dwordx4 v[84:87], v37, s[60:63], s91 offen offset:3072 sc1
  v_cvt_pk_bf16_f32 v88, -v176, -v178
  v_cvt_pk_bf16_f32 v89, -v180, -v182
  v_cvt_pk_bf16_f32 v90, -v184, -v186
  v_cvt_pk_bf16_f32 v91, -v188, -v190
  buffer_store_dwordx4 v[88:91], v37, s[60:63], s92 offen offset:1024 sc1
  v_cvt_pk_bf16_f32 v92, -v177, -v179
  v_cvt_pk_bf16_f32 v93, -v181, -v183
  v_cvt_pk_bf16_f32 v94, -v185, -v187
  v_cvt_pk_bf16_f32 v95, -v189, -v191
  buffer_store_dwordx4 v[92:95], v37, s[60:63], s92 offen offset:3072 sc1
  s_barrier
  s_waitcnt vmcnt(0)
  s_mov_b64 exec, 1
  buffer_store_dword v41, v40, s[60:63], s93 offen sc1
  s_mov_b64 exec, -1
L_A2:
  s_lshr_b32 s6, s11, 4
  s_mul_i32 s6, s6, 2304
  s_mul_i32 s7, s12, 384
  s_add_u32 s6, s6, s7
  s_mul_i32 s7, s77, 192
  s_add_u32 s6, s6, s7
  s_add_u32 s6, s6, 147456
  s_add_u32 s8, s54, s6
  s_addc_u32 s9, s55, 0
  s_load_dwordx16 s[16:31], s[8:9], 0
  s_load_dwordx16 s[32:47], s[8:9], 64
  s_load_dwordx8 s[64:71], s[8:9], 128
  s_load_dwordx4 s[56:59], s[8:9], 160
  s_load_dwordx4 s[84:87], s[8:9], 176
  s_barrier
  v_lshlrev_b32_e64 v201, 4, v1
  s_mul_i32 s89, s11, 147456
  s_lshl_b32 s15, s76, 12
  s_add_u32 s89, s89, s15
  s_add_u32 s89, s89, 1048576
  s_lshl_b32 s14, s13, 14
  v_min_u32 v203, 8, v1
  v_lshlrev_b32 v203, 8, v203
  s_mul_i32 s88, s11, 18
  s_add_u32 s88, s88, s77
  s_lshl_b32 s88, s88, 7
  s_add_u32 s88, s88, 327680
  v_lshrrev_b32 v204, 3, v1
  v_and_b32 v205, 7, v1
  v_bfe_u32 v200, v1, 4, 1
  v_xor_b32 v205, v205, v200
  v_and_b32 v200, 4, v204
  v_xor_b32 v205, v205, v200
  v_lshlrev_b32 v200, 12, v204
  v_lshl_add_u32 v200, v205, 4, v200
  s_mul_i32 s92, s76, 6144
  s_add_u32 s92, s92, 114688
  s_mul_i32 s90, s12, 393216
  s_mul_i32 s7, s77, 196608
  s_add_u32 s90, s90, s7
  s_lshl_b32 s7, s11, 7
  s_add_u32 s90, s90, s7
  s_mul_i32 s7, s78, 98304
  s_add_u32 s90, s90, s7
  s_add_u32 s90, s90, 6291456
  s_waitcnt lgkmcnt(0)
  s_or_b64 s[16:17], s[16:17], s[18:19]
  s_or_b64 s[16:17], s[16:17], s[20:21]
  s_or_b64 s[16:17], s[16:17], s[22:23]
  s_or_b64 s[16:17], s[16:17], s[24:25]
  s_or_b64 s[16:17], s[16:17], s[26:27]
  s_or_b64 s[16:17], s[16:17], s[28:29]
  s_or_b64 s[16:17], s[16:17], s[30:31]
  s_or_b64 s[16:17], s[16:17], s[32:33]
  s_or_b64 s[16:17], s[16:17], s[34:35]
  s_or_b64 s[16:17], s[16:17], s[36:37]
  s_or_b64 s[16:17], s[16:17], s[38:39]
  s_or_b64 s[16:17], s[16:17], s[40:41]
  s_or_b64 s[16:17], s[16:17], s[42:43]
  s_or_b64 s[16:17], s[16:17], s[44:45]
  s_or_b64 s[16:17], s[16:17], s[46:47]
  s_or_b64 s[16:17], s[16:17], s[64:65]
  s_or_b64 s[16:17], s[16:17], s[66:67]
  s_or_b64 s[16:17], s[16:17], s[68:69]
  s_or_b64 s[16:17], s[16:17], s[70:71]
  s_or_b64 s[16:17], s[16:17], s[56:57]
  s_or_b64 s[16:17], s[16:17], s[58:59]
  s_or_b64 s[16:17], s[16:17], s[84:85]
  s_or_b64 s[16:17], s[16:17], s[86:87]
  s_or_b32 s94, s16, s17
  s_cmp_eq_u32 s94, 1
  s_cbranch_scc1 L_fl_ok
  s_lshr_b32 s6, s11, 4
  s_mul_i32 s6, s6, 2304
  s_mul_i32 s7, s12, 384
  s_add_u32 s6, s6, s7
  s_mul_i32 s7, s77, 192
  s_add_u32 s6, s6, s7
  s_add_u32 s6, s6, 147456
  v_min_u32 v233, 47, v1
  v_lshlrev_b32 v233, 2, v233
  buffer_load_dword v232, v233, s[60:63], s6 offen sc1
  s_waitcnt vmcnt(0)
  v_cmp_ne_u32_e64 vcc, 1, v232
  s_nop 0
  s_cbranch_vccnz Len4
Lok2:
L_fl_ok:
  s_add_u32 s16, s89, s14
  s_add_u32 s14, s14, 16384
  s_cmp_ge_u32 s14, 147456
  s_cselect_b32 s14, 0, s14
  s_add_u32 s17, s89, s14
  s_add_u32 s14, s14, 16384
  s_cmp_ge_u32 s14, 147456
  s_cselect_b32 s14, 0, s14
  s_add_u32 s18, s89, s14
  s_add_u32 s14, s14, 16384
  s_cmp_ge_u32 s14, 147456
  s_cselect_b32 s14, 0, s14
  s_add_u32 s19, s89, s14
  s_add_u32 s14, s14, 16384
  s_cmp_ge_u32 s14, 147456
  s_cselect_b32 s14, 0, s14
  s_add_u32 s20, s89, s14
  s_add_u32 s14, s14, 16384
  s_cmp_ge_u32 s14, 147456
  s_cselect_b32 s14, 0, s14
  s_add_u32 s21, s89, s14
  s_add_u32 s14, s14, 16384
  s_cmp_ge_u32 s14, 147456
  s_cselect_b32 s14, 0, s14
  s_add_u32 s22, s89, s14
  s_add_u32 s14, s14, 16384
  s_cmp_ge_u32 s14, 147456
  s_cselect_b32 s14, 0, s14
  s_add_u32 s23, s89, s14
  s_add_u32 s14, s14, 16384
  s_cmp_ge_u32 s14, 147456
  s_cselect_b32 s14, 0, s14
  s_add_u32 s24, s89, s14
  s_waitcnt vmcnt(0)
  buffer_load_dword v202, v203, s[60:63], s88 offen sc1
  s_waitcnt vmcnt(0)
  v_cmp_ne_u32 vcc, 1, v202
  s_nop 0
  s_cbranch_vccnz Len7
Lok5:
  v_add_u32_e64 v220, s92, v201
  s_setprio 2
  s_add_u32 m0, s15, 0
  s_nop 0
  buffer_load_dwordx4 v201, s[60:63], s16 offen offset:0 sc1 lds
  buffer_load_dwordx4 v201, s[60:63], s16 offen offset:1024 sc1 lds
  buffer_load_dwordx4 v201, s[60:63], s16 offen offset:2048 sc1 lds
  buffer_load_dwordx4 v201, s[60:63], s16 offen offset:3072 sc1 lds
  s_barrier
  s_add_u32 m0, s15, 16384
  s_nop 0
  buffer_load_dwordx4 v201, s[60:63], s17 offen offset:0 sc1 lds
  buffer_load_dwordx4 v201, s[60:63], s17 offen offset:1024 sc1 lds
  buffer_load_dwordx4 v201, s[60:63], s17 offen offset:2048 sc1 lds
  buffer_load_dwordx4 v201, s[60:63], s17 offen offset:3072 sc1 lds
  s_barrier
  s_add_u32 m0, s15, 32768
  s_nop 0
  buffer_load_dwordx4 v201, s[60:63], s18 offen offset:0 sc1 lds
  buffer_load_dwordx4 v201, s[60:63], s18 offen offset:1024 sc1 lds
  buffer_load_dwordx4 v201, s[60:63], s18 offen offset:2048 sc1 lds
  buffer_load_dwordx4 v201, s[60:63], s18 offen offset:3072 sc1 lds
  s_waitcnt vmcnt(8)
  s_barrier
  s_add_u32 m0, s15, 49152
  s_nop 0
  buffer_load_dwordx4 v201, s[60:63], s19 offen offset:0 sc1 lds
  buffer_load_dwordx4 v201, s[60:63], s19 offen offset:1024 sc1 lds
  buffer_load_dwordx4 v201, s[60:63], s19 offen offset:2048 sc1 lds
  buffer_load_dwordx4 v201, s[60:63], s19 offen offset:3072 sc1 lds
  s_add_u32 m0, s15, 139264
  s_nop 0
  buffer_load_dwordx4 v201, s[60:63], s20 offen offset:0 sc1 lds
  s_waitcnt vmcnt(9)
  s_barrier
  s_add_u32 m0, s15, 139264
  s_nop 0
  buffer_load_dwordx4 v201, s[60:63], s20 offen offset:1024 sc1 lds
  buffer_load_dwordx4 v201, s[60:63], s20 offen offset:2048 sc1 lds
  buffer_load_dwordx4 v201, s[60:63], s20 offen offset:3072 sc1 lds
  s_add_u32 m0, s15, 0
  s_nop 0
  buffer_load_dwordx4 v201, s[60:63], s21 offen offset:0 sc1 lds
  buffer_load_dwordx4 v201, s[60:63], s21 offen offset:1024 sc1 lds
  s_waitcnt vmcnt(10)
  s_barrier
  s_add_u32 m0, s15, 0
  s_nop 0
  buffer_load_dwordx4 v201, s[60:63], s21 offen offset:2048 sc1 lds
  buffer_load_dwordx4 v201, s[60:63], s21 offen offset:3072 sc1 lds
  s_add_u32 m0, s92, 0
  s_add_u32 s7, s90, 0
  buffer_load_dwordx4 v200, s[60:63], s7 offen sc1 lds
  s_add_u32 m0, s92, 1024
  s_add_u32 s7, s90, 32768
  buffer_load_dwordx4 v200, s[60:63], s7 offen sc1 lds
  s_add_u32 m0, s92, 2048
  s_add_u32 s7, s90, 65536
  buffer_load_dwordx4 v200, s[60:63], s7 offen sc1 lds
  s_waitcnt vmcnt(11)
  s_barrier
  s_add_u32 m0, s15, 16384
  s_nop 0
  buffer_load_dwordx4 v201, s[60:63], s22 offen offset:0 sc1 lds
  buffer_load_dwordx4 v201, s[60:63], s22 offen offset:1024 sc1 lds
  buffer_load_dwordx4 v201, s[60:63], s22 offen offset:2048 sc1 lds
  buffer_load_dwordx4 v201, s[60:63], s22 offen offset:3072 sc1 lds
  s_add_u32 m0, s15, 32768
  s_nop 0
  buffer_load_dwordx4 v201, s[60:63], s23 offen offset:0 sc1 lds
  s_waitcnt vmcnt(12)
  s_barrier
  s_add_u32 m0, s15, 32768
  s_nop 0
  buffer_load_dwordx4 v201, s[60:63], s23 offen offset:1024 sc1 lds
  buffer_load_dwordx4 v201, s[60:63], s23 offen offset:2048 sc1 lds
  buffer_load_dwordx4 v201, s[60:63], s23 offen offset:3072 sc1 lds
  s_add_u32 m0, s15, 49152
  s_nop 0
  buffer_load_dwordx4 v201, s[60:63], s24 offen offset:0 sc1 lds
  buffer_load_dwordx4 v201, s[60:63], s24 offen offset:1024 sc1 lds
  s_waitcnt vmcnt(13)
  s_waitcnt vmcnt(10)
  ds_read_b128 v[204:207], v220 offset:0
  ds_read_b128 v[208:211], v220 offset:1024
  ds_read_b128 v[212:215], v220 offset:2048
  s_waitcnt lgkmcnt(2)
  v_max_u32_e64 v202, v204, v205
  v_max3_u32 v202, v206, v207, v202
  s_waitcnt lgkmcnt(1)
  v_max3_u32 v202, v208, v209, v202
  v_max3_u32 v202, v210, v211, v202
  s_waitcnt lgkmcnt(0)
  v_max3_u32 v202, v212, v213, v202
  v_max3_u32 v202, v214, v215, v202
  v_cmp_eq_u32 vcc, -1, v202
  s_nop 0
  s_cbranch_vccnz Len10
Lok8:
  s_barrier
  s_add_u32 m0, s15, 49152
  s_nop 0
  buffer_load_dwordx4 v201, s[60:63], s24 offen offset:2048 sc1 lds
  buffer_load_dwordx4 v201, s[60:63], s24 offen offset:3072 sc1 lds
  s_waitcnt vmcnt(8)
  s_barrier
  s_waitcnt vmcnt(4)
  s_barrier
  s_waitcnt vmcnt(0)
  s_barrier
  s_barrier
  s_barrier
L_exit:
  s_endpgm
L_B2:
  v_lshlrev_b32 v44, 16, v44
  v_lshlrev_b32 v45, 16, v45
  v_lshlrev_b32 v46, 16, v46
  v_mul_f32 v4, v4, v44
  v_mul_f32 v5, v5, v44
  v_mul_f32 v6, v6, v44
  v_mul_f32 v7, v7, v44
  v_mul_f32 v8, v8, v45
  v_mul_f32 v9, v9, v45
  v_mul_f32 v10, v10, v45
  v_mul_f32 v11, v11, v45
  v_mul_f32 v12, v12, v46
  v_mul_f32 v13, v13, v46
  v_mul_f32 v14, v14, v46
  v_mul_f32 v15, v15, v46
  v_mul_f32 v16, v16, v44
  v_mul_f32 v17, v17, v44
  v_mul_f32 v18, v18, v44
  v_mul_f32 v19, v19, v44
  v_mul_f32 v20, v20, v45
  v_mul_f32 v21, v21, v45
  v_mul_f32 v22, v22, v45
  v_mul_f32 v23, v23, v45
  v_mul_f32 v24, v24, v46
  v_mul_f32 v25, v25, v46
  v_mul_f32 v26, v26, v46
  v_mul_f32 v27, v27, v46
  s_cmp_lg_u32 s76, 0
  s_cbranch_scc1 Lq018
  s_waitcnt vmcnt(0)
  v_max3_u32 v37, v28, v29, v30
  v_max3_u32 v37, v31, v32, v37
  v_max3_u32 v37, v33, v34, v37
  v_max3_u32 v37, v35, v36, v37
  v_cmp_eq_u32 vcc, -1, v37
  s_nop 0
  s_cbranch_vccnz Len21
Lok19:
  v_add_f32 v28, v28, v29
  v_add_f32 v28, v28, v30
  v_add_f32 v28, v28, v31
  v_add_f32 v28, v28, v32
  v_add_f32 v28, v28, v33
  v_add_f32 v28, v28, v34
  v_add_f32 v28, v28, v35
  v_add_f32_e64 v28, v28, v36
  v_cvt_pk_bf16_f32 v28, 0, v28
  v_mul_f32 v28, 0xbfb8aa3b, v28
  v_exp_f32_e64 v28, v28
  v_add_u32 v30, 159744, v3
  v_add_f32 v28, 1.0, v28
  v_rcp_f32_e64 v28, v28
  s_nop 0
  v_cvt_pk_bf16_f32 v28, 0, v28
  v_sub_f32_e64 v29, 1.0, v28
  v_cvt_pk_bf16_f32 v29, 0, v29
  ds_write2st64_b32 v30, v29, v28 offset0:0 offset1:1
  s_waitcnt lgkmcnt(0)
Lq018:
  s_setprio 1
  s_barrier
  s_barrier
  s_barrier
  ds_read_b64_tr_b16 v[196:197], v228 offset:0
  ds_read_b64_tr_b16 v[198:199], v229 offset:0
  ds_read_b64_tr_b16 v[200:201], v228 offset:2048
  ds_read_b64_tr_b16 v[202:203], v229 offset:2048
  ds_read_b64_tr_b16 v[204:205], v230 offset:0
  ds_read_b64_tr_b16 v[206:207], v231 offset:0
  ds_read_b64_tr_b16 v[208:209], v230 offset:2048
  ds_read_b64_tr_b16 v[210:211], v231 offset:2048
  ds_read_b64_tr_b16 v[212:213], v228 offset:4096
  ds_read_b64_tr_b16 v[214:215], v229 offset:4096
  ds_read_b64_tr_b16 v[216:217], v228 offset:6144
  ds_read_b64_tr_b16 v[218:219], v229 offset:6144
  s_waitcnt lgkmcnt(10)
  v_mfma_f32_16x16x32_bf16 v[4:7], v[196:199], v[52:55], v[4:7]
  ds_read_b64_tr_b16 v[220:221], v230 offset:4096
  v_mfma_f32_16x16x32_bf16 v[8:11], v[196:199], v[56:59], v[8:11]
  ds_read_b64_tr_b16 v[222:223], v231 offset:4096
  v_mfma_f32_16x16x32_bf16 v[12:15], v[196:199], v[60:63], v[12:15]
  s_waitcnt lgkmcnt(10)
  v_mfma_f32_16x16x32_bf16 v[16:19], v[200:203], v[52:55], v[16:19]
  ds_read_b64_tr_b16 v[224:225], v230 offset:6144
  v_mfma_f32_16x16x32_bf16 v[20:23], v[200:203], v[56:59], v[20:23]
  ds_read_b64_tr_b16 v[226:227], v231 offset:6144
  v_mfma_f32_16x16x32_bf16 v[24:27], v[200:203], v[60:63], v[24:27]
  s_waitcnt lgkmcnt(8)
  v_mfma_f32_16x16x32_bf16 v[28:31], v[204:207], v[52:55], 0
  v_mfma_f32_16x16x32_bf16 v[32:35], v[204:207], v[56:59], 0
  v_mfma_f32_16x16x32_bf16 v[36:39], v[204:207], v[60:63], 0
  v_mfma_f32_16x16x32_bf16 v[40:43], v[208:211], v[52:55], 0
  s_waitcnt lgkmcnt(0)
  s_barrier
  ds_read_b64_tr_b16 v[196:197], v228 offset:16384
  v_mfma_f32_16x16x32_bf16 v[44:47], v[208:211], v[56:59], 0
  ds_read_b64_tr_b16 v[198:199], v229 offset:16384
  ds_read_b64_tr_b16 v[200:201], v228 offset:18432
  v_mfma_f32_16x16x32_bf16 v[48:51], v[208:211], v[60:63], 0
  ds_read_b64_tr_b16 v[202:203], v229 offset:18432
  v_mfma_f32_16x16x32_bf16 v[4:7], v[212:215], v[64:67], v[4:7]
  ds_read_b64_tr_b16 v[204:205], v230 offset:16384
  v_mfma_f32_16x16x32_bf16 v[8:11], v[212:215], v[68:71], v[8:11]
  ds_read_b64_tr_b16 v[206:207], v231 offset:16384
  v_mfma_f32_16x16x32_bf16 v[12:15], v[212:215], v[72:75], v[12:15]
  s_waitcnt vmcnt(0)
  ds_read_b128 v[52:55], v244 offset:49152
  v_mfma_f32_16x16x32_bf16 v[16:19], v[216:219], v[64:67], v[16:19]
  ds_read_b64_tr_b16 v[208:209], v230 offset:18432
  v_mfma_f32_16x16x32_bf16 v[20:23], v[216:219], v[68:71], v[20:23]
  ds_read_b64_tr_b16 v[210:211], v231 offset:18432
  v_mfma_f32_16x16x32_bf16 v[24:27], v[216:219], v[72:75], v[24:27]
  ds_read_b128 v[56:59], v244 offset:51200
  v_mfma_f32_16x16x32_bf16 v[28:31], v[220:223], v[64:67], v[28:31]
  ds_read_b64_tr_b16 v[212:213], v228 offset:20480
  v_mfma_f32_16x16x32_bf16 v[32:35], v[220:223], v[68:71], v[32:35]
  ds_read_b64_tr_b16 v[214:215], v229 offset:20480
  v_mfma_f32_16x16x32_bf16 v[36:39], v[220:223], v[72:75], v[36:39]
  ds_read_b128 v[60:63], v244 offset:53248
  v_mfma_f32_16x16x32_bf16 v[40:43], v[224:227], v[64:67], v[40:43]
  ds_read_b64_tr_b16 v[216:217], v228 offset:22528
  v_mfma_f32_16x16x32_bf16 v[44:47], v[224:227], v[68:71], v[44:47]
  ds_read_b64_tr_b16 v[218:219], v229 offset:22528
  v_mfma_f32_16x16x32_bf16 v[48:51], v[224:227], v[72:75], v[48:51]
  s_waitcnt lgkmcnt(11)
  v_mfma_f32_16x16x32_bf16 v[4:7], v[196:199], v[76:79], v[4:7]
  ds_read_b64_tr_b16 v[220:221], v230 offset:20480
  v_mfma_f32_16x16x32_bf16 v[8:11], v[196:199], v[80:83], v[8:11]
  ds_read_b64_tr_b16 v[222:223], v231 offset:20480
  v_mfma_f32_16x16x32_bf16 v[12:15], v[196:199], v[84:87], v[12:15]
  ds_read_b128 v[64:67], v245 offset:49152
  v_mfma_f32_16x16x32_bf16 v[16:19], v[200:203], v[76:79], v[16:19]
  ds_read_b64_tr_b16 v[224:225], v230 offset:22528
  v_mfma_f32_16x16x32_bf16 v[20:23], v[200:203], v[80:83], v[20:23]
  ds_read_b64_tr_b16 v[226:227], v231 offset:22528
  v_mfma_f32_16x16x32_bf16 v[24:27], v[200:203], v[84:87], v[24:27]
  ds_read_b128 v[68:71], v245 offset:51200
  s_waitcnt lgkmcnt(12)
  v_mfma_f32_16x16x32_bf16 v[28:31], v[204:207], v[76:79], v[28:31]
  v_mfma_f32_16x16x32_bf16 v[32:35], v[204:207], v[80:83], v[32:35]
  v_mfma_f32_16x16x32_bf16 v[36:39], v[204:207], v[84:87], v[36:39]
  ds_read_b128 v[72:75], v245 offset:53248
  v_mfma_f32_16x16x32_bf16 v[40:43], v[208:211], v[76:79], v[40:43]
  s_waitcnt lgkmcnt(2)
  s_barrier
  ds_read_b64_tr_b16 v[196:197], v228 offset:32768
  v_mfma_f32_16x16x32_bf16 v[44:47], v[208:211], v[80:83], v[44:47]
  ds_read_b64_tr_b16 v[198:199], v229 offset:32768
  ds_read_b64_tr_b16 v[200:201], v228 offset:34816
  v_mfma_f32_16x16x32_bf16 v[48:51], v[208:211], v[84:87], v[48:51]
  ds_read_b64_tr_b16 v[202:203], v229 offset:34816
  v_mfma_f32_16x16x32_bf16 v[4:7], v[212:215], v[88:91], v[4:7]
  ds_read_b64_tr_b16 v[204:205], v230 offset:32768
  v_mfma_f32_16x16x32_bf16 v[8:11], v[212:215], v[92:95], v[8:11]
  ds_read_b64_tr_b16 v[206:207], v231 offset:32768
  v_mfma_f32_16x16x32_bf16 v[12:15], v[212:215], v[96:99], v[12:15]
  ds_read_b128 v[76:79], v244 offset:24576
  v_mfma_f32_16x16x32_bf16 v[16:19], v[216:219], v[88:91], v[16:19]
  ds_read_b64_tr_b16 v[208:209], v230 offset:34816
  v_mfma_f32_16x16x32_bf16 v[20:23], v[216:219], v[92:95], v[20:23]
  ds_read_b64_tr_b16 v[210:211], v231 offset:34816
  v_mfma_f32_16x16x32_bf16 v[24:27], v[216:219], v[96:99], v[24:27]
  ds_read_b128 v[80:83], v244 offset:26624
  v_mfma_f32_16x16x32_bf16 v[28:31], v[220:223], v[88:91], v[28:31]
  ds_read_b64_tr_b16 v[212:213], v228 offset:36864
  v_mfma_f32_16x16x32_bf16 v[32:35], v[220:223], v[92:95], v[32:35]
  ds_read_b64_tr_b16 v[214:215], v229 offset:36864
  v_mfma_f32_16x16x32_bf16 v[36:39], v[220:223], v[96:99], v[36:39]
  ds_read_b128 v[84:87], v244 offset:28672
  v_mfma_f32_16x16x32_bf16 v[40:43], v[224:227], v[88:91], v[40:43]
  ds_read_b64_tr_b16 v[216:217], v228 offset:38912
  v_mfma_f32_16x16x32_bf16 v[44:47], v[224:227], v[92:95], v[44:47]
  ds_read_b64_tr_b16 v[218:219], v229 offset:38912
  v_mfma_f32_16x16x32_bf16 v[48:51], v[224:227], v[96:99], v[48:51]
  s_waitcnt lgkmcnt(11)
  v_mfma_f32_16x16x32_bf16 v[4:7], v[196:199], v[100:103], v[4:7]
  ds_read_b64_tr_b16 v[220:221], v230 offset:36864
  v_mfma_f32_16x16x32_bf16 v[8:11], v[196:199], v[104:107], v[8:11]
  ds_read_b64_tr_b16 v[222:223], v231 offset:36864
  v_mfma_f32_16x16x32_bf16 v[12:15], v[196:199], v[108:111], v[12:15]
  ds_read_b128 v[88:91], v245 offset:24576
  v_mfma_f32_16x16x32_bf16 v[16:19], v[200:203], v[100:103], v[16:19]
  ds_read_b64_tr_b16 v[224:225], v230 offset:38912
  v_mfma_f32_16x16x32_bf16 v[20:23], v[200:203], v[104:107], v[20:23]
  ds_read_b64_tr_b16 v[226:227], v231 offset:38912
  v_mfma_f32_16x16x32_bf16 v[24:27], v[200:203], v[108:111], v[24:27]
  ds_read_b128 v[92:95], v245 offset:26624
  s_waitcnt lgkmcnt(12)
  v_mfma_f32_16x16x32_bf16 v[28:31], v[204:207], v[100:103], v[28:31]
  v_mfma_f32_16x16x32_bf16 v[32:35], v[204:207], v[104:107], v[32:35]
  v_mfma_f32_16x16x32_bf16 v[36:39], v[204:207], v[108:111], v[36:39]
  ds_read_b128 v[96:99], v245 offset:28672
  v_mfma_f32_16x16x32_bf16 v[40:43], v[208:211], v[100:103], v[40:43]
  s_waitcnt lgkmcnt(2)
  s_barrier
  ds_read_b64_tr_b16 v[196:197], v228 offset:49152
  v_mfma_f32_16x16x32_bf16 v[44:47], v[208:211], v[104:107], v[44:47]
  ds_read_b64_tr_b16 v[198:199], v229 offset:49152
  ds_read_b64_tr_b16 v[200:201], v228 offset:51200
  v_mfma_f32_16x16x32_bf16 v[48:51], v[208:211], v[108:111], v[48:51]
  ds_read_b64_tr_b16 v[202:203], v229 offset:51200
  v_mfma_f32_16x16x32_bf16 v[4:7], v[212:215], v[112:115], v[4:7]
  ds_read_b64_tr_b16 v[204:205], v230 offset:49152
  v_mfma_f32_16x16x32_bf16 v[8:11], v[212:215], v[116:119], v[8:11]
  ds_read_b64_tr_b16 v[206:207], v231 offset:49152
  v_mfma_f32_16x16x32_bf16 v[12:15], v[212:215], v[120:123], v[12:15]
  ds_read_b128 v[100:103], v244 offset:0
  v_mfma_f32_16x16x32_bf16 v[16:19], v[216:219], v[112:115], v[16:19]
  ds_read_b64_tr_b16 v[208:209], v230 offset:51200
  v_mfma_f32_16x16x32_bf16 v[20:23], v[216:219], v[116:119], v[20:23]
  ds_read_b64_tr_b16 v[210:211], v231 offset:51200
  v_mfma_f32_16x16x32_bf16 v[24:27], v[216:219], v[120:123], v[24:27]
  ds_read_b128 v[104:107], v244 offset:2048
  v_mfma_f32_16x16x32_bf16 v[28:31], v[220:223], v[112:115], v[28:31]
  ds_read_b64_tr_b16 v[212:213], v228 offset:53248
  v_mfma_f32_16x16x32_bf16 v[32:35], v[220:223], v[116:119], v[32:35]
  ds_read_b64_tr_b16 v[214:215], v229 offset:53248
  v_mfma_f32_16x16x32_bf16 v[36:39], v[220:223], v[120:123], v[36:39]
  ds_read_b128 v[108:111], v244 offset:4096
  v_mfma_f32_16x16x32_bf16 v[40:43], v[224:227], v[112:115], v[40:43]
  ds_read_b64_tr_b16 v[216:217], v228 offset:55296
  v_mfma_f32_16x16x32_bf16 v[44:47], v[224:227], v[116:119], v[44:47]
  ds_read_b64_tr_b16 v[218:219], v229 offset:55296
  v_mfma_f32_16x16x32_bf16 v[48:51], v[224:227], v[120:123], v[48:51]
  s_waitcnt lgkmcnt(11)
  v_mfma_f32_16x16x32_bf16 v[4:7], v[196:199], v[124:127], v[4:7]
  ds_read_b64_tr_b16 v[220:221], v230 offset:53248
  v_mfma_f32_16x16x32_bf16 v[8:11], v[196:199], v[128:131], v[8:11]
  ds_read_b64_tr_b16 v[222:223], v231 offset:53248
  v_mfma_f32_16x16x32_bf16 v[12:15], v[196:199], v[132:135], v[12:15]
  ds_read_b128 v[112:115], v245 offset:0
  v_mfma_f32_16x16x32_bf16 v[16:19], v[200:203], v[124:127], v[16:19]
  ds_read_b64_tr_b16 v[224:225], v230 offset:55296
  v_mfma_f32_16x16x32_bf16 v[20:23], v[200:203], v[128:131], v[20:23]
  ds_read_b64_tr_b16 v[226:227], v231 offset:55296
  v_mfma_f32_16x16x32_bf16 v[24:27], v[200:203], v[132:135], v[24:27]
  ds_read_b128 v[116:119], v245 offset:2048
  s_waitcnt lgkmcnt(12)
  v_mfma_f32_16x16x32_bf16 v[28:31], v[204:207], v[124:127], v[28:31]
  v_mfma_f32_16x16x32_bf16 v[32:35], v[204:207], v[128:131], v[32:35]
  v_mfma_f32_16x16x32_bf16 v[36:39], v[204:207], v[132:135], v[36:39]
  ds_read_b128 v[120:123], v245 offset:4096
  v_mfma_f32_16x16x32_bf16 v[40:43], v[208:211], v[124:127], v[40:43]
  s_waitcnt lgkmcnt(2)
  s_barrier
  ds_read_b64_tr_b16 v[196:197], v232 offset:0
  v_mfma_f32_16x16x32_bf16 v[44:47], v[208:211], v[128:131], v[44:47]
  ds_read_b64_tr_b16 v[198:199], v233 offset:0
  ds_read_b64_tr_b16 v[200:201], v232 offset:2048
  v_mfma_f32_16x16x32_bf16 v[48:51], v[208:211], v[132:135], v[48:51]
  ds_read_b64_tr_b16 v[202:203], v233 offset:2048
  v_mfma_f32_16x16x32_bf16 v[4:7], v[212:215], v[136:139], v[4:7]
  ds_read_b64_tr_b16 v[204:205], v234 offset:0
  v_mfma_f32_16x16x32_bf16 v[8:11], v[212:215], v[140:143], v[8:11]
  ds_read_b64_tr_b16 v[206:207], v235 offset:0
  v_mfma_f32_16x16x32_bf16 v[12:15], v[212:215], v[144:147], v[12:15]
  v_mfma_f32_16x16x32_bf16 v[16:19], v[216:219], v[136:139], v[16:19]
  ds_read_b64_tr_b16 v[208:209], v234 offset:2048
  v_mfma_f32_16x16x32_bf16 v[20:23], v[216:219], v[140:143], v[20:23]
  ds_read_b64_tr_b16 v[210:211], v235 offset:2048
  v_mfma_f32_16x16x32_bf16 v[24:27], v[216:219], v[144:147], v[24:27]
  v_mfma_f32_16x16x32_bf16 v[28:31], v[220:223], v[136:139], v[28:31]
  ds_read_b64_tr_b16 v[212:213], v232 offset:4096
  v_mfma_f32_16x16x32_bf16 v[32:35], v[220:223], v[140:143], v[32:35]
  ds_read_b64_tr_b16 v[214:215], v233 offset:4096
  v_mfma_f32_16x16x32_bf16 v[36:39], v[220:223], v[144:147], v[36:39]
  v_mfma_f32_16x16x32_bf16 v[40:43], v[224:227], v[136:139], v[40:43]
  ds_read_b64_tr_b16 v[216:217], v232 offset:6144
  v_mfma_f32_16x16x32_bf16 v[44:47], v[224:227], v[140:143], v[44:47]
  ds_read_b64_tr_b16 v[218:219], v233 offset:6144
  v_mfma_f32_16x16x32_bf16 v[48:51], v[224:227], v[144:147], v[48:51]
  s_waitcnt lgkmcnt(8)
  v_mfma_f32_16x16x32_bf16 v[4:7], v[196:199], v[148:151], v[4:7]
  ds_read_b64_tr_b16 v[220:221], v234 offset:4096
  v_mfma_f32_16x16x32_bf16 v[8:11], v[196:199], v[152:155], v[8:11]
  ds_read_b64_tr_b16 v[222:223], v235 offset:4096
  v_mfma_f32_16x16x32_bf16 v[12:15], v[196:199], v[156:159], v[12:15]
  v_mfma_f32_16x16x32_bf16 v[16:19], v[200:203], v[148:151], v[16:19]
  ds_read_b64_tr_b16 v[224:225], v234 offset:6144
  v_mfma_f32_16x16x32_bf16 v[20:23], v[200:203], v[152:155], v[20:23]
  ds_read_b64_tr_b16 v[226:227], v235 offset:6144
  v_mfma_f32_16x16x32_bf16 v[24:27], v[200:203], v[156:159], v[24:27]
  s_waitcnt lgkmcnt(8)
  v_mfma_f32_16x16x32_bf16 v[28:31], v[204:207], v[148:151], v[28:31]
  v_mfma_f32_16x16x32_bf16 v[32:35], v[204:207], v[152:155], v[32:35]
  v_mfma_f32_16x16x32_bf16 v[36:39], v[204:207], v[156:159], v[36:39]
  v_mfma_f32_16x16x32_bf16 v[40:43], v[208:211], v[148:151], v[40:43]
  s_barrier
  ds_read_b64_tr_b16 v[196:197], v230 offset:2048
  v_mfma_f32_16x16x32_bf16 v[44:47], v[208:211], v[152:155], v[44:47]
  ds_read_b64_tr_b16 v[198:199], v231 offset:2048
  ds_read_b64_tr_b16 v[200:201], v230 offset:0
  v_mfma_f32_16x16x32_bf16 v[48:51], v[208:211], v[156:159], v[48:51]
  ds_read_b64_tr_b16 v[202:203], v231 offset:0
  s_waitcnt lgkmcnt(8)
  v_mfma_f32_16x16x32_bf16 v[4:7], v[212:215], v[160:163], v[4:7]
  ds_read_b64_tr_b16 v[204:205], v230 offset:6144
  v_mfma_f32_16x16x32_bf16 v[8:11], v[212:215], v[164:167], v[8:11]
  ds_read_b64_tr_b16 v[206:207], v231 offset:6144
  v_mfma_f32_16x16x32_bf16 v[12:15], v[212:215], v[168:171], v[12:15]
  v_mfma_f32_16x16x32_bf16 v[16:19], v[216:219], v[160:163], v[16:19]
  ds_read_b64_tr_b16 v[208:209], v230 offset:4096
  v_mfma_f32_16x16x32_bf16 v[20:23], v[216:219], v[164:167], v[20:23]
  ds_read_b64_tr_b16 v[210:211], v231 offset:4096
  v_mfma_f32_16x16x32_bf16 v[24:27], v[216:219], v[168:171], v[24:27]
  s_waitcnt lgkmcnt(8)
  v_mfma_f32_16x16x32_bf16 v[28:31], v[220:223], v[160:163], v[28:31]
  v_mfma_f32_16x16x32_bf16 v[32:35], v[220:223], v[164:167], v[32:35]
  v_mfma_f32_16x16x32_bf16 v[36:39], v[220:223], v[168:171], v[36:39]
  v_mfma_f32_16x16x32_bf16 v[40:43], v[224:227], v[160:163], v[40:43]
  s_barrier
  ds_read_b64_tr_b16 v[212:213], v230 offset:18432
  v_mfma_f32_16x16x32_bf16 v[44:47], v[224:227], v[164:167], v[44:47]
  ds_read_b64_tr_b16 v[214:215], v231 offset:18432
  ds_read_b64_tr_b16 v[216:217], v230 offset:16384
  v_mfma_f32_16x16x32_bf16 v[48:51], v[224:227], v[168:171], v[48:51]
  ds_read_b64_tr_b16 v[218:219], v231 offset:16384
  s_waitcnt lgkmcnt(8)
  v_mfma_f32_16x16x32_bf16 v[40:43], v[196:199], v[172:175], v[40:43]
  ds_read_b64_tr_b16 v[220:221], v230 offset:22528
  v_mfma_f32_16x16x32_bf16 v[44:47], v[196:199], v[176:179], v[44:47]
  ds_read_b64_tr_b16 v[222:223], v231 offset:22528
  v_mfma_f32_16x16x32_bf16 v[48:51], v[196:199], v[180:183], v[48:51]
  ds_read_b128 v[160:163], v238 offset:320
  v_mfma_f32_16x16x32_bf16 v[28:31], v[200:203], v[172:175], v[28:31]
  ds_read_b64_tr_b16 v[224:225], v230 offset:20480
  v_mfma_f32_16x16x32_bf16 v[32:35], v[200:203], v[176:179], v[32:35]
  ds_read_b64_tr_b16 v[226:227], v231 offset:20480
  v_mfma_f32_16x16x32_bf16 v[36:39], v[200:203], v[180:183], v[36:39]
  ds_read_b128 v[164:167], v238 offset:256
  s_waitcnt lgkmcnt(10)
  v_mfma_f32_16x16x32_bf16 v[40:43], v[204:207], v[184:187], v[40:43]
  v_mfma_f32_16x16x32_bf16 v[44:47], v[204:207], v[188:191], v[44:47]
  v_mfma_f32_16x16x32_bf16 v[48:51], v[204:207], v[192:195], v[48:51]
  ds_read_b128 v[168:171], v238 offset:64
  v_mfma_f32_16x16x32_bf16 v[28:31], v[208:211], v[184:187], v[28:31]
  s_barrier
  ds_read_b64_tr_b16 v[196:197], v230 offset:34816
  v_mfma_f32_16x16x32_bf16 v[32:35], v[208:211], v[188:191], v[32:35]
  ds_read_b64_tr_b16 v[198:199], v231 offset:34816
  ds_read_b64_tr_b16 v[200:201], v230 offset:32768
  v_mfma_f32_16x16x32_bf16 v[36:39], v[208:211], v[192:195], v[36:39]
  ds_read_b64_tr_b16 v[202:203], v231 offset:32768
  ds_read_b128 v[232:235], v238
  s_waitcnt lgkmcnt(12)
  v_mfma_f32_16x16x32_bf16 v[40:43], v[212:215], v[52:55], v[40:43]
  ds_read_b64_tr_b16 v[204:205], v230 offset:38912
  ds_read_b64 v[148:149], v239 offset:32
  v_mfma_f32_16x16x32_bf16 v[44:47], v[212:215], v[56:59], v[44:47]
  ds_read_b64_tr_b16 v[206:207], v231 offset:38912
  ds_read_b64 v[150:151], v240 offset:32
  v_mfma_f32_16x16x32_bf16 v[48:51], v[212:215], v[60:63], v[48:51]
  ds_read_b64 v[152:153], v241 offset:32
  v_mfma_f32_16x16x32_bf16 v[28:31], v[216:219], v[52:55], v[28:31]
  ds_read_b64_tr_b16 v[208:209], v230 offset:36864
  ds_read_b64 v[154:155], v239 offset:0
  v_mfma_f32_16x16x32_bf16 v[32:35], v[216:219], v[56:59], v[32:35]
  ds_read_b64_tr_b16 v[210:211], v231 offset:36864
  ds_read_b64 v[156:157], v240 offset:0
  v_mfma_f32_16x16x32_bf16 v[36:39], v[216:219], v[60:63], v[36:39]
  ds_read_b64 v[158:159], v241 offset:0
  s_waitcnt lgkmcnt(15)
  v_mfma_f32_16x16x32_bf16 v[40:43], v[220:223], v[64:67], v[40:43]
  v_mfma_f32_16x16x32_bf16 v[44:47], v[220:223], v[68:71], v[44:47]
  v_mfma_f32_16x16x32_bf16 v[48:51], v[220:223], v[72:75], v[48:51]
  v_mfma_f32_16x16x32_bf16 v[28:31], v[224:227], v[64:67], v[28:31]
  s_barrier
  ds_read_b64_tr_b16 v[212:213], v230 offset:51200
  s_waitcnt lgkmcnt(9)
  v_lshlrev_b32_e64 v124, 16, v148
  v_mfma_f32_16x16x32_bf16 v[32:35], v[224:227], v[68:71], v[32:35]
  ds_read_b64_tr_b16 v[214:215], v231 offset:51200
  ds_read_b64_tr_b16 v[216:217], v230 offset:55296
  v_and_b32 v125, 0xffff0000, v148
  v_mfma_f32_16x16x32_bf16 v[36:39], v[224:227], v[72:75], v[36:39]
  ds_read_b64_tr_b16 v[218:219], v231 offset:55296
  v_mul_f32 v124, v124, v160
  v_mul_f32 v125, v125, v161
  v_mfma_f32_16x16x32_bf16 v[40:43], v[196:199], v[76:79], v[40:43]
  ds_read_b64_tr_b16 v[220:221], v230 offset:49152
  v_lshlrev_b32_e64 v126, 16, v149
  v_mfma_f32_16x16x32_bf16 v[44:47], v[196:199], v[80:83], v[44:47]
  ds_read_b64_tr_b16 v[222:223], v231 offset:49152
  v_and_b32 v127, 0xffff0000, v149
  v_mfma_f32_16x16x32_bf16 v[48:51], v[196:199], v[84:87], v[48:51]
  v_mul_f32 v126, v126, v162
  v_mul_f32 v127, v127, v163
  v_mfma_f32_16x16x32_bf16 v[28:31], v[200:203], v[76:79], v[28:31]
  ds_read_b64_tr_b16 v[224:225], v230 offset:53248
  s_waitcnt lgkmcnt(13)
  v_lshlrev_b32 v128, 16, v150
  v_mfma_f32_16x16x32_bf16 v[32:35], v[200:203], v[80:83], v[32:35]
  ds_read_b64_tr_b16 v[226:227], v231 offset:53248
  v_and_b32 v129, 0xffff0000, v150
  v_mfma_f32_16x16x32_bf16 v[36:39], v[200:203], v[84:87], v[36:39]
  v_mul_f32 v128, v128, v160
  v_mul_f32_e64 v129, v129, v161
  s_waitcnt lgkmcnt(10)
  v_mfma_f32_16x16x32_bf16 v[40:43], v[204:207], v[88:91], v[40:43]
  ds_read_b64_tr_b16 v[196:197], v228 offset:2048
  v_lshlrev_b32_e64 v130, 16, v151
  v_mfma_f32_16x16x32_bf16 v[44:47], v[204:207], v[92:95], v[44:47]
  ds_read_b64_tr_b16 v[198:199], v229 offset:2048
  v_and_b32 v131, 0xffff0000, v151
  v_mfma_f32_16x16x32_bf16 v[48:51], v[204:207], v[96:99], v[48:51]
  v_mul_f32 v130, v130, v162
  v_mul_f32 v131, v131, v163
  v_mfma_f32_16x16x32_bf16 v[28:31], v[208:211], v[88:91], v[28:31]
  ds_read_b64_tr_b16 v[200:201], v228 offset:6144
  v_lshlrev_b32_e64 v132, 16, v152
  v_mfma_f32_16x16x32_bf16 v[32:35], v[208:211], v[92:95], v[32:35]
  ds_read_b64_tr_b16 v[202:203], v229 offset:6144
  v_and_b32 v133, 0xffff0000, v152
  v_mfma_f32_16x16x32_bf16 v[36:39], v[208:211], v[96:99], v[36:39]
  v_mul_f32 v132, v132, v160
  v_mul_f32_e64 v133, v133, v161
  s_waitcnt lgkmcnt(8)
  v_mfma_f32_16x16x32_bf16 v[40:43], v[212:215], v[100:103], v[40:43]
  ds_read_b64_tr_b16 v[204:205], v228 offset:18432
  v_lshlrev_b32_e64 v134, 16, v153
  v_mfma_f32_16x16x32_bf16 v[44:47], v[212:215], v[104:107], v[44:47]
  ds_read_b64_tr_b16 v[206:207], v229 offset:18432
  v_and_b32 v135, 0xffff0000, v153
  v_mfma_f32_16x16x32_bf16 v[48:51], v[212:215], v[108:111], v[48:51]
  v_mul_f32 v134, v134, v162
  v_mul_f32 v135, v135, v163
  v_mfma_f32_16x16x32_bf16 v[40:43], v[216:219], v[112:115], v[40:43]
  ds_read_b64_tr_b16 v[208:209], v228 offset:22528
  v_lshlrev_b32_e64 v136, 16, v154
  v_mfma_f32_16x16x32_bf16 v[44:47], v[216:219], v[116:119], v[44:47]
  ds_read_b64_tr_b16 v[210:211], v229 offset:22528
  v_and_b32 v137, 0xffff0000, v154
  v_mfma_f32_16x16x32_bf16 v[48:51], v[216:219], v[120:123], v[48:51]
  v_mul_f32 v136, v136, v164
  v_mul_f32_e64 v137, v137, v165
  s_waitcnt lgkmcnt(8)
  v_mfma_f32_16x16x32_bf16 v[28:31], v[220:223], v[100:103], v[28:31]
  ds_read_b64_tr_b16 v[212:213], v228 offset:34816
  v_lshlrev_b32_e64 v138, 16, v155
  v_mfma_f32_16x16x32_bf16 v[32:35], v[220:223], v[104:107], v[32:35]
  ds_read_b64_tr_b16 v[214:215], v229 offset:34816
  v_and_b32 v139, 0xffff0000, v155
  v_mfma_f32_16x16x32_bf16 v[36:39], v[220:223], v[108:111], v[36:39]
  v_mul_f32 v138, v138, v166
  v_mul_f32 v139, v139, v167
  v_mfma_f32_16x16x32_bf16 v[28:31], v[224:227], v[112:115], v[28:31]
  ds_read_b64_tr_b16 v[216:217], v228 offset:38912
  v_lshlrev_b32_e64 v140, 16, v156
  v_mfma_f32_16x16x32_bf16 v[32:35], v[224:227], v[116:119], v[32:35]
  ds_read_b64_tr_b16 v[218:219], v229 offset:38912
  v_and_b32 v141, 0xffff0000, v156
  v_mfma_f32_16x16x32_bf16 v[36:39], v[224:227], v[120:123], v[36:39]
  ds_write_b128 v236, v[40:43] offset:3072
  v_mul_f32 v140, v140, v164
  s_waitcnt lgkmcnt(9)
  v_mfma_f32_16x16x32_bf16 v[16:19], v[196:199], v[172:175], v[16:19]
  ds_read_b64_tr_b16 v[220:221], v228 offset:51200
  v_mul_f32_e64 v141, v141, v165
  v_mfma_f32_16x16x32_bf16 v[20:23], v[196:199], v[176:179], v[20:23]
  ds_read_b64_tr_b16 v[222:223], v229 offset:51200
  v_lshlrev_b32_e64 v142, 16, v157
  v_mfma_f32_16x16x32_bf16 v[24:27], v[196:199], v[180:183], v[24:27]
  v_and_b32 v143, 0xffff0000, v157
  v_mul_f32_e64 v142, v142, v166
  v_mfma_f32_16x16x32_bf16 v[16:19], v[200:203], v[184:187], v[16:19]
  ds_read_b64_tr_b16 v[224:225], v228 offset:55296
  v_mul_f32_e64 v143, v143, v167
  v_mfma_f32_16x16x32_bf16 v[20:23], v[200:203], v[188:191], v[20:23]
  ds_read_b64_tr_b16 v[226:227], v229 offset:55296
  ds_write_b128 v236, v[44:47] offset:4096
  v_lshlrev_b32_e64 v144, 16, v158
  v_mfma_f32_16x16x32_bf16 v[24:27], v[200:203], v[192:195], v[24:27]
  v_and_b32 v145, 0xffff0000, v158
  v_mul_f32 v144, v144, v164
  s_waitcnt lgkmcnt(10)
  v_mfma_f32_16x16x32_bf16 v[16:19], v[204:207], v[52:55], v[16:19]
  ds_read_b64_tr_b16 v[196:197], v228 offset:0
  v_mul_f32_e64 v145, v145, v165
  v_mfma_f32_16x16x32_bf16 v[20:23], v[204:207], v[56:59], v[20:23]
  ds_read_b64_tr_b16 v[198:199], v229 offset:0
  v_lshlrev_b32_e64 v146, 16, v159
  v_mfma_f32_16x16x32_bf16 v[24:27], v[204:207], v[60:63], v[24:27]
  v_and_b32 v147, 0xffff0000, v159
  v_mul_f32_e64 v146, v146, v166
  v_mfma_f32_16x16x32_bf16 v[16:19], v[208:211], v[64:67], v[16:19]
  ds_read_b64_tr_b16 v[200:201], v228 offset:4096
  ds_write_b128 v236, v[48:51] offset:5120
  v_mul_f32_e64 v147, v147, v167
  v_mfma_f32_16x16x32_bf16 v[20:23], v[208:211], v[68:71], v[20:23]
  ds_read_b64_tr_b16 v[202:203], v229 offset:4096
  v_mfma_f32_16x16x32_bf16 v[24:27], v[208:211], v[72:75], v[24:27]
  s_waitcnt lgkmcnt(11)
  v_mfma_f32_16x16x32_bf16 v[16:19], v[212:215], v[76:79], v[16:19]
  ds_read_b64_tr_b16 v[204:205], v228 offset:16384
  v_mfma_f32_16x16x32_bf16 v[20:23], v[212:215], v[80:83], v[20:23]
  ds_read_b64_tr_b16 v[206:207], v229 offset:16384
  v_mfma_f32_16x16x32_bf16 v[24:27], v[212:215], v[84:87], v[24:27]
  ds_write_b128 v236, v[28:31] offset:0
  v_mfma_f32_16x16x32_bf16 v[16:19], v[216:219], v[88:91], v[16:19]
  ds_read_b64_tr_b16 v[208:209], v228 offset:20480
  v_mfma_f32_16x16x32_bf16 v[20:23], v[216:219], v[92:95], v[20:23]
  ds_read_b64_tr_b16 v[210:211], v229 offset:20480
  s_waitcnt lgkmcnt(6)
  s_barrier
  ds_read_b128 v[40:43], v237 offset:3072
  v_mfma_f32_16x16x32_bf16 v[24:27], v[216:219], v[96:99], v[24:27]
  ds_read_b128 v[44:47], v237 offset:4096
  v_mfma_f32_16x16x32_bf16 v[16:19], v[220:223], v[100:103], v[16:19]
  ds_read_b64_tr_b16 v[212:213], v228 offset:32768
  ds_read_b128 v[48:51], v237 offset:5120
  v_mfma_f32_16x16x32_bf16 v[20:23], v[220:223], v[104:107], v[20:23]
  ds_read_b64_tr_b16 v[214:215], v229 offset:32768
  ds_write_b128 v236, v[32:35] offset:1024
  v_mfma_f32_16x16x32_bf16 v[24:27], v[220:223], v[108:111], v[24:27]
  v_mfma_f32_16x16x32_bf16 v[16:19], v[224:227], v[112:115], v[16:19]
  ds_read_b64_tr_b16 v[216:217], v228 offset:36864
  v_mfma_f32_16x16x32_bf16 v[20:23], v[224:227], v[116:119], v[20:23]
  ds_read_b64_tr_b16 v[218:219], v229 offset:36864
  v_mfma_f32_16x16x32_bf16 v[24:27], v[224:227], v[120:123], v[24:27]
  s_waitcnt lgkmcnt(7)
  v_fmac_f32 v124, v168, v40
  v_fmac_f32 v125, v169, v41
  v_mfma_f32_16x16x32_bf16 v[4:7], v[196:199], v[172:175], v[4:7]
  ds_read_b64_tr_b16 v[220:221], v228 offset:49152
  ds_write_b128 v236, v[36:39] offset:2048
  v_fmac_f32_e64 v126, v170, v42
  v_mfma_f32_16x16x32_bf16 v[8:11], v[196:199], v[176:179], v[8:11]
  ds_read_b64_tr_b16 v[222:223], v229 offset:49152
  v_fmac_f32_e64 v127, v171, v43
  v_mfma_f32_16x16x32_bf16 v[12:15], v[196:199], v[180:183], v[12:15]
  s_waitcnt lgkmcnt(9)
  v_fmac_f32 v128, v168, v44
  v_fmac_f32_e64 v129, v169, v45
  v_mfma_f32_16x16x32_bf16 v[4:7], v[200:203], v[184:187], v[4:7]
  ds_read_b64_tr_b16 v[224:225], v228 offset:53248
  v_fmac_f32 v130, v170, v46
  v_fmac_f32 v131, v171, v47
  v_mfma_f32_16x16x32_bf16 v[8:11], v[200:203], v[188:191], v[8:11]
  ds_read_b64_tr_b16 v[226:227], v229 offset:53248
  s_waitcnt lgkmcnt(9)
  v_fmac_f32 v132, v168, v48
  v_fmac_f32_e64 v133, v169, v49
  v_mfma_f32_16x16x32_bf16 v[12:15], v[200:203], v[192:195], v[12:15]
  v_fmac_f32 v134, v170, v50
  v_fmac_f32 v135, v171, v51
  v_mfma_f32_16x16x32_bf16 v[4:7], v[204:207], v[52:55], v[4:7]
  s_waitcnt lgkmcnt(3)
  s_barrier
  ds_read_b128 v[28:31], v237 offset:0
  v_fma_f32 v40, v168, v16, v124
  v_mfma_f32_16x16x32_bf16 v[8:11], v[204:207], v[56:59], v[8:11]
  ds_read_b128 v[32:35], v237 offset:1024
  v_fma_f32 v41, v168, v20, v128
  v_mfma_f32_16x16x32_bf16 v[12:15], v[204:207], v[60:63], v[12:15]
  ds_read_b128 v[36:39], v237 offset:2048
  v_fma_f32 v42, v168, v24, v132
  v_mfma_f32_16x16x32_bf16 v[4:7], v[208:211], v[64:67], v[4:7]
  buffer_store_dwordx3 v[40:42], v242, s[80:83], s18 offen offset:0 sc1
  v_fma_f32 v44, v169, v17, v125
  v_mfma_f32_16x16x32_bf16 v[8:11], v[208:211], v[68:71], v[8:11]
  v_fma_f32 v45, v169, v21, v129
  v_fma_f32 v46, v169, v25, v133
  v_mfma_f32_16x16x32_bf16 v[12:15], v[208:211], v[72:75], v[12:15]
  buffer_store_dwordx3 v[44:46], v242, s[80:83], s18 offen offset:2304 sc1
  v_fma_f32 v48, v170, v18, v126
  v_mfma_f32_16x16x32_bf16 v[4:7], v[212:215], v[76:79], v[4:7]
  v_fma_f32 v49, v170, v22, v130
  v_fma_f32 v50, v170, v26, v134
  v_mfma_f32_16x16x32_bf16 v[8:11], v[212:215], v[80:83], v[8:11]
  buffer_store_dwordx3 v[48:50], v242, s[80:83], s19 offen offset:0 sc1
  v_fma_f32 v148, v171, v19, v127
  v_mfma_f32_16x16x32_bf16 v[12:15], v[212:215], v[84:87], v[12:15]
  v_fma_f32 v149, v171, v23, v131
  v_fma_f32 v150, v171, v27, v135
  v_mfma_f32_16x16x32_bf16 v[4:7], v[216:219], v[88:91], v[4:7]
  buffer_store_dwordx3 v[148:150], v242, s[80:83], s19 offen offset:2304 sc1
  s_waitcnt lgkmcnt(2)
  v_fmac_f32 v136, v232, v28
  v_mfma_f32_16x16x32_bf16 v[8:11], v[216:219], v[92:95], v[8:11]
  v_fmac_f32 v137, v233, v29
  v_fmac_f32 v138, v234, v30
  v_mfma_f32_16x16x32_bf16 v[12:15], v[216:219], v[96:99], v[12:15]
  v_fmac_f32 v139, v235, v31
  s_waitcnt lgkmcnt(1)
  v_fmac_f32_e64 v140, v232, v32
  v_mfma_f32_16x16x32_bf16 v[4:7], v[220:223], v[100:103], v[4:7]
  v_fmac_f32 v141, v233, v33
  v_fmac_f32 v142, v234, v34
  v_mfma_f32_16x16x32_bf16 v[8:11], v[220:223], v[104:107], v[8:11]
  v_fmac_f32 v143, v235, v35
  s_waitcnt lgkmcnt(0)
  v_fmac_f32_e64 v144, v232, v36
  v_mfma_f32_16x16x32_bf16 v[12:15], v[220:223], v[108:111], v[12:15]
  v_fmac_f32 v145, v233, v37
  v_fmac_f32 v146, v234, v38
  v_mfma_f32_16x16x32_bf16 v[4:7], v[224:227], v[112:115], v[4:7]
  v_fmac_f32_e64 v147, v235, v39
  v_mfma_f32_16x16x32_bf16 v[8:11], v[224:227], v[116:119], v[8:11]
  v_mfma_f32_16x16x32_bf16 v[12:15], v[224:227], v[120:123], v[12:15]
  s_nop 4
  v_fma_f32 v16, v232, v4, v136
  s_nop 0
  v_fma_f32 v17, v232, v8, v140
  v_fma_f32 v18, v232, v12, v144
  buffer_store_dwordx3 v[16:18], v242, s[80:83], s16 offen offset:0 sc1
  v_fma_f32 v20, v233, v5, v137
  v_fma_f32 v21, v233, v9, v141
  v_fma_f32 v22, v233, v13, v145
  buffer_store_dwordx3 v[20:22], v242, s[80:83], s16 offen offset:2304 sc1
  v_fma_f32 v24, v234, v6, v138
  v_fma_f32 v25, v234, v10, v142
  v_fma_f32 v26, v234, v14, v146
  buffer_store_dwordx3 v[24:26], v242, s[80:83], s17 offen offset:0 sc1
  v_fma_f32 v28, v235, v7, v139
  v_fma_f32 v29, v235, v11, v143
  v_fma_f32 v30, v235, v15, v147
  buffer_store_dwordx3 v[28:30], v242, s[80:83], s17 offen offset:2304 sc1
  s_endpgm
L_conv:
  s_mul_i32 s88, s4, 72
  s_cmp_ge_u32 s5, 24
  s_cselect_b32 s94, 3, 2
  s_cmp_ge_u32 s4, 3
  s_cselect_b32 s8, 4, 8
  s_cmp_ge_u32 s4, 6
  s_cselect_b32 s8, 0, s8
  s_sub_u32 s6, s5, 24
  s_cmp_ge_u32 s6, s8
  s_cselect_b32 s7, 24, 0
  s_mul_i32 s6, s6, 6
  s_add_u32 s6, s6, s7
  s_mul_i32 s8, s8, 6
  s_lshl_b32 s7, s5, 2
  s_add_u32 s8, s8, s7
  s_sub_u32 s8, s8, 72
  s_cmp_ge_u32 s5, 24
  s_cselect_b32 s6, s6, s8
  s_add_u32 s88, s88, s6
  s_mov_b32 s100, 0x55555555
  s_mov_b32 s101, 0x55555555
  s_lshl_b32 s89, s3, 13
  s_add_u32 s89, s89, 90112
  s_cmp_ge_u32 s3, 4
  s_cbranch_scc1 L_CK
  s_waitcnt lgkmcnt(0)
  s_add_u32 s90, s88, s76
  s_lshl_b32 s7, s90, 8
  v_lshl_add_u32 v33, v1, 1, s7
  global_load_ushort v24, v33, s[18:19] offset:0
  global_load_ushort v25, v33, s[20:21] offset:0
  global_load_ushort v26, v33, s[22:23] offset:0
  global_load_ushort v27, v33, s[24:25] offset:0
  s_lshl_b32 s7, s90, 1
  v_mov_b32 v33, s7
  global_load_ushort v32, v33, s[26:27] offset:0
  s_lshl_b32 s7, s90, 8
  v_lshl_add_u32 v33, v1, 1, s7
  global_load_ushort v28, v33, s[18:19] offset:128
  global_load_ushort v29, v33, s[20:21] offset:128
  global_load_ushort v30, v33, s[22:23] offset:128
  global_load_ushort v31, v33, s[24:25] offset:128
  s_lshl_b32 s7, s90, 1
  v_mov_b32_e64 v33, s7
  global_load_ushort v12, v33, s[28:29] offset:0
  s_waitcnt lgkmcnt(0)
  v_lshlrev_b32 v3, 2, v1
  s_mul_i32 s8, s5, 43
  s_lshr_b32 s8, s8, 8
  s_mul_i32 s9, s8, 6
  s_sub_u32 s12, s5, s9
  s_lshl_b32 s11, s4, 2
  s_add_u32 s11, s11, s8
  s_and_b32 s13, s12, 1
  s_mul_i32 s13, s13, 0
  s_mul_i32 s8, s8, 0
  s_add_u32 s13, s13, s8
  s_add_u32 s13, s13, s4
  s_mul_i32 s8, s13, 57
  s_lshr_b32 s8, s8, 9
  s_mul_i32 s8, s8, 9
  s_sub_u32 s13, s13, s8
  s_mov_b64 s[60:61], s[54:55]
  s_mov_b32 s62, 16777216
  s_mov_b32 s63, 0x20000
  s_cmp_eq_u32 s78, 0
  s_cselect_b32 s72, s40, s42
  s_cselect_b32 s73, s41, s43
  s_mov_b32 s74, 663552
  s_mov_b32 s75, 0x20000
  s_mov_b32 s80, s50
  s_and_b32 s81, s51, 0xffff
  s_mov_b32 s82, 4718592
  s_mov_b32 s83, 0x20000
  v_lshl_add_u32 v42, v1, 6, s89
  v_bfe_u32 v43, v1, 1, 2
  v_lshlrev_b32 v43, 4, v43
  v_add_u32 v36, v42, v43
  v_xor_b32 v44, 16, v43
  v_add_u32 v37, v42, v44
  v_xor_b32 v44, 32, v43
  v_add_u32 v38, v42, v44
  v_xor_b32 v44, 48, v43
  v_add_u32 v39, v42, v44
  v_lshrrev_b32_e64 v42, 5, v1
  v_lshl_add_u32 v42, v42, 12, s89
  v_bfe_u32 v43, v1, 2, 2
  v_lshl_add_u32 v42, v43, 6, v42
  v_and_b32_e64 v43, 1, v1
  v_lshl_add_u32 v42, v43, 3, v42
  v_bfe_u32 v43, v1, 3, 2
  v_bfe_u32 v44, v1, 1, 1
  v_xor_b32_e64 v43, v43, v44
  v_lshl_add_u32 v40, v43, 4, v42
  v_xor_b32_e64 v43, 2, v43
  v_lshl_add_u32 v41, v43, 4, v42
  v_add_u32 v41, 256, v41
  s_mul_i32 s9, s76, 4800
  s_add_u32 s9, s9, 18432
  s_add_u32 s6, s9, 32
  v_and_b32 v47, 31, v1
  v_lshrrev_b32_e64 v46, 5, v1
  v_lshl_add_u32 v45, v47, 4, s6
  v_lshl_add_u32 v42, v46, 3, v45
  v_lshl_add_u32 v43, v46, 9, v45
  s_add_u32 s6, s9, 4544
  v_lshrrev_b32_e64 v47, 1, v47
  v_lshl_add_u32 v45, v47, 2, s6
  v_lshl_add_u32 v44, v46, 7, v45
  v_mov_b32 v48, 0
  v_mov_b32 v49, 0
  v_mov_b32 v50, 0
  v_mov_b32 v51, 0
  v_add_u32 v52, -32, v42
  s_mov_b64 exec, 15
  ds_write_b128 v52, v[48:51] offset:0
  ds_write_b128 v52, v[48:51] offset:2080
  ds_write_b128 v52, v[48:51] offset:2240
  ds_write_b128 v52, v[48:51] offset:4320
  ds_write_b128 v52, v[48:51] offset:4480
  s_mov_b64 exec, -1
  v_and_b32 v45, 15, v1
  v_lshrrev_b32 v46, 4, v1
  v_add_u32 v47, 1, v45
  v_lshrrev_b32 v47, 1, v47
  v_lshl_add_u32 v47, v46, 2, v47
  v_lshlrev_b32_e64 v47, 2, v47
  v_add_u32 v14, 2240, v47
  v_cndmask_b32 v47, v47, v14, s[100:101]
  v_add_u32_e64 v14, s9, v47
  v_add_u32 v15, 1024, v14
  v_add_u32 v16, 2048, v14
  s_add_u32 s6, s9, 4532
  v_lshlrev_b32 v47, 2, v46
  v_sub_u32 v47, v45, v47
  v_lshl_add_u32 v17, v47, 2, s6
  s_mul_i32 s93, s78, 4800
  s_add_u32 s93, s93, 63232
  s_sub_u32 s93, s93, s9
  s_lshl_b32 s7, s77, 8
  s_sub_u32 s7, s7, 256
  s_add_u32 s94, s93, s7
  s_mul_i32 s6, s76, 4608
  s_mul_i32 s92, s78, 4608
  s_add_u32 s92, s92, 54016
  s_sub_u32 s92, s92, s6
  s_sub_u32 s92, s92, s7
  s_add_u32 s6, s6, 336
  v_lshlrev_b32 v47, 1, v45
  v_sub_u32_e64 v47, v47, v46
  v_lshl_add_u32 v18, v47, 4, s6
  v_bfe_u32 v47, v1, 1, 2
  v_xor_b32 v47, v47, v46
  v_lshlrev_b32 v47, 4, v47
  v_lshl_add_u32 v47, v45, 6, v47
  v_add_u32_e64 v19, s89, v47
  v_bfe_u32 v47, v1, 2, 1
  v_lshlrev_b32 v47, 1, v47
  v_xor_b32 v47, v47, v46
  v_lshlrev_b32_e64 v47, 3, v47
  v_lshl_add_u32 v47, v45, 5, v47
  s_lshl_b32 s6, s76, 12
  s_add_u32 s6, s6, 37632
  v_add_u32 v20, s6, v47
  v_lshl_add_u32 v45, v46, 3, v45
  v_min_u32_e64 v45, 31, v45
  s_mov_b32 s6, 0x3f80
  v_mov_b32 v46, 133169152
  v_lshrrev_b32_e64 v46, v45, v46
  v_bfe_u32 v47, v46, 0, 1
  v_bfe_u32 v48, v46, 1, 1
  v_lshl_add_u32 v47, v48, 16, v47
  v_mul_u32_u24_e64 v4, s6, v47
  v_bfe_u32 v47, v46, 2, 1
  v_bfe_u32 v48, v46, 3, 1
  v_lshl_add_u32 v47, v48, 16, v47
  v_mul_u32_u24_e64 v5, s6, v47
  v_bfe_u32 v47, v46, 4, 1
  v_bfe_u32 v48, v46, 5, 1
  v_lshl_add_u32 v47, v48, 16, v47
  v_mul_u32_u24_e64 v6, s6, v47
  v_bfe_u32 v47, v46, 6, 1
  v_bfe_u32 v48, v46, 7, 1
  v_lshl_add_u32 v47, v48, 16, v47
  v_mul_u32_u24_e64 v7, s6, v47
  v_mov_b32 v46, 267911168
  v_lshrrev_b32_e64 v46, v45, v46
  v_bfe_u32 v47, v46, 0, 1
  v_bfe_u32 v48, v46, 1, 1
  v_lshl_add_u32 v47, v48, 16, v47
  v_mul_u32_u24_e64 v8, s6, v47
  v_bfe_u32 v47, v46, 2, 1
  v_bfe_u32 v48, v46, 3, 1
  v_lshl_add_u32 v47, v48, 16, v47
  v_mul_u32_u24_e64 v9, s6, v47
  v_bfe_u32 v47, v46, 4, 1
  v_bfe_u32 v48, v46, 5, 1
  v_lshl_add_u32 v47, v48, 16, v47
  v_mul_u32_u24_e64 v10, s6, v47
  v_bfe_u32 v47, v46, 6, 1
  v_bfe_u32 v48, v46, 7, 1
  v_lshl_add_u32 v47, v48, 16, v47
  v_mul_u32_u24 v11, s6, v47
  s_waitcnt vmcnt(5)
  v_lshlrev_b32_e64 v45, 16, v32
  v_mul_f32 v45, 0x3fb8aa3b, v45
  v_exp_f32 v45, v45
  s_nop 0
  v_cvt_pk_bf16_f32 v45, 0, v45
  v_lshlrev_b32 v24, 16, v24
  v_lshlrev_b32 v25, 16, v25
  v_lshlrev_b32 v26, 16, v26
  v_lshlrev_b32 v27, 16, v27
  v_mul_f32 v64, 0x3fb8aa3b, v24
  v_exp_f32 v64, v64
  v_mul_f32 v65, v45, v25
  v_cvt_pk_bf16_f32 v64, 0, v64
  v_mul_f32 v65, 0.15915494, v65
  v_mul_f32 v64, v45, v64
  v_add_f32_e64 v66, v45, v45
  v_mul_f32 v64, 0xbfb8aa3b, v64
  v_mul_f32 v74, v66, v26
  v_mul_f32 v75, v66, v27
  v_exp_f32 v66, v64
  v_fract_f32 v67, v65
  v_cos_f32 v68, v67
  v_sin_f32 v69, v67
  v_mul_f32 v68, v68, v66
  v_mul_f32 v69, v69, v66
  v_mul_f32 v66, 0x43800000, v64
  v_mul_f32 v67, 0x43800000, v65
  v_exp_f32 v66, v66
  v_fract_f32 v67, v67
  v_cos_f32 v72, v67
  v_sin_f32 v73, v67
  v_mul_f32 v72, v72, v66
  v_mul_f32 v73, v73, v66
  v_mul_f32 v66, 0x41000000, v64
  v_mul_f32 v67, 0x41000000, v65
  v_exp_f32 v66, v66
  v_fract_f32 v67, v67
  v_cos_f32 v70, v67
  v_sin_f32 v71, v67
  v_mul_f32 v70, v70, v66
  v_mul_f32 v71, v71, v66
  v_pk_mul_f32 v[76:77], v[74:75], v[68:69] op_sel_hi:[1,0]
  v_pk_fma_f32 v[76:77], v[74:75], v[68:69], v[76:77] op_sel:[1,1,0] op_sel_hi:[0,1,1] neg_lo:[1,0,0]
  v_pk_mul_f32 v[78:79], v[76:77], v[68:69] op_sel_hi:[1,0]
  v_pk_fma_f32 v[78:79], v[76:77], v[68:69], v[78:79] op_sel:[1,1,0] op_sel_hi:[0,1,1] neg_lo:[1,0,0]
  v_pk_mul_f32 v[80:81], v[78:79], v[68:69] op_sel_hi:[1,0]
  v_pk_fma_f32 v[80:81], v[78:79], v[68:69], v[80:81] op_sel:[1,1,0] op_sel_hi:[0,1,1] neg_lo:[1,0,0]
  v_pk_mul_f32 v[82:83], v[80:81], v[68:69] op_sel_hi:[1,0]
  v_pk_fma_f32 v[82:83], v[80:81], v[68:69], v[82:83] op_sel:[1,1,0] op_sel_hi:[0,1,1] neg_lo:[1,0,0]
  v_pk_mul_f32 v[84:85], v[82:83], v[68:69] op_sel_hi:[1,0]
  v_pk_fma_f32 v[84:85], v[82:83], v[68:69], v[84:85] op_sel:[1,1,0] op_sel_hi:[0,1,1] neg_lo:[1,0,0]
  v_pk_mul_f32 v[86:87], v[84:85], v[68:69] op_sel_hi:[1,0]
  v_pk_fma_f32 v[86:87], v[84:85], v[68:69], v[86:87] op_sel:[1,1,0] op_sel_hi:[0,1,1] neg_lo:[1,0,0]
  v_pk_mul_f32 v[88:89], v[86:87], v[68:69] op_sel_hi:[1,0]
  v_pk_fma_f32 v[88:89], v[86:87], v[68:69], v[88:89] op_sel:[1,1,0] op_sel_hi:[0,1,1] neg_lo:[1,0,0]
  v_cvt_pk_bf16_f32 v132, v74, v76
  v_cvt_pk_bf16_f32 v133, v78, v80
  v_cvt_pk_bf16_f32 v134, v82, v84
  v_cvt_pk_bf16_f32 v135, v86, v88
  v_cvt_pk_bf16_f32 v136, -v75, -v77
  v_cvt_pk_bf16_f32 v137, -v79, -v81
  v_cvt_pk_bf16_f32 v138, -v83, -v85
  v_cvt_pk_bf16_f32 v139, -v87, -v89
  ds_write_b128 v36, v[132:135]
  v_pk_mul_f32 v[90:91], v[88:89], v[68:69] op_sel_hi:[1,0]
  v_pk_fma_f32 v[90:91], v[88:89], v[68:69], v[90:91] op_sel:[1,1,0] op_sel_hi:[0,1,1] neg_lo:[1,0,0]
  v_pk_mul_f32 v[92:93], v[74:75], v[72:73] op_sel_hi:[1,0]
  v_pk_fma_f32 v[92:93], v[74:75], v[72:73], v[92:93] op_sel:[1,1,0] op_sel_hi:[0,1,1] neg_lo:[1,0,0]
  v_pk_mul_f32 v[94:95], v[78:79], v[72:73] op_sel_hi:[1,0]
  v_pk_fma_f32 v[94:95], v[78:79], v[72:73], v[94:95] op_sel:[1,1,0] op_sel_hi:[0,1,1] neg_lo:[1,0,0]
  v_pk_mul_f32 v[96:97], v[82:83], v[72:73] op_sel_hi:[1,0]
  v_pk_fma_f32 v[96:97], v[82:83], v[72:73], v[96:97] op_sel:[1,1,0] op_sel_hi:[0,1,1] neg_lo:[1,0,0]
  v_pk_mul_f32 v[98:99], v[86:87], v[72:73] op_sel_hi:[1,0]
  v_pk_fma_f32 v[98:99], v[86:87], v[72:73], v[98:99] op_sel:[1,1,0] op_sel_hi:[0,1,1] neg_lo:[1,0,0]
  ds_write_b128 v36, v[136:139] offset:4096
  v_pk_mul_f32 v[100:101], v[90:91], v[72:73] op_sel_hi:[1,0]
  v_pk_fma_f32 v[100:101], v[90:91], v[72:73], v[100:101] op_sel:[1,1,0] op_sel_hi:[0,1,1] neg_lo:[1,0,0]
  v_cvt_pk_bf16_f32 v140, v82, v92
  v_cvt_pk_bf16_f32 v141, v94, v96
  v_cvt_pk_bf16_f32 v142, v90, v96
  v_cvt_pk_bf16_f32 v143, v98, v100
  v_cvt_pk_bf16_f32 v144, -v83, -v93
  v_cvt_pk_bf16_f32 v145, -v95, -v97
  v_cvt_pk_bf16_f32 v146, -v91, -v97
  v_cvt_pk_bf16_f32 v147, -v99, -v101
  ds_write_b128 v37, v[140:143]
  v_pk_mul_f32 v[102:103], v[92:93], v[72:73] op_sel_hi:[1,0]
  v_pk_fma_f32 v[102:103], v[92:93], v[72:73], v[102:103] op_sel:[1,1,0] op_sel_hi:[0,1,1] neg_lo:[1,0,0]
  v_pk_mul_f32 v[104:105], v[96:97], v[72:73] op_sel_hi:[1,0]
  v_pk_fma_f32 v[104:105], v[96:97], v[72:73], v[104:105] op_sel:[1,1,0] op_sel_hi:[0,1,1] neg_lo:[1,0,0]
  v_pk_mul_f32 v[106:107], v[100:101], v[72:73] op_sel_hi:[1,0]
  v_pk_fma_f32 v[106:107], v[100:101], v[72:73], v[106:107] op_sel:[1,1,0] op_sel_hi:[0,1,1] neg_lo:[1,0,0]
  v_pk_mul_f32 v[108:109], v[102:103], v[72:73] op_sel_hi:[1,0]
  v_pk_fma_f32 v[108:109], v[102:103], v[72:73], v[108:109] op_sel:[1,1,0] op_sel_hi:[0,1,1] neg_lo:[1,0,0]
  v_pk_mul_f32 v[110:111], v[104:105], v[72:73] op_sel_hi:[1,0]
  v_pk_fma_f32 v[110:111], v[104:105], v[72:73], v[110:111] op_sel:[1,1,0] op_sel_hi:[0,1,1] neg_lo:[1,0,0]
  ds_write_b128 v37, v[144:147] offset:4096
  v_pk_mul_f32 v[112:113], v[106:107], v[72:73] op_sel_hi:[1,0]
  v_pk_fma_f32 v[112:113], v[106:107], v[72:73], v[112:113] op_sel:[1,1,0] op_sel_hi:[0,1,1] neg_lo:[1,0,0]
  v_pk_mul_f32 v[114:115], v[108:109], v[72:73] op_sel_hi:[1,0]
  v_pk_fma_f32 v[114:115], v[108:109], v[72:73], v[114:115] op_sel:[1,1,0] op_sel_hi:[0,1,1] neg_lo:[1,0,0]
  v_pk_mul_f32 v[116:117], v[112:113], v[72:73] op_sel_hi:[1,0]
  v_pk_fma_f32 v[116:117], v[112:113], v[72:73], v[116:117] op_sel:[1,1,0] op_sel_hi:[0,1,1] neg_lo:[1,0,0]
  v_pk_mul_f32 v[118:119], v[114:115], v[72:73] op_sel_hi:[1,0]
  v_pk_fma_f32 v[118:119], v[114:115], v[72:73], v[118:119] op_sel:[1,1,0] op_sel_hi:[0,1,1] neg_lo:[1,0,0]
  v_pk_mul_f32 v[120:121], v[116:117], v[72:73] op_sel_hi:[1,0]
  v_pk_fma_f32 v[120:121], v[116:117], v[72:73], v[120:121] op_sel:[1,1,0] op_sel_hi:[0,1,1] neg_lo:[1,0,0]
  v_pk_mul_f32 v[122:123], v[118:119], v[72:73] op_sel_hi:[1,0]
  v_pk_fma_f32 v[122:123], v[118:119], v[72:73], v[122:123] op_sel:[1,1,0] op_sel_hi:[0,1,1] neg_lo:[1,0,0]
  v_pk_mul_f32 v[124:125], v[120:121], v[72:73] op_sel_hi:[1,0]
  v_pk_fma_f32 v[124:125], v[120:121], v[72:73], v[124:125] op_sel:[1,1,0] op_sel_hi:[0,1,1] neg_lo:[1,0,0]
  v_pk_mul_f32 v[126:127], v[122:123], v[72:73] op_sel_hi:[1,0]
  v_pk_fma_f32 v[126:127], v[122:123], v[72:73], v[126:127] op_sel:[1,1,0] op_sel_hi:[0,1,1] neg_lo:[1,0,0]
  v_pk_mul_f32 v[128:129], v[124:125], v[72:73] op_sel_hi:[1,0]
  v_pk_fma_f32 v[128:129], v[124:125], v[72:73], v[128:129] op_sel:[1,1,0] op_sel_hi:[0,1,1] neg_lo:[1,0,0]
  v_cvt_pk_bf16_f32 v132, v102, v104
  v_cvt_pk_bf16_f32 v133, v106, v114
  v_cvt_pk_bf16_f32 v134, v108, v110
  v_cvt_pk_bf16_f32 v135, v112, v122
  v_cvt_pk_bf16_f32 v136, -v103, -v105
  v_cvt_pk_bf16_f32 v137, -v107, -v115
  v_cvt_pk_bf16_f32 v138, -v109, -v111
  v_cvt_pk_bf16_f32 v139, -v113, -v123
  ds_write_b128 v38, v[132:135]
  v_cvt_pk_bf16_f32 v140, v116, v118
  v_cvt_pk_bf16_f32 v141, v120, v120
  v_cvt_pk_bf16_f32 v142, v124, v126
  v_cvt_pk_bf16_f32 v143, v128, v128
  v_cvt_pk_bf16_f32 v144, -v117, -v119
  v_cvt_pk_bf16_f32 v145, -v121, -v121
  v_cvt_pk_bf16_f32 v146, -v125, -v127
  v_cvt_pk_bf16_f32 v147, -v129, -v129
  v_pk_mul_f32 v[78:79], v[70:71], v[70:71] op_sel_hi:[1,0]
  v_pk_fma_f32 v[78:79], v[70:71], v[70:71], v[78:79] op_sel:[1,1,0] op_sel_hi:[0,1,1] neg_lo:[1,0,0]
  ds_write_b128 v38, v[136:139] offset:4096
  v_pk_mul_f32 v[80:81], v[78:79], v[70:71] op_sel_hi:[1,0]
  v_pk_fma_f32 v[80:81], v[78:79], v[70:71], v[80:81] op_sel:[1,1,0] op_sel_hi:[0,1,1] neg_lo:[1,0,0]
  v_pk_mul_f32 v[82:83], v[80:81], v[70:71] op_sel_hi:[1,0]
  v_pk_fma_f32 v[82:83], v[80:81], v[70:71], v[82:83] op_sel:[1,1,0] op_sel_hi:[0,1,1] neg_lo:[1,0,0]
  v_pk_mul_f32 v[84:85], v[82:83], v[70:71] op_sel_hi:[1,0]
  v_pk_fma_f32 v[84:85], v[82:83], v[70:71], v[84:85] op_sel:[1,1,0] op_sel_hi:[0,1,1] neg_lo:[1,0,0]
  v_pk_mul_f32 v[86:87], v[84:85], v[70:71] op_sel_hi:[1,0]
  v_pk_fma_f32 v[86:87], v[84:85], v[70:71], v[86:87] op_sel:[1,1,0] op_sel_hi:[0,1,1] neg_lo:[1,0,0]
  v_pk_mul_f32 v[88:89], v[86:87], v[70:71] op_sel_hi:[1,0]
  v_pk_fma_f32 v[88:89], v[86:87], v[70:71], v[88:89] op_sel:[1,1,0] op_sel_hi:[0,1,1] neg_lo:[1,0,0]
  ds_write_b128 v39, v[140:143]
  v_cvt_pk_bf16_f32 v132, 1.0, v70
  v_cvt_pk_bf16_f32 v133, v78, v80
  v_cvt_pk_bf16_f32 v134, v82, v84
  v_cvt_pk_bf16_f32 v135, v86, v88
  v_cvt_pk_bf16_f32 v136, 0, v71
  v_cvt_pk_bf16_f32 v137, v79, v81
  v_cvt_pk_bf16_f32 v138, v83, v85
  v_cvt_pk_bf16_f32 v139, v87, v89
  v_pk_mul_f32 v[90:91], v[88:89], v[70:71] op_sel_hi:[1,0]
  v_pk_fma_f32 v[90:91], v[88:89], v[70:71], v[90:91] op_sel:[1,1,0] op_sel_hi:[0,1,1] neg_lo:[1,0,0]
  ds_write_b128 v39, v[144:147] offset:4096
  ds_read_b64_tr_b16 v[148:149], v40 offset:0
  ds_read_b64_tr_b16 v[150:151], v41 offset:0
  ds_read_b64_tr_b16 v[152:153], v40 offset:512
  ds_read_b64_tr_b16 v[154:155], v41 offset:512
  ds_read_b64_tr_b16 v[156:157], v40 offset:1024
  ds_read_b64_tr_b16 v[158:159], v41 offset:1024
  ds_read_b64_tr_b16 v[160:161], v40 offset:1536
  ds_read_b64_tr_b16 v[162:163], v41 offset:1536
  v_pk_mul_f32 v[74:75], v[90:91], v[70:71] op_sel_hi:[1,0]
  v_pk_fma_f32 v[74:75], v[90:91], v[70:71], v[74:75] op_sel:[1,1,0] op_sel_hi:[0,1,1] neg_lo:[1,0,0]
  v_pk_mul_f32 v[76:77], v[74:75], v[70:71] op_sel_hi:[1,0]
  v_pk_fma_f32 v[76:77], v[74:75], v[70:71], v[76:77] op_sel:[1,1,0] op_sel_hi:[0,1,1] neg_lo:[1,0,0]
  v_pk_mul_f32 v[78:79], v[76:77], v[70:71] op_sel_hi:[1,0]
  v_pk_fma_f32 v[78:79], v[76:77], v[70:71], v[78:79] op_sel:[1,1,0] op_sel_hi:[0,1,1] neg_lo:[1,0,0]
  v_pk_mul_f32 v[80:81], v[78:79], v[70:71] op_sel_hi:[1,0]
  v_pk_fma_f32 v[80:81], v[78:79], v[70:71], v[80:81] op_sel:[1,1,0] op_sel_hi:[0,1,1] neg_lo:[1,0,0]
  v_pk_mul_f32 v[82:83], v[80:81], v[70:71] op_sel_hi:[1,0]
  v_pk_fma_f32 v[82:83], v[80:81], v[70:71], v[82:83] op_sel:[1,1,0] op_sel_hi:[0,1,1] neg_lo:[1,0,0]
  ds_read_b64_tr_b16 v[164:165], v40 offset:2048
  ds_read_b64_tr_b16 v[166:167], v41 offset:2048
  ds_read_b64_tr_b16 v[168:169], v40 offset:2560
  ds_read_b64_tr_b16 v[170:171], v41 offset:2560
  ds_read_b64_tr_b16 v[172:173], v40 offset:3072
  ds_read_b64_tr_b16 v[174:175], v41 offset:3072
  ds_read_b64_tr_b16 v[176:177], v40 offset:3584
  ds_read_b64_tr_b16 v[178:179], v41 offset:3584
  v_pk_mul_f32 v[84:85], v[82:83], v[70:71] op_sel_hi:[1,0]
  v_pk_fma_f32 v[84:85], v[82:83], v[70:71], v[84:85] op_sel:[1,1,0] op_sel_hi:[0,1,1] neg_lo:[1,0,0]
  v_pk_mul_f32 v[86:87], v[84:85], v[70:71] op_sel_hi:[1,0]
  v_pk_fma_f32 v[86:87], v[84:85], v[70:71], v[86:87] op_sel:[1,1,0] op_sel_hi:[0,1,1] neg_lo:[1,0,0]
  v_cvt_pk_bf16_f32 v140, v90, v74
  v_cvt_pk_bf16_f32 v141, v76, v78
  v_cvt_pk_bf16_f32 v142, v80, v82
  v_cvt_pk_bf16_f32 v143, v84, v86
  v_cvt_pk_bf16_f32 v144, v91, v75
  v_cvt_pk_bf16_f32 v145, v77, v79
  ds_write_b128 v36, v[132:135]
  v_cvt_pk_bf16_f32 v146, v81, v83
  v_cvt_pk_bf16_f32 v147, v85, v87
  v_pk_mul_f32 v[88:89], v[86:87], v[70:71] op_sel_hi:[1,0]
  v_pk_fma_f32 v[88:89], v[86:87], v[70:71], v[88:89] op_sel:[1,1,0] op_sel_hi:[0,1,1] neg_lo:[1,0,0]
  v_pk_mul_f32 v[90:91], v[88:89], v[70:71] op_sel_hi:[1,0]
  v_pk_fma_f32 v[90:91], v[88:89], v[70:71], v[90:91] op_sel:[1,1,0] op_sel_hi:[0,1,1] neg_lo:[1,0,0]
  v_pk_mul_f32 v[74:75], v[90:91], v[70:71] op_sel_hi:[1,0]
  v_pk_fma_f32 v[74:75], v[90:91], v[70:71], v[74:75] op_sel:[1,1,0] op_sel_hi:[0,1,1] neg_lo:[1,0,0]
  v_pk_mul_f32 v[76:77], v[74:75], v[70:71] op_sel_hi:[1,0]
  v_pk_fma_f32 v[76:77], v[74:75], v[70:71], v[76:77] op_sel:[1,1,0] op_sel_hi:[0,1,1] neg_lo:[1,0,0]
  ds_write_b128 v36, v[136:139] offset:4096
  v_pk_mul_f32 v[78:79], v[76:77], v[70:71] op_sel_hi:[1,0]
  v_pk_fma_f32 v[78:79], v[76:77], v[70:71], v[78:79] op_sel:[1,1,0] op_sel_hi:[0,1,1] neg_lo:[1,0,0]
  v_pk_mul_f32 v[80:81], v[78:79], v[70:71] op_sel_hi:[1,0]
  v_pk_fma_f32 v[80:81], v[78:79], v[70:71], v[80:81] op_sel:[1,1,0] op_sel_hi:[0,1,1] neg_lo:[1,0,0]
  v_pk_mul_f32 v[82:83], v[80:81], v[70:71] op_sel_hi:[1,0]
  v_pk_fma_f32 v[82:83], v[80:81], v[70:71], v[82:83] op_sel:[1,1,0] op_sel_hi:[0,1,1] neg_lo:[1,0,0]
  v_pk_mul_f32 v[84:85], v[82:83], v[70:71] op_sel_hi:[1,0]
  v_pk_fma_f32 v[84:85], v[82:83], v[70:71], v[84:85] op_sel:[1,1,0] op_sel_hi:[0,1,1] neg_lo:[1,0,0]
  v_cvt_pk_bf16_f32 v132, v88, v90
  v_cvt_pk_bf16_f32 v133, v74, v76
  ds_write_b128 v37, v[140:143]
  v_cvt_pk_bf16_f32 v134, v78, v80
  v_cvt_pk_bf16_f32 v135, v82, v84
  v_cvt_pk_bf16_f32 v136, v89, v91
  v_cvt_pk_bf16_f32 v137, v75, v77
  v_cvt_pk_bf16_f32 v138, v79, v81
  v_cvt_pk_bf16_f32 v139, v83, v85
  v_pk_mul_f32 v[86:87], v[84:85], v[70:71] op_sel_hi:[1,0]
  v_pk_fma_f32 v[86:87], v[84:85], v[70:71], v[86:87] op_sel:[1,1,0] op_sel_hi:[0,1,1] neg_lo:[1,0,0]
  v_pk_mul_f32 v[88:89], v[86:87], v[70:71] op_sel_hi:[1,0]
  v_pk_fma_f32 v[88:89], v[86:87], v[70:71], v[88:89] op_sel:[1,1,0] op_sel_hi:[0,1,1] neg_lo:[1,0,0]
  ds_write_b128 v37, v[144:147] offset:4096
  v_pk_mul_f32 v[90:91], v[88:89], v[70:71] op_sel_hi:[1,0]
  v_pk_fma_f32 v[90:91], v[88:89], v[70:71], v[90:91] op_sel:[1,1,0] op_sel_hi:[0,1,1] neg_lo:[1,0,0]
  v_pk_mul_f32 v[74:75], v[90:91], v[70:71] op_sel_hi:[1,0]
  v_pk_fma_f32 v[74:75], v[90:91], v[70:71], v[74:75] op_sel:[1,1,0] op_sel_hi:[0,1,1] neg_lo:[1,0,0]
  v_pk_mul_f32 v[76:77], v[74:75], v[70:71] op_sel_hi:[1,0]
  v_pk_fma_f32 v[76:77], v[74:75], v[70:71], v[76:77] op_sel:[1,1,0] op_sel_hi:[0,1,1] neg_lo:[1,0,0]
  v_pk_mul_f32 v[78:79], v[76:77], v[70:71] op_sel_hi:[1,0]
  v_pk_fma_f32 v[78:79], v[76:77], v[70:71], v[78:79] op_sel:[1,1,0] op_sel_hi:[0,1,1] neg_lo:[1,0,0]
  v_pk_mul_f32 v[80:81], v[78:79], v[70:71] op_sel_hi:[1,0]
  v_pk_fma_f32 v[80:81], v[78:79], v[70:71], v[80:81] op_sel:[1,1,0] op_sel_hi:[0,1,1] neg_lo:[1,0,0]
  ds_write_b128 v38, v[132:135]
  v_pk_mul_f32 v[82:83], v[80:81], v[70:71] op_sel_hi:[1,0]
  v_pk_fma_f32 v[82:83], v[80:81], v[70:71], v[82:83] op_sel:[1,1,0] op_sel_hi:[0,1,1] neg_lo:[1,0,0]
  v_cvt_pk_bf16_f32 v140, v86, v88
  v_cvt_pk_bf16_f32 v141, v90, v74
  v_cvt_pk_bf16_f32 v142, v76, v78
  v_cvt_pk_bf16_f32 v143, v80, v82
  v_cvt_pk_bf16_f32 v144, v87, v89
  v_cvt_pk_bf16_f32 v145, v91, v75
  v_cvt_pk_bf16_f32 v146, v77, v79
  v_cvt_pk_bf16_f32 v147, v81, v83
  ds_write_b128 v38, v[136:139] offset:4096
  ds_write_b128 v39, v[140:143]
  ds_write_b128 v39, v[144:147] offset:4096
  ds_read_b64_tr_b16 v[180:181], v40 offset:0
  ds_read_b64_tr_b16 v[182:183], v41 offset:0
  ds_read_b64_tr_b16 v[184:185], v40 offset:512
  ds_read_b64_tr_b16 v[186:187], v41 offset:512
  ds_read_b64_tr_b16 v[188:189], v40 offset:1024
  ds_read_b64_tr_b16 v[190:191], v41 offset:1024
  ds_read_b64_tr_b16 v[192:193], v40 offset:1536
  ds_read_b64_tr_b16 v[194:195], v41 offset:1536
  ds_read_b64_tr_b16 v[196:197], v40 offset:2048
  ds_read_b64_tr_b16 v[198:199], v41 offset:2048
  ds_read_b64_tr_b16 v[200:201], v40 offset:2560
  ds_read_b64_tr_b16 v[202:203], v41 offset:2560
  ds_read_b64_tr_b16 v[204:205], v40 offset:3072
  ds_read_b64_tr_b16 v[206:207], v41 offset:3072
  ds_read_b64_tr_b16 v[208:209], v40 offset:3584
  ds_read_b64_tr_b16 v[210:211], v41 offset:3584
  s_waitcnt lgkmcnt(14)
  v_mfma_f32_32x32x16_bf16 v[48:63], v[148:151], v[180:183], 0
  s_waitcnt lgkmcnt(12)
  v_mfma_f32_32x32x16_bf16 v[48:63], v[152:155], v[184:187], v[48:63]
  s_waitcnt lgkmcnt(10)
  v_mfma_f32_32x32x16_bf16 v[48:63], v[156:159], v[188:191], v[48:63]
  s_waitcnt lgkmcnt(8)
  v_mfma_f32_32x32x16_bf16 v[48:63], v[160:163], v[192:195], v[48:63]
  s_waitcnt lgkmcnt(6)
  v_mfma_f32_32x32x16_bf16 v[48:63], v[164:167], v[196:199], v[48:63]
  s_waitcnt lgkmcnt(4)
  v_mfma_f32_32x32x16_bf16 v[48:63], v[168:171], v[200:203], v[48:63]
  s_waitcnt lgkmcnt(2)
  v_mfma_f32_32x32x16_bf16 v[48:63], v[172:175], v[204:207], v[48:63]
  s_waitcnt lgkmcnt(0)
  v_mfma_f32_32x32x16_bf16 v[48:63], v[176:179], v[208:211], v[48:63]
  s_cmp_lg_u32 s76, 0
  s_cbranch_scc1 Lq022
  v_lshlrev_b32_e64 v64, 21, v1
  v_add_u32 v64, 2097024, v64
  s_mov_b64 exec, 31
  buffer_load_dword v2, v64, s[60:63], 0 offen sc1
  v_lshlrev_b32_e64 v64, 21, v1
  s_mov_b64 exec, 1
  global_load_dword v2, v64, s[40:41]
  global_load_dword v2, v64, s[42:43]
  s_mov_b64 exec, -1
Lq022:
  s_waitcnt vmcnt(4)
  v_lshlrev_b32 v28, 16, v28
  s_waitcnt vmcnt(3)
  v_lshlrev_b32 v29, 16, v29
  s_waitcnt vmcnt(2)
  v_lshlrev_b32 v30, 16, v30
  s_waitcnt vmcnt(1)
  v_lshlrev_b32_e64 v31, 16, v31
  v_mul_f32 v64, 0x3fb8aa3b, v28
  v_exp_f32 v64, v64
  v_mul_f32 v65, v45, v29
  v_cvt_pk_bf16_f32 v64, 0, v64
  v_mul_f32 v65, 0.15915494, v65
  v_mul_f32 v64, v45, v64
  v_add_f32_e64 v66, v45, v45
  v_mul_f32 v64, 0xbfb8aa3b, v64
  v_mul_f32 v74, v66, v30
  v_mul_f32 v75, v66, v31
  v_exp_f32 v66, v64
  v_fract_f32 v67, v65
  v_cos_f32 v68, v67
  v_sin_f32 v69, v67
  v_mul_f32 v68, v68, v66
  v_mul_f32 v69, v69, v66
  v_mul_f32 v66, 0x43800000, v64
  v_mul_f32 v67, 0x43800000, v65
  v_exp_f32 v66, v66
  v_fract_f32 v67, v67
  v_cos_f32 v72, v67
  v_sin_f32 v73, v67
  v_mul_f32 v72, v72, v66
  v_mul_f32 v73, v73, v66
  v_mul_f32 v66, 0x41000000, v64
  v_mul_f32 v67, 0x41000000, v65
  v_exp_f32 v66, v66
  v_fract_f32 v67, v67
  v_cos_f32 v70, v67
  v_sin_f32 v71, v67
  v_mul_f32 v70, v70, v66
  v_mul_f32 v71, v71, v66
  v_pk_mul_f32 v[76:77], v[74:75], v[68:69] op_sel_hi:[1,0]
  v_pk_fma_f32 v[76:77], v[74:75], v[68:69], v[76:77] op_sel:[1,1,0] op_sel_hi:[0,1,1] neg_lo:[1,0,0]
  v_pk_mul_f32 v[78:79], v[76:77], v[68:69] op_sel_hi:[1,0]
  v_pk_fma_f32 v[78:79], v[76:77], v[68:69], v[78:79] op_sel:[1,1,0] op_sel_hi:[0,1,1] neg_lo:[1,0,0]
  v_pk_mul_f32 v[80:81], v[78:79], v[68:69] op_sel_hi:[1,0]
  v_pk_fma_f32 v[80:81], v[78:79], v[68:69], v[80:81] op_sel:[1,1,0] op_sel_hi:[0,1,1] neg_lo:[1,0,0]
  v_pk_mul_f32 v[82:83], v[80:81], v[68:69] op_sel_hi:[1,0]
  v_pk_fma_f32 v[82:83], v[80:81], v[68:69], v[82:83] op_sel:[1,1,0] op_sel_hi:[0,1,1] neg_lo:[1,0,0]
  v_pk_mul_f32 v[84:85], v[82:83], v[68:69] op_sel_hi:[1,0]
  v_pk_fma_f32 v[84:85], v[82:83], v[68:69], v[84:85] op_sel:[1,1,0] op_sel_hi:[0,1,1] neg_lo:[1,0,0]
  v_pk_mul_f32 v[86:87], v[84:85], v[68:69] op_sel_hi:[1,0]
  v_pk_fma_f32 v[86:87], v[84:85], v[68:69], v[86:87] op_sel:[1,1,0] op_sel_hi:[0,1,1] neg_lo:[1,0,0]
  v_pk_mul_f32 v[88:89], v[86:87], v[68:69] op_sel_hi:[1,0]
  v_pk_fma_f32 v[88:89], v[86:87], v[68:69], v[88:89] op_sel:[1,1,0] op_sel_hi:[0,1,1] neg_lo:[1,0,0]
  v_cvt_pk_bf16_f32 v132, v74, v76
  v_cvt_pk_bf16_f32 v133, v78, v80
  v_cvt_pk_bf16_f32 v134, v82, v84
  v_cvt_pk_bf16_f32 v135, v86, v88
  v_cvt_pk_bf16_f32 v136, -v75, -v77
  v_cvt_pk_bf16_f32 v137, -v79, -v81
  v_cvt_pk_bf16_f32 v138, -v83, -v85
  v_cvt_pk_bf16_f32 v139, -v87, -v89
  ds_write_b128 v36, v[132:135]
  v_pk_mul_f32 v[90:91], v[88:89], v[68:69] op_sel_hi:[1,0]
  v_pk_fma_f32 v[90:91], v[88:89], v[68:69], v[90:91] op_sel:[1,1,0] op_sel_hi:[0,1,1] neg_lo:[1,0,0]
  v_pk_mul_f32 v[92:93], v[74:75], v[72:73] op_sel_hi:[1,0]
  v_pk_fma_f32 v[92:93], v[74:75], v[72:73], v[92:93] op_sel:[1,1,0] op_sel_hi:[0,1,1] neg_lo:[1,0,0]
  v_pk_mul_f32 v[94:95], v[78:79], v[72:73] op_sel_hi:[1,0]
  v_pk_fma_f32 v[94:95], v[78:79], v[72:73], v[94:95] op_sel:[1,1,0] op_sel_hi:[0,1,1] neg_lo:[1,0,0]
  v_pk_mul_f32 v[96:97], v[82:83], v[72:73] op_sel_hi:[1,0]
  v_pk_fma_f32 v[96:97], v[82:83], v[72:73], v[96:97] op_sel:[1,1,0] op_sel_hi:[0,1,1] neg_lo:[1,0,0]
  v_pk_mul_f32 v[98:99], v[86:87], v[72:73] op_sel_hi:[1,0]
  v_pk_fma_f32 v[98:99], v[86:87], v[72:73], v[98:99] op_sel:[1,1,0] op_sel_hi:[0,1,1] neg_lo:[1,0,0]
  ds_write_b128 v36, v[136:139] offset:4096
  v_pk_mul_f32 v[100:101], v[90:91], v[72:73] op_sel_hi:[1,0]
  v_pk_fma_f32 v[100:101], v[90:91], v[72:73], v[100:101] op_sel:[1,1,0] op_sel_hi:[0,1,1] neg_lo:[1,0,0]
  v_cvt_pk_bf16_f32 v140, v82, v92
  v_cvt_pk_bf16_f32 v141, v94, v96
  v_cvt_pk_bf16_f32 v142, v90, v96
  v_cvt_pk_bf16_f32 v143, v98, v100
  v_cvt_pk_bf16_f32 v144, -v83, -v93
  v_cvt_pk_bf16_f32 v145, -v95, -v97
  v_cvt_pk_bf16_f32 v146, -v91, -v97
  v_cvt_pk_bf16_f32 v147, -v99, -v101
  ds_write_b128 v37, v[140:143]
  v_pk_mul_f32 v[102:103], v[92:93], v[72:73] op_sel_hi:[1,0]
  v_pk_fma_f32 v[102:103], v[92:93], v[72:73], v[102:103] op_sel:[1,1,0] op_sel_hi:[0,1,1] neg_lo:[1,0,0]
  v_pk_mul_f32 v[104:105], v[96:97], v[72:73] op_sel_hi:[1,0]
  v_pk_fma_f32 v[104:105], v[96:97], v[72:73], v[104:105] op_sel:[1,1,0] op_sel_hi:[0,1,1] neg_lo:[1,0,0]
  v_pk_mul_f32 v[106:107], v[100:101], v[72:73] op_sel_hi:[1,0]
  v_pk_fma_f32 v[106:107], v[100:101], v[72:73], v[106:107] op_sel:[1,1,0] op_sel_hi:[0,1,1] neg_lo:[1,0,0]
  v_pk_mul_f32 v[108:109], v[102:103], v[72:73] op_sel_hi:[1,0]
  v_pk_fma_f32 v[108:109], v[102:103], v[72:73], v[108:109] op_sel:[1,1,0] op_sel_hi:[0,1,1] neg_lo:[1,0,0]
  v_pk_mul_f32 v[110:111], v[104:105], v[72:73] op_sel_hi:[1,0]
  v_pk_fma_f32 v[110:111], v[104:105], v[72:73], v[110:111] op_sel:[1,1,0] op_sel_hi:[0,1,1] neg_lo:[1,0,0]
  ds_write_b128 v37, v[144:147] offset:4096
  v_pk_mul_f32 v[112:113], v[106:107], v[72:73] op_sel_hi:[1,0]
  v_pk_fma_f32 v[112:113], v[106:107], v[72:73], v[112:113] op_sel:[1,1,0] op_sel_hi:[0,1,1] neg_lo:[1,0,0]
  v_pk_mul_f32 v[114:115], v[108:109], v[72:73] op_sel_hi:[1,0]
  v_pk_fma_f32 v[114:115], v[108:109], v[72:73], v[114:115] op_sel:[1,1,0] op_sel_hi:[0,1,1] neg_lo:[1,0,0]
  v_pk_mul_f32 v[116:117], v[112:113], v[72:73] op_sel_hi:[1,0]
  v_pk_fma_f32 v[116:117], v[112:113], v[72:73], v[116:117] op_sel:[1,1,0] op_sel_hi:[0,1,1] neg_lo:[1,0,0]
  v_pk_mul_f32 v[118:119], v[114:115], v[72:73] op_sel_hi:[1,0]
  v_pk_fma_f32 v[118:119], v[114:115], v[72:73], v[118:119] op_sel:[1,1,0] op_sel_hi:[0,1,1] neg_lo:[1,0,0]
  v_pk_mul_f32 v[120:121], v[116:117], v[72:73] op_sel_hi:[1,0]
  v_pk_fma_f32 v[120:121], v[116:117], v[72:73], v[120:121] op_sel:[1,1,0] op_sel_hi:[0,1,1] neg_lo:[1,0,0]
  v_pk_mul_f32 v[122:123], v[118:119], v[72:73] op_sel_hi:[1,0]
  v_pk_fma_f32 v[122:123], v[118:119], v[72:73], v[122:123] op_sel:[1,1,0] op_sel_hi:[0,1,1] neg_lo:[1,0,0]
  v_pk_mul_f32 v[124:125], v[120:121], v[72:73] op_sel_hi:[1,0]
  v_pk_fma_f32 v[124:125], v[120:121], v[72:73], v[124:125] op_sel:[1,1,0] op_sel_hi:[0,1,1] neg_lo:[1,0,0]
  v_pk_mul_f32 v[126:127], v[122:123], v[72:73] op_sel_hi:[1,0]
  v_pk_fma_f32 v[126:127], v[122:123], v[72:73], v[126:127] op_sel:[1,1,0] op_sel_hi:[0,1,1] neg_lo:[1,0,0]
  v_pk_mul_f32 v[128:129], v[124:125], v[72:73] op_sel_hi:[1,0]
  v_pk_fma_f32 v[128:129], v[124:125], v[72:73], v[128:129] op_sel:[1,1,0] op_sel_hi:[0,1,1] neg_lo:[1,0,0]
  v_cvt_pk_bf16_f32 v132, v102, v104
  v_cvt_pk_bf16_f32 v133, v106, v114
  v_cvt_pk_bf16_f32 v134, v108, v110
  v_cvt_pk_bf16_f32 v135, v112, v122
  v_cvt_pk_bf16_f32 v136, -v103, -v105
  v_cvt_pk_bf16_f32 v137, -v107, -v115
  v_cvt_pk_bf16_f32 v138, -v109, -v111
  v_cvt_pk_bf16_f32 v139, -v113, -v123
  ds_write_b128 v38, v[132:135]
  v_cvt_pk_bf16_f32 v140, v116, v118
  v_cvt_pk_bf16_f32 v141, v120, v120
  v_cvt_pk_bf16_f32 v142, v124, v126
  v_cvt_pk_bf16_f32 v143, v128, v128
  v_cvt_pk_bf16_f32 v144, -v117, -v119
  v_cvt_pk_bf16_f32 v145, -v121, -v121
  v_cvt_pk_bf16_f32 v146, -v125, -v127
  v_cvt_pk_bf16_f32 v147, -v129, -v129
  v_pk_mul_f32 v[78:79], v[70:71], v[70:71] op_sel_hi:[1,0]
  v_pk_fma_f32 v[78:79], v[70:71], v[70:71], v[78:79] op_sel:[1,1,0] op_sel_hi:[0,1,1] neg_lo:[1,0,0]
  ds_write_b128 v38, v[136:139] offset:4096
  v_pk_mul_f32 v[80:81], v[78:79], v[70:71] op_sel_hi:[1,0]
  v_pk_fma_f32 v[80:81], v[78:79], v[70:71], v[80:81] op_sel:[1,1,0] op_sel_hi:[0,1,1] neg_lo:[1,0,0]
  v_pk_mul_f32 v[82:83], v[80:81], v[70:71] op_sel_hi:[1,0]
  v_pk_fma_f32 v[82:83], v[80:81], v[70:71], v[82:83] op_sel:[1,1,0] op_sel_hi:[0,1,1] neg_lo:[1,0,0]
  v_pk_mul_f32 v[84:85], v[82:83], v[70:71] op_sel_hi:[1,0]
  v_pk_fma_f32 v[84:85], v[82:83], v[70:71], v[84:85] op_sel:[1,1,0] op_sel_hi:[0,1,1] neg_lo:[1,0,0]
  v_pk_mul_f32 v[86:87], v[84:85], v[70:71] op_sel_hi:[1,0]
  v_pk_fma_f32 v[86:87], v[84:85], v[70:71], v[86:87] op_sel:[1,1,0] op_sel_hi:[0,1,1] neg_lo:[1,0,0]
  v_pk_mul_f32 v[88:89], v[86:87], v[70:71] op_sel_hi:[1,0]
  v_pk_fma_f32 v[88:89], v[86:87], v[70:71], v[88:89] op_sel:[1,1,0] op_sel_hi:[0,1,1] neg_lo:[1,0,0]
  ds_write_b128 v39, v[140:143]
  v_cvt_pk_bf16_f32 v132, 1.0, v70
  v_cvt_pk_bf16_f32 v133, v78, v80
  v_cvt_pk_bf16_f32 v134, v82, v84
  v_cvt_pk_bf16_f32 v135, v86, v88
  v_cvt_pk_bf16_f32 v136, 0, v71
  v_cvt_pk_bf16_f32 v137, v79, v81
  v_cvt_pk_bf16_f32 v138, v83, v85
  v_cvt_pk_bf16_f32 v139, v87, v89
  v_pk_mul_f32 v[90:91], v[88:89], v[70:71] op_sel_hi:[1,0]
  v_pk_fma_f32 v[90:91], v[88:89], v[70:71], v[90:91] op_sel:[1,1,0] op_sel_hi:[0,1,1] neg_lo:[1,0,0]
  ds_write_b128 v39, v[144:147] offset:4096
  ds_read_b64_tr_b16 v[148:149], v40 offset:0
  ds_read_b64_tr_b16 v[150:151], v41 offset:0
  ds_read_b64_tr_b16 v[152:153], v40 offset:512
  ds_read_b64_tr_b16 v[154:155], v41 offset:512
  ds_read_b64_tr_b16 v[156:157], v40 offset:1024
  ds_read_b64_tr_b16 v[158:159], v41 offset:1024
  ds_read_b64_tr_b16 v[160:161], v40 offset:1536
  ds_read_b64_tr_b16 v[162:163], v41 offset:1536
  v_pk_mul_f32 v[74:75], v[90:91], v[70:71] op_sel_hi:[1,0]
  v_pk_fma_f32 v[74:75], v[90:91], v[70:71], v[74:75] op_sel:[1,1,0] op_sel_hi:[0,1,1] neg_lo:[1,0,0]
  v_pk_mul_f32 v[76:77], v[74:75], v[70:71] op_sel_hi:[1,0]
  v_pk_fma_f32 v[76:77], v[74:75], v[70:71], v[76:77] op_sel:[1,1,0] op_sel_hi:[0,1,1] neg_lo:[1,0,0]
  v_pk_mul_f32 v[78:79], v[76:77], v[70:71] op_sel_hi:[1,0]
  v_pk_fma_f32 v[78:79], v[76:77], v[70:71], v[78:79] op_sel:[1,1,0] op_sel_hi:[0,1,1] neg_lo:[1,0,0]
  v_pk_mul_f32 v[80:81], v[78:79], v[70:71] op_sel_hi:[1,0]
  v_pk_fma_f32 v[80:81], v[78:79], v[70:71], v[80:81] op_sel:[1,1,0] op_sel_hi:[0,1,1] neg_lo:[1,0,0]
  v_pk_mul_f32 v[82:83], v[80:81], v[70:71] op_sel_hi:[1,0]
  v_pk_fma_f32 v[82:83], v[80:81], v[70:71], v[82:83] op_sel:[1,1,0] op_sel_hi:[0,1,1] neg_lo:[1,0,0]
  ds_read_b64_tr_b16 v[164:165], v40 offset:2048
  ds_read_b64_tr_b16 v[166:167], v41 offset:2048
  ds_read_b64_tr_b16 v[168:169], v40 offset:2560
  ds_read_b64_tr_b16 v[170:171], v41 offset:2560
  ds_read_b64_tr_b16 v[172:173], v40 offset:3072
  ds_read_b64_tr_b16 v[174:175], v41 offset:3072
  ds_read_b64_tr_b16 v[176:177], v40 offset:3584
  ds_read_b64_tr_b16 v[178:179], v41 offset:3584
  v_pk_mul_f32 v[84:85], v[82:83], v[70:71] op_sel_hi:[1,0]
  v_pk_fma_f32 v[84:85], v[82:83], v[70:71], v[84:85] op_sel:[1,1,0] op_sel_hi:[0,1,1] neg_lo:[1,0,0]
  v_pk_mul_f32 v[86:87], v[84:85], v[70:71] op_sel_hi:[1,0]
  v_pk_fma_f32 v[86:87], v[84:85], v[70:71], v[86:87] op_sel:[1,1,0] op_sel_hi:[0,1,1] neg_lo:[1,0,0]
  v_cvt_pk_bf16_f32 v140, v90, v74
  v_cvt_pk_bf16_f32 v141, v76, v78
  v_cvt_pk_bf16_f32 v142, v80, v82
  v_cvt_pk_bf16_f32 v143, v84, v86
  v_cvt_pk_bf16_f32 v144, v91, v75
  v_cvt_pk_bf16_f32 v145, v77, v79
  ds_write_b128 v36, v[132:135]
  v_cvt_pk_bf16_f32 v146, v81, v83
  v_cvt_pk_bf16_f32 v147, v85, v87
  v_pk_mul_f32 v[88:89], v[86:87], v[70:71] op_sel_hi:[1,0]
  v_pk_fma_f32 v[88:89], v[86:87], v[70:71], v[88:89] op_sel:[1,1,0] op_sel_hi:[0,1,1] neg_lo:[1,0,0]
  v_pk_mul_f32 v[90:91], v[88:89], v[70:71] op_sel_hi:[1,0]
  v_pk_fma_f32 v[90:91], v[88:89], v[70:71], v[90:91] op_sel:[1,1,0] op_sel_hi:[0,1,1] neg_lo:[1,0,0]
  v_pk_mul_f32 v[74:75], v[90:91], v[70:71] op_sel_hi:[1,0]
  v_pk_fma_f32 v[74:75], v[90:91], v[70:71], v[74:75] op_sel:[1,1,0] op_sel_hi:[0,1,1] neg_lo:[1,0,0]
  v_pk_mul_f32 v[76:77], v[74:75], v[70:71] op_sel_hi:[1,0]
  v_pk_fma_f32 v[76:77], v[74:75], v[70:71], v[76:77] op_sel:[1,1,0] op_sel_hi:[0,1,1] neg_lo:[1,0,0]
  ds_write_b128 v36, v[136:139] offset:4096
  v_pk_mul_f32 v[78:79], v[76:77], v[70:71] op_sel_hi:[1,0]
  v_pk_fma_f32 v[78:79], v[76:77], v[70:71], v[78:79] op_sel:[1,1,0] op_sel_hi:[0,1,1] neg_lo:[1,0,0]
  v_pk_mul_f32 v[80:81], v[78:79], v[70:71] op_sel_hi:[1,0]
  v_pk_fma_f32 v[80:81], v[78:79], v[70:71], v[80:81] op_sel:[1,1,0] op_sel_hi:[0,1,1] neg_lo:[1,0,0]
  v_pk_mul_f32 v[82:83], v[80:81], v[70:71] op_sel_hi:[1,0]
  v_pk_fma_f32 v[82:83], v[80:81], v[70:71], v[82:83] op_sel:[1,1,0] op_sel_hi:[0,1,1] neg_lo:[1,0,0]
  v_pk_mul_f32 v[84:85], v[82:83], v[70:71] op_sel_hi:[1,0]
  v_pk_fma_f32 v[84:85], v[82:83], v[70:71], v[84:85] op_sel:[1,1,0] op_sel_hi:[0,1,1] neg_lo:[1,0,0]
  v_cvt_pk_bf16_f32 v132, v88, v90
  v_cvt_pk_bf16_f32 v133, v74, v76
  ds_write_b128 v37, v[140:143]
  v_cvt_pk_bf16_f32 v134, v78, v80
  v_cvt_pk_bf16_f32 v135, v82, v84
  v_cvt_pk_bf16_f32 v136, v89, v91
  v_cvt_pk_bf16_f32 v137, v75, v77
  v_cvt_pk_bf16_f32 v138, v79, v81
  v_cvt_pk_bf16_f32 v139, v83, v85
  v_pk_mul_f32 v[86:87], v[84:85], v[70:71] op_sel_hi:[1,0]
  v_pk_fma_f32 v[86:87], v[84:85], v[70:71], v[86:87] op_sel:[1,1,0] op_sel_hi:[0,1,1] neg_lo:[1,0,0]
  v_pk_mul_f32 v[88:89], v[86:87], v[70:71] op_sel_hi:[1,0]
  v_pk_fma_f32 v[88:89], v[86:87], v[70:71], v[88:89] op_sel:[1,1,0] op_sel_hi:[0,1,1] neg_lo:[1,0,0]
  ds_write_b128 v37, v[144:147] offset:4096
  v_pk_mul_f32 v[90:91], v[88:89], v[70:71] op_sel_hi:[1,0]
  v_pk_fma_f32 v[90:91], v[88:89], v[70:71], v[90:91] op_sel:[1,1,0] op_sel_hi:[0,1,1] neg_lo:[1,0,0]
  v_pk_mul_f32 v[74:75], v[90:91], v[70:71] op_sel_hi:[1,0]
  v_pk_fma_f32 v[74:75], v[90:91], v[70:71], v[74:75] op_sel:[1,1,0] op_sel_hi:[0,1,1] neg_lo:[1,0,0]
  v_pk_mul_f32 v[76:77], v[74:75], v[70:71] op_sel_hi:[1,0]
  v_pk_fma_f32 v[76:77], v[74:75], v[70:71], v[76:77] op_sel:[1,1,0] op_sel_hi:[0,1,1] neg_lo:[1,0,0]
  v_pk_mul_f32 v[78:79], v[76:77], v[70:71] op_sel_hi:[1,0]
  v_pk_fma_f32 v[78:79], v[76:77], v[70:71], v[78:79] op_sel:[1,1,0] op_sel_hi:[0,1,1] neg_lo:[1,0,0]
  v_pk_mul_f32 v[80:81], v[78:79], v[70:71] op_sel_hi:[1,0]
  v_pk_fma_f32 v[80:81], v[78:79], v[70:71], v[80:81] op_sel:[1,1,0] op_sel_hi:[0,1,1] neg_lo:[1,0,0]
  ds_write_b128 v38, v[132:135]
  v_pk_mul_f32 v[82:83], v[80:81], v[70:71] op_sel_hi:[1,0]
  v_pk_fma_f32 v[82:83], v[80:81], v[70:71], v[82:83] op_sel:[1,1,0] op_sel_hi:[0,1,1] neg_lo:[1,0,0]
  v_cvt_pk_bf16_f32 v140, v86, v88
  v_cvt_pk_bf16_f32 v141, v90, v74
  v_cvt_pk_bf16_f32 v142, v76, v78
  v_cvt_pk_bf16_f32 v143, v80, v82
  v_cvt_pk_bf16_f32 v144, v87, v89
  v_cvt_pk_bf16_f32 v145, v91, v75
  v_cvt_pk_bf16_f32 v146, v77, v79
  v_cvt_pk_bf16_f32 v147, v81, v83
  ds_write_b128 v38, v[136:139] offset:4096
  ds_write_b128 v39, v[140:143]
  ds_write_b128 v39, v[144:147] offset:4096
  ds_read_b64_tr_b16 v[180:181], v40 offset:0
  ds_read_b64_tr_b16 v[182:183], v41 offset:0
  ds_read_b64_tr_b16 v[184:185], v40 offset:512
  ds_read_b64_tr_b16 v[186:187], v41 offset:512
  ds_read_b64_tr_b16 v[188:189], v40 offset:1024
  ds_read_b64_tr_b16 v[190:191], v41 offset:1024
  ds_read_b64_tr_b16 v[192:193], v40 offset:1536
  ds_read_b64_tr_b16 v[194:195], v41 offset:1536
  ds_read_b64_tr_b16 v[196:197], v40 offset:2048
  ds_read_b64_tr_b16 v[198:199], v41 offset:2048
  ds_read_b64_tr_b16 v[200:201], v40 offset:2560
  ds_read_b64_tr_b16 v[202:203], v41 offset:2560
  ds_read_b64_tr_b16 v[204:205], v40 offset:3072
  ds_read_b64_tr_b16 v[206:207], v41 offset:3072
  ds_read_b64_tr_b16 v[208:209], v40 offset:3584
  ds_read_b64_tr_b16 v[210:211], v41 offset:3584
  s_waitcnt lgkmcnt(14)
  v_mfma_f32_32x32x16_bf16 v[48:63], v[148:151], v[180:183], v[48:63]
  s_waitcnt lgkmcnt(12)
  v_mfma_f32_32x32x16_bf16 v[48:63], v[152:155], v[184:187], v[48:63]
  s_waitcnt lgkmcnt(10)
  v_mfma_f32_32x32x16_bf16 v[48:63], v[156:159], v[188:191], v[48:63]
  s_waitcnt lgkmcnt(8)
  v_mfma_f32_32x32x16_bf16 v[48:63], v[160:163], v[192:195], v[48:63]
  s_waitcnt lgkmcnt(6)
  v_mfma_f32_32x32x16_bf16 v[48:63], v[164:167], v[196:199], v[48:63]
  s_waitcnt lgkmcnt(4)
  v_mfma_f32_32x32x16_bf16 v[48:63], v[168:171], v[200:203], v[48:63]
  s_waitcnt lgkmcnt(2)
  v_mfma_f32_32x32x16_bf16 v[48:63], v[172:175], v[204:207], v[48:63]
  s_waitcnt lgkmcnt(0)
  v_mfma_f32_32x32x16_bf16 v[48:63], v[176:179], v[208:211], v[48:63]
  s_waitcnt vmcnt(0)
  v_lshlrev_b32 v12, 16, v12
  s_mov_b64 exec, 1
  s_nop 8
  v_add_f32 v48, v48, v12
  s_mov_b64 exec, -1
  v_cvt_pk_bf16_f32 v64, v48, v49
  v_cvt_pk_bf16_f32 v65, v50, v51
  v_cvt_pk_bf16_f32 v66, v53, v53
  v_cvt_pk_bf16_f32 v67, v54, v55
  v_cvt_pk_bf16_f32 v68, v56, v56
  v_cvt_pk_bf16_f32 v69, v56, v57
  v_cvt_pk_bf16_f32 v70, v57, v57
  v_cvt_pk_bf16_f32 v71, v58, v58
  v_cvt_pk_bf16_f32 v74, v59, 0
  v_cvt_pk_bf16_f32 v72, v59, v59
  v_cvt_pk_bf16_f32 v73, v59, v59
  v_cvt_pk_bf16_f32 v76, v59, v60
  v_cvt_pk_bf16_f32 v77, v61, v62
  ds_write_b64 v42, v[64:65] offset:0
  ds_write_b64 v42, v[66:67] offset:512
  ds_write_b128 v43, v[68:71] offset:1024
  s_mov_b64 exec, 1
  ds_write_b64 v42, v[72:73] offset:2048
  ds_write_b32 v42, v74 offset:2056
  s_not_b64 exec, s[100:101]
  ds_write2_b32 v44, v76, v77 offset0:0 offset1:16
  s_mov_b64 exec, -1
  s_nop 0
  v_cvt_pk_bf16_f32 v64, v49, v50
  v_cvt_pk_bf16_f32 v65, v51, v52
  v_cvt_pk_bf16_f32 v66, v53, v54
  v_cvt_pk_bf16_f32 v67, v55, v55
  v_cvt_pk_bf16_f32 v68, v56, v56
  v_cvt_pk_bf16_f32 v69, v57, v57
  v_cvt_pk_bf16_f32 v70, v57, v58
  v_cvt_pk_bf16_f32 v71, v58, v58
  v_cvt_pk_bf16_f32 v74, 0, v48
  v_add_u32_e64 v75, -4, v42
  v_cvt_pk_bf16_f32 v72, v59, v59
  v_cvt_pk_bf16_f32 v73, v59, v59
  ds_write_b64 v42, v[64:65] offset:2240
  ds_write_b64 v42, v[66:67] offset:2752
  ds_write_b128 v43, v[68:71] offset:3264
  s_mov_b64 exec, 1
  ds_write_b64 v42, v[72:73] offset:4288
  ds_write_b32 v75, v74 offset:2240
  s_mov_b64 exec, -1
  s_waitcnt lgkmcnt(0)
  s_barrier
  s_setprio 1
  ds_read_b128 v[88:91], v18 offset:192
  ds_read_b128 v[92:95], v18 offset:704
  ds_read_b128 v[96:99], v18 offset:1216
  ds_read_b128 v[100:103], v18 offset:1728
  ds_read_b128 v[104:107], v18 offset:2240
  ds_read_b128 v[108:111], v18 offset:2752
  ds_read_b128 v[112:115], v18 offset:3264
  ds_read_b128 v[116:119], v18 offset:3776
  ds_read2_b32 v[56:57], v14 offset0:0 offset1:1
  ds_read2_b32 v[58:59], v14 offset0:2 offset1:3
  ds_read2_b32 v[60:61], v14 offset0:128 offset1:129
  ds_read2_b32 v[62:63], v14 offset0:130 offset1:131
  ds_read2_b32 v[64:65], v15 offset0:0 offset1:1
  ds_read2_b32 v[66:67], v15 offset0:2 offset1:3
  ds_read2_b32 v[68:69], v15 offset0:128 offset1:129
  ds_read2_b32 v[70:71], v15 offset0:130 offset1:131
  s_waitcnt lgkmcnt(0)
  v_mfma_f32_16x16x32_bf16 v[24:27], v[56:59], v[88:91], 0
  ds_read_b128 v[156:159], v18 offset:176
  v_mfma_f32_16x16x32_bf16 v[28:31], v[56:59], v[92:95], 0
  ds_read_b128 v[160:163], v18 offset:688
  v_mfma_f32_16x16x32_bf16 v[32:35], v[56:59], v[96:99], 0
  ds_read_b128 v[164:167], v18 offset:1200
  v_mfma_f32_16x16x32_bf16 v[36:39], v[56:59], v[100:103], 0
  ds_read_b128 v[168:171], v18 offset:1712
  v_mfma_f32_16x16x32_bf16 v[40:43], v[56:59], v[104:107], 0
  ds_read2_b32 v[172:173], v16 offset0:0 offset1:1
  v_mfma_f32_16x16x32_bf16 v[44:47], v[56:59], v[108:111], 0
  ds_read2_b32 v[174:175], v16 offset0:2 offset1:3
  v_mfma_f32_16x16x32_bf16 v[48:51], v[56:59], v[112:115], 0
  ds_read_b128 v[120:123], v18 offset:128
  v_mfma_f32_16x16x32_bf16 v[52:55], v[56:59], v[116:119], 0
  ds_read_b128 v[124:127], v18 offset:640
  v_mfma_f32_16x16x32_bf16 v[28:31], v[60:63], v[88:91], v[28:31]
  v_mfma_f32_16x16x32_bf16 v[32:35], v[60:63], v[92:95], v[32:35]
  ds_read_b128 v[128:131], v18 offset:1152
  v_mfma_f32_16x16x32_bf16 v[36:39], v[60:63], v[96:99], v[36:39]
  ds_read_b128 v[132:135], v18 offset:1664
  v_mfma_f32_16x16x32_bf16 v[40:43], v[60:63], v[100:103], v[40:43]
  ds_read_b128 v[136:139], v18 offset:2176
  v_mfma_f32_16x16x32_bf16 v[44:47], v[60:63], v[104:107], v[44:47]
  ds_read_b128 v[140:143], v18 offset:2688
  v_mfma_f32_16x16x32_bf16 v[48:51], v[60:63], v[108:111], v[48:51]
  ds_read_b128 v[144:147], v18 offset:3200
  v_mfma_f32_16x16x32_bf16 v[52:55], v[60:63], v[112:115], v[52:55]
  ds_read_b128 v[148:151], v18 offset:3712
  v_mfma_f32_16x16x32_bf16 v[32:35], v[64:67], v[88:91], v[32:35]
  ds_read2_b32 v[72:73], v14 offset0:16 offset1:17
  v_mfma_f32_16x16x32_bf16 v[36:39], v[64:67], v[92:95], v[36:39]
  v_mfma_f32_16x16x32_bf16 v[40:43], v[64:67], v[96:99], v[40:43]
  ds_read2_b32 v[74:75], v14 offset0:18 offset1:19
  v_mfma_f32_16x16x32_bf16 v[44:47], v[64:67], v[100:103], v[44:47]
  ds_read2_b32 v[76:77], v14 offset0:144 offset1:145
  v_mfma_f32_16x16x32_bf16 v[48:51], v[64:67], v[104:107], v[48:51]
  ds_read2_b32 v[78:79], v14 offset0:146 offset1:147
  v_mfma_f32_16x16x32_bf16 v[52:55], v[64:67], v[108:111], v[52:55]
  ds_read2_b32 v[80:81], v15 offset0:16 offset1:17
  v_mfma_f32_16x16x32_bf16 v[36:39], v[68:71], v[88:91], v[36:39]
  ds_read2_b32 v[82:83], v15 offset0:18 offset1:19
  v_mfma_f32_16x16x32_bf16 v[40:43], v[68:71], v[92:95], v[40:43]
  ds_read2_b32 v[84:85], v15 offset0:144 offset1:145
  v_mfma_f32_16x16x32_bf16 v[44:47], v[68:71], v[96:99], v[44:47]
  ds_read2_b32 v[86:87], v15 offset0:146 offset1:147
  v_mfma_f32_16x16x32_bf16 v[48:51], v[68:71], v[100:103], v[48:51]
  v_mfma_f32_16x16x32_bf16 v[52:55], v[68:71], v[104:107], v[52:55]
  v_mfma_f32_16x16x32_bf16 v[192:195], v[88:91], v[4:7], 0
  s_waitcnt lgkmcnt(15)
  v_mfma_f32_16x16x32_bf16 v[196:199], v[156:159], v[8:11], 0
  s_waitcnt lgkmcnt(15)
  v_mfma_f32_16x16x32_bf16 v[40:43], v[172:175], v[88:91], v[40:43]
  v_mfma_f32_16x16x32_bf16 v[200:203], v[92:95], v[4:7], 0
  v_mfma_f32_16x16x32_bf16 v[204:207], v[160:163], v[8:11], 0
  v_mfma_f32_16x16x32_bf16 v[44:47], v[172:175], v[92:95], v[44:47]
  v_mfma_f32_16x16x32_bf16 v[208:211], v[96:99], v[4:7], 0
  v_mfma_f32_16x16x32_bf16 v[212:215], v[164:167], v[8:11], 0
  v_mfma_f32_16x16x32_bf16 v[48:51], v[172:175], v[96:99], v[48:51]
  v_mfma_f32_16x16x32_bf16 v[216:219], v[100:103], v[4:7], 0
  v_mfma_f32_16x16x32_bf16 v[220:223], v[168:171], v[8:11], 0
  v_mfma_f32_16x16x32_bf16 v[52:55], v[172:175], v[100:103], v[52:55]
  s_waitcnt lgkmcnt(6)
  v_mfma_f32_16x16x32_bf16 v[24:27], v[72:75], v[120:123], v[24:27]
  ds_read2_b32 v[188:189], v17 offset0:51 offset1:50
  v_mfma_f32_16x16x32_bf16 v[28:31], v[72:75], v[124:127], v[28:31]
  ds_read2_b32 v[190:191], v17 offset0:49 offset1:48
  v_mfma_f32_16x16x32_bf16 v[32:35], v[72:75], v[128:131], v[32:35]
  ds_read2_b32 v[184:185], v17 offset0:35 offset1:34
  v_mfma_f32_16x16x32_bf16 v[36:39], v[72:75], v[132:135], v[36:39]
  ds_read2_b32 v[186:187], v17 offset0:33 offset1:32
  v_mfma_f32_16x16x32_bf16 v[40:43], v[72:75], v[136:139], v[40:43]
  ds_read2_b32 v[180:181], v17 offset0:19 offset1:18
  v_mfma_f32_16x16x32_bf16 v[44:47], v[72:75], v[140:143], v[44:47]
  ds_read2_b32 v[182:183], v17 offset0:17 offset1:16
  v_mfma_f32_16x16x32_bf16 v[48:51], v[72:75], v[144:147], v[48:51]
  ds_read2_b32 v[176:177], v17 offset0:3 offset1:2
  v_cvt_pk_bf16_f32 v156, v192, v196
  v_mfma_f32_16x16x32_bf16 v[52:55], v[72:75], v[148:151], v[52:55]
  ds_read2_b32 v[178:179], v17 offset0:1 offset1:0
  v_cvt_pk_bf16_f32 v157, v193, v197
  s_waitcnt lgkmcnt(12)
  v_mfma_f32_16x16x32_bf16 v[28:31], v[76:79], v[120:123], v[28:31]
  ds_read_b128 v[88:91], v18 offset:64
  v_cvt_pk_bf16_f32 v158, v194, v198
  v_mfma_f32_16x16x32_bf16 v[32:35], v[76:79], v[124:127], v[32:35]
  ds_read_b128 v[92:95], v18 offset:576
  v_cvt_pk_bf16_f32 v159, v195, v199
  v_mfma_f32_16x16x32_bf16 v[36:39], v[76:79], v[128:131], v[36:39]
  ds_read_b128 v[96:99], v18 offset:1088
  v_cvt_pk_bf16_f32 v160, v200, v204
  v_mfma_f32_16x16x32_bf16 v[40:43], v[76:79], v[132:135], v[40:43]
  ds_read_b128 v[100:103], v18 offset:1600
  v_cvt_pk_bf16_f32 v161, v201, v205
  v_mfma_f32_16x16x32_bf16 v[44:47], v[76:79], v[136:139], v[44:47]
  ds_read_b128 v[104:107], v18 offset:2112
  v_cvt_pk_bf16_f32 v162, v202, v206
  v_mfma_f32_16x16x32_bf16 v[48:51], v[76:79], v[140:143], v[48:51]
  ds_read_b128 v[108:111], v18 offset:2624
  v_cvt_pk_bf16_f32 v163, v203, v207
  v_mfma_f32_16x16x32_bf16 v[52:55], v[76:79], v[144:147], v[52:55]
  ds_read_b128 v[112:115], v18 offset:3136
  v_cvt_pk_bf16_f32 v164, v208, v212
  s_waitcnt lgkmcnt(15)
  v_mfma_f32_16x16x32_bf16 v[32:35], v[80:83], v[120:123], v[32:35]
  ds_read_b128 v[116:119], v18 offset:3648
  v_cvt_pk_bf16_f32 v165, v209, v213
  v_mfma_f32_16x16x32_bf16 v[36:39], v[80:83], v[124:127], v[36:39]
  ds_read2_b32 v[56:57], v14 offset0:32 offset1:33
  v_cvt_pk_bf16_f32 v166, v210, v214
  v_mfma_f32_16x16x32_bf16 v[40:43], v[80:83], v[128:131], v[40:43]
  ds_read2_b32 v[58:59], v14 offset0:34 offset1:35
  v_cvt_pk_bf16_f32 v167, v211, v215
  v_mfma_f32_16x16x32_bf16 v[44:47], v[80:83], v[132:135], v[44:47]
  ds_read2_b32 v[60:61], v14 offset0:160 offset1:161
  v_cvt_pk_bf16_f32 v168, v216, v220
  v_mfma_f32_16x16x32_bf16 v[48:51], v[80:83], v[136:139], v[48:51]
  ds_read2_b32 v[62:63], v14 offset0:162 offset1:163
  v_cvt_pk_bf16_f32 v169, v217, v221
  v_mfma_f32_16x16x32_bf16 v[52:55], v[80:83], v[140:143], v[52:55]
  ds_read2_b32 v[64:65], v15 offset0:32 offset1:33
  v_cvt_pk_bf16_f32 v170, v218, v222
  s_waitcnt lgkmcnt(15)
  v_mfma_f32_16x16x32_bf16 v[36:39], v[84:87], v[120:123], v[36:39]
  ds_read2_b32 v[66:67], v15 offset0:34 offset1:35
  v_cvt_pk_bf16_f32 v171, v219, v223
  v_mfma_f32_16x16x32_bf16 v[40:43], v[84:87], v[124:127], v[40:43]
  ds_read2_b32 v[68:69], v15 offset0:160 offset1:161
  v_mfma_f32_16x16x32_bf16 v[44:47], v[84:87], v[128:131], v[44:47]
  ds_read2_b32 v[70:71], v15 offset0:162 offset1:163
  v_mfma_f32_16x16x32_bf16 v[48:51], v[84:87], v[132:135], v[48:51]
  v_mfma_f32_16x16x32_bf16 v[52:55], v[84:87], v[136:139], v[52:55]
  s_waitcnt lgkmcnt(6)
  v_mfma_f32_16x16x32_bf16 v[40:43], v[156:159], v[176:179], v[40:43]
  v_mfma_f32_16x16x32_bf16 v[44:47], v[160:163], v[176:179], v[44:47]
  v_mfma_f32_16x16x32_bf16 v[48:51], v[164:167], v[176:179], v[48:51]
  v_mfma_f32_16x16x32_bf16 v[52:55], v[168:171], v[176:179], v[52:55]
  v_mfma_f32_16x16x32_bf16 v[44:47], v[156:159], v[180:183], v[44:47]
  v_mfma_f32_16x16x32_bf16 v[48:51], v[160:163], v[180:183], v[48:51]
  v_mfma_f32_16x16x32_bf16 v[52:55], v[164:167], v[180:183], v[52:55]
  v_mfma_f32_16x16x32_bf16 v[48:51], v[156:159], v[184:187], v[48:51]
  v_mfma_f32_16x16x32_bf16 v[52:55], v[160:163], v[184:187], v[52:55]
  v_mfma_f32_16x16x32_bf16 v[52:55], v[156:159], v[188:191], v[52:55]
  v_mfma_f32_16x16x32_bf16 v[24:27], v[56:59], v[88:91], v[24:27]
  ds_read_b128 v[120:123], v18 offset:0
  v_mfma_f32_16x16x32_bf16 v[28:31], v[56:59], v[92:95], v[28:31]
  ds_read_b128 v[124:127], v18 offset:512
  v_mfma_f32_16x16x32_bf16 v[32:35], v[56:59], v[96:99], v[32:35]
  v_mfma_f32_16x16x32_bf16 v[36:39], v[56:59], v[100:103], v[36:39]
  ds_read_b128 v[128:131], v18 offset:1024
  v_mfma_f32_16x16x32_bf16 v[40:43], v[56:59], v[104:107], v[40:43]
  ds_read_b128 v[132:135], v18 offset:1536
  v_mfma_f32_16x16x32_bf16 v[44:47], v[56:59], v[108:111], v[44:47]
  v_mfma_f32_16x16x32_bf16 v[48:51], v[56:59], v[112:115], v[48:51]
  ds_read_b128 v[136:139], v18 offset:2048
  v_mfma_f32_16x16x32_bf16 v[52:55], v[56:59], v[116:119], v[52:55]
  ds_read_b128 v[140:143], v18 offset:2560
  s_waitcnt lgkmcnt(10)
  v_mfma_f32_16x16x32_bf16 v[28:31], v[60:63], v[88:91], v[28:31]
  v_mfma_f32_16x16x32_bf16 v[32:35], v[60:63], v[92:95], v[32:35]
  ds_read_b128 v[144:147], v18 offset:3072
  v_mfma_f32_16x16x32_bf16 v[36:39], v[60:63], v[96:99], v[36:39]
  ds_read_b128 v[148:151], v18 offset:3584
  v_mfma_f32_16x16x32_bf16 v[40:43], v[60:63], v[100:103], v[40:43]
  v_mfma_f32_16x16x32_bf16 v[44:47], v[60:63], v[104:107], v[44:47]
  ds_read2_b32 v[72:73], v14 offset0:48 offset1:49
  v_mfma_f32_16x16x32_bf16 v[48:51], v[60:63], v[108:111], v[48:51]
  v_mfma_f32_16x16x32_bf16 v[52:55], v[60:63], v[112:115], v[52:55]
  ds_read2_b32 v[74:75], v14 offset0:50 offset1:51
  s_waitcnt lgkmcnt(12)
  v_mfma_f32_16x16x32_bf16 v[32:35], v[64:67], v[88:91], v[32:35]
  ds_read2_b32 v[76:77], v14 offset0:176 offset1:177
  v_mfma_f32_16x16x32_bf16 v[36:39], v[64:67], v[92:95], v[36:39]
  v_mfma_f32_16x16x32_bf16 v[40:43], v[64:67], v[96:99], v[40:43]
  ds_read2_b32 v[78:79], v14 offset0:178 offset1:179
  v_mfma_f32_16x16x32_bf16 v[44:47], v[64:67], v[100:103], v[44:47]
  ds_read2_b32 v[80:81], v15 offset0:48 offset1:49
  v_mfma_f32_16x16x32_bf16 v[48:51], v[64:67], v[104:107], v[48:51]
  v_mfma_f32_16x16x32_bf16 v[52:55], v[64:67], v[108:111], v[52:55]
  ds_read2_b32 v[82:83], v15 offset0:50 offset1:51
  s_waitcnt lgkmcnt(14)
  v_mfma_f32_16x16x32_bf16 v[36:39], v[68:71], v[88:91], v[36:39]
  ds_read2_b32 v[84:85], v15 offset0:176 offset1:177
  v_mfma_f32_16x16x32_bf16 v[40:43], v[68:71], v[92:95], v[40:43]
  v_mfma_f32_16x16x32_bf16 v[44:47], v[68:71], v[96:99], v[44:47]
  ds_read2_b32 v[86:87], v15 offset0:178 offset1:179
  v_mfma_f32_16x16x32_bf16 v[48:51], v[68:71], v[100:103], v[48:51]
  v_mfma_f32_16x16x32_bf16 v[52:55], v[68:71], v[104:107], v[52:55]
  s_waitcnt lgkmcnt(6)
  v_mfma_f32_16x16x32_bf16 v[24:27], v[72:75], v[120:123], v[24:27]
  v_add_u32 v14, 256, v14
  v_add_u32 v15, 256, v15
  v_subrev_u32 v18, 256, v18
  v_mfma_f32_16x16x32_bf16 v[28:31], v[72:75], v[124:127], v[28:31]
  ds_read_b128 v[88:91], v18 offset:192
  v_mfma_f32_16x16x32_bf16 v[32:35], v[72:75], v[128:131], v[32:35]
  ds_read_b128 v[92:95], v18 offset:704
  v_mfma_f32_16x16x32_bf16 v[36:39], v[72:75], v[132:135], v[36:39]
  v_mfma_f32_16x16x32_bf16 v[40:43], v[72:75], v[136:139], v[40:43]
  ds_read_b128 v[96:99], v18 offset:1216
  v_mfma_f32_16x16x32_bf16 v[44:47], v[72:75], v[140:143], v[44:47]
  ds_read_b128 v[100:103], v18 offset:1728
  v_mfma_f32_16x16x32_bf16 v[48:51], v[72:75], v[144:147], v[48:51]
  v_mfma_f32_16x16x32_bf16 v[52:55], v[72:75], v[148:151], v[52:55]
  ds_read_b128 v[104:107], v18 offset:2240
  s_waitcnt lgkmcnt(9)
  v_mfma_f32_16x16x32_bf16 v[28:31], v[76:79], v[120:123], v[28:31]
  ds_read_b128 v[108:111], v18 offset:2752
  v_mfma_f32_16x16x32_bf16 v[32:35], v[76:79], v[124:127], v[32:35]
  v_mfma_f32_16x16x32_bf16 v[36:39], v[76:79], v[128:131], v[36:39]
  ds_read_b128 v[112:115], v18 offset:3264
  v_mfma_f32_16x16x32_bf16 v[40:43], v[76:79], v[132:135], v[40:43]
  ds_read_b128 v[116:119], v18 offset:3776
  v_mfma_f32_16x16x32_bf16 v[44:47], v[76:79], v[136:139], v[44:47]
  v_mfma_f32_16x16x32_bf16 v[48:51], v[76:79], v[140:143], v[48:51]
  ds_read2_b32 v[56:57], v14 offset0:0 offset1:1
  v_mfma_f32_16x16x32_bf16 v[52:55], v[76:79], v[144:147], v[52:55]
  ds_read2_b32 v[58:59], v14 offset0:2 offset1:3
  s_waitcnt lgkmcnt(12)
  v_mfma_f32_16x16x32_bf16 v[32:35], v[80:83], v[120:123], v[32:35]
  v_mfma_f32_16x16x32_bf16 v[36:39], v[80:83], v[124:127], v[36:39]
  ds_read2_b32 v[60:61], v14 offset0:128 offset1:129
  v_mfma_f32_16x16x32_bf16 v[40:43], v[80:83], v[128:131], v[40:43]
  ds_read2_b32 v[62:63], v14 offset0:130 offset1:131
  v_mfma_f32_16x16x32_bf16 v[44:47], v[80:83], v[132:135], v[44:47]
  v_mfma_f32_16x16x32_bf16 v[48:51], v[80:83], v[136:139], v[48:51]
  ds_read2_b32 v[64:65], v15 offset0:0 offset1:1
  v_mfma_f32_16x16x32_bf16 v[52:55], v[80:83], v[140:143], v[52:55]
  ds_read2_b32 v[66:67], v15 offset0:2 offset1:3
  s_waitcnt lgkmcnt(14)
  v_mfma_f32_16x16x32_bf16 v[36:39], v[84:87], v[120:123], v[36:39]
  v_mfma_f32_16x16x32_bf16 v[40:43], v[84:87], v[124:127], v[40:43]
  ds_read2_b32 v[68:69], v15 offset0:128 offset1:129
  v_mfma_f32_16x16x32_bf16 v[44:47], v[84:87], v[128:131], v[44:47]
  ds_read2_b32 v[70:71], v15 offset0:130 offset1:131
  v_mfma_f32_16x16x32_bf16 v[48:51], v[84:87], v[132:135], v[48:51]
  v_mfma_f32_16x16x32_bf16 v[52:55], v[84:87], v[136:139], v[52:55]
  s_waitcnt lgkmcnt(6)
  v_mfma_f32_16x16x32_bf16 v[24:27], v[56:59], v[88:91], v[24:27]
  ds_read_b128 v[120:123], v18 offset:128
  v_mfma_f32_16x16x32_bf16 v[28:31], v[56:59], v[92:95], v[28:31]
  ds_read_b128 v[124:127], v18 offset:640
  v_mfma_f32_16x16x32_bf16 v[32:35], v[56:59], v[96:99], v[32:35]
  v_mfma_f32_16x16x32_bf16 v[36:39], v[56:59], v[100:103], v[36:39]
  ds_read_b128 v[128:131], v18 offset:1152
  v_mfma_f32_16x16x32_bf16 v[40:43], v[56:59], v[104:107], v[40:43]
  ds_read_b128 v[132:135], v18 offset:1664
  v_mfma_f32_16x16x32_bf16 v[44:47], v[56:59], v[108:111], v[44:47]
  v_mfma_f32_16x16x32_bf16 v[48:51], v[56:59], v[112:115], v[48:51]
  ds_read_b128 v[136:139], v18 offset:2176
  v_mfma_f32_16x16x32_bf16 v[52:55], v[56:59], v[116:119], v[52:55]
  ds_read_b128 v[140:143], v18 offset:2688
  s_waitcnt lgkmcnt(10)
  v_mfma_f32_16x16x32_bf16 v[28:31], v[60:63], v[88:91], v[28:31]
  v_mfma_f32_16x16x32_bf16 v[32:35], v[60:63], v[92:95], v[32:35]
  ds_read_b128 v[144:147], v18 offset:3200
  v_mfma_f32_16x16x32_bf16 v[36:39], v[60:63], v[96:99], v[36:39]
  ds_read_b128 v[148:151], v18 offset:3712
  v_mfma_f32_16x16x32_bf16 v[40:43], v[60:63], v[100:103], v[40:43]
  v_mfma_f32_16x16x32_bf16 v[44:47], v[60:63], v[104:107], v[44:47]
  ds_read2_b32 v[72:73], v14 offset0:16 offset1:17
  v_mfma_f32_16x16x32_bf16 v[48:51], v[60:63], v[108:111], v[48:51]
  v_mfma_f32_16x16x32_bf16 v[52:55], v[60:63], v[112:115], v[52:55]
  ds_read2_b32 v[74:75], v14 offset0:18 offset1:19
  s_waitcnt lgkmcnt(12)
  v_mfma_f32_16x16x32_bf16 v[32:35], v[64:67], v[88:91], v[32:35]
  ds_read2_b32 v[76:77], v14 offset0:144 offset1:145
  v_mfma_f32_16x16x32_bf16 v[36:39], v[64:67], v[92:95], v[36:39]
  v_mfma_f32_16x16x32_bf16 v[40:43], v[64:67], v[96:99], v[40:43]
  ds_read2_b32 v[78:79], v14 offset0:146 offset1:147
  v_mfma_f32_16x16x32_bf16 v[44:47], v[64:67], v[100:103], v[44:47]
  ds_read2_b32 v[80:81], v15 offset0:16 offset1:17
  v_mfma_f32_16x16x32_bf16 v[48:51], v[64:67], v[104:107], v[48:51]
  v_mfma_f32_16x16x32_bf16 v[52:55], v[64:67], v[108:111], v[52:55]
  ds_read2_b32 v[82:83], v15 offset0:18 offset1:19
  s_waitcnt lgkmcnt(14)
  v_mfma_f32_16x16x32_bf16 v[36:39], v[68:71], v[88:91], v[36:39]
  ds_read2_b32 v[84:85], v15 offset0:144 offset1:145
  v_mfma_f32_16x16x32_bf16 v[40:43], v[68:71], v[92:95], v[40:43]
  v_mfma_f32_16x16x32_bf16 v[44:47], v[68:71], v[96:99], v[44:47]
  ds_read2_b32 v[86:87], v15 offset0:146 offset1:147
  v_mfma_f32_16x16x32_bf16 v[48:51], v[68:71], v[100:103], v[48:51]
  v_mfma_f32_16x16x32_bf16 v[52:55], v[68:71], v[104:107], v[52:55]
  s_waitcnt lgkmcnt(6)
  v_mfma_f32_16x16x32_bf16 v[24:27], v[72:75], v[120:123], v[24:27]
  ds_read_b128 v[88:91], v18 offset:64
  v_mfma_f32_16x16x32_bf16 v[28:31], v[72:75], v[124:127], v[28:31]
  ds_read_b128 v[92:95], v18 offset:576
  v_mfma_f32_16x16x32_bf16 v[32:35], v[72:75], v[128:131], v[32:35]
  v_mfma_f32_16x16x32_bf16 v[36:39], v[72:75], v[132:135], v[36:39]
  ds_read_b128 v[96:99], v18 offset:1088
  v_mfma_f32_16x16x32_bf16 v[40:43], v[72:75], v[136:139], v[40:43]
  ds_read_b128 v[100:103], v18 offset:1600
  v_mfma_f32_16x16x32_bf16 v[44:47], v[72:75], v[140:143], v[44:47]
  v_mfma_f32_16x16x32_bf16 v[48:51], v[72:75], v[144:147], v[48:51]
  ds_read_b128 v[104:107], v18 offset:2112
  v_mfma_f32_16x16x32_bf16 v[52:55], v[72:75], v[148:151], v[52:55]
  ds_read_b128 v[108:111], v18 offset:2624
  s_waitcnt lgkmcnt(10)
  v_mfma_f32_16x16x32_bf16 v[28:31], v[76:79], v[120:123], v[28:31]
  v_mfma_f32_16x16x32_bf16 v[32:35], v[76:79], v[124:127], v[32:35]
  ds_read_b128 v[112:115], v18 offset:3136
  v_mfma_f32_16x16x32_bf16 v[36:39], v[76:79], v[128:131], v[36:39]
  ds_read_b128 v[116:119], v18 offset:3648
  v_mfma_f32_16x16x32_bf16 v[40:43], v[76:79], v[132:135], v[40:43]
  v_mfma_f32_16x16x32_bf16 v[44:47], v[76:79], v[136:139], v[44:47]
  ds_read2_b32 v[56:57], v14 offset0:32 offset1:33
  v_mfma_f32_16x16x32_bf16 v[48:51], v[76:79], v[140:143], v[48:51]
  v_mfma_f32_16x16x32_bf16 v[52:55], v[76:79], v[144:147], v[52:55]
  ds_read2_b32 v[58:59], v14 offset0:34 offset1:35
  s_waitcnt lgkmcnt(12)
  v_mfma_f32_16x16x32_bf16 v[32:35], v[80:83], v[120:123], v[32:35]
  ds_read2_b32 v[60:61], v14 offset0:160 offset1:161
  v_mfma_f32_16x16x32_bf16 v[36:39], v[80:83], v[124:127], v[36:39]
  v_mfma_f32_16x16x32_bf16 v[40:43], v[80:83], v[128:131], v[40:43]
  ds_read2_b32 v[62:63], v14 offset0:162 offset1:163
  v_mfma_f32_16x16x32_bf16 v[44:47], v[80:83], v[132:135], v[44:47]
  ds_read2_b32 v[64:65], v15 offset0:32 offset1:33
  v_mfma_f32_16x16x32_bf16 v[48:51], v[80:83], v[136:139], v[48:51]
  v_mfma_f32_16x16x32_bf16 v[52:55], v[80:83], v[140:143], v[52:55]
  ds_read2_b32 v[66:67], v15 offset0:34 offset1:35
  s_waitcnt lgkmcnt(14)
  v_mfma_f32_16x16x32_bf16 v[36:39], v[84:87], v[120:123], v[36:39]
  ds_read2_b32 v[68:69], v15 offset0:160 offset1:161
  v_mfma_f32_16x16x32_bf16 v[40:43], v[84:87], v[124:127], v[40:43]
  v_mfma_f32_16x16x32_bf16 v[44:47], v[84:87], v[128:131], v[44:47]
  ds_read2_b32 v[70:71], v15 offset0:162 offset1:163
  v_mfma_f32_16x16x32_bf16 v[48:51], v[84:87], v[132:135], v[48:51]
  v_mfma_f32_16x16x32_bf16 v[52:55], v[84:87], v[136:139], v[52:55]
  s_waitcnt lgkmcnt(6)
  s_cmp_ge_u32 s5, 24
  s_cbranch_scc1 Lsk23
  s_barrier
Lsk23:
  v_mfma_f32_16x16x32_bf16 v[24:27], v[56:59], v[88:91], v[24:27]
  ds_read_b128 v[120:123], v18 offset:0
  v_mfma_f32_16x16x32_bf16 v[28:31], v[56:59], v[92:95], v[28:31]
  ds_read_b128 v[124:127], v18 offset:512
  v_mfma_f32_16x16x32_bf16 v[32:35], v[56:59], v[96:99], v[32:35]
  v_mfma_f32_16x16x32_bf16 v[36:39], v[56:59], v[100:103], v[36:39]
  ds_read_b128 v[128:131], v18 offset:1024
  v_mfma_f32_16x16x32_bf16 v[40:43], v[56:59], v[104:107], v[40:43]
  ds_read_b128 v[132:135], v18 offset:1536
  v_mfma_f32_16x16x32_bf16 v[44:47], v[56:59], v[108:111], v[44:47]
  v_mfma_f32_16x16x32_bf16 v[48:51], v[56:59], v[112:115], v[48:51]
  ds_read_b128 v[136:139], v18 offset:2048
  v_mfma_f32_16x16x32_bf16 v[52:55], v[56:59], v[116:119], v[52:55]
  ds_read_b128 v[140:143], v18 offset:2560
  s_waitcnt lgkmcnt(10)
  v_mfma_f32_16x16x32_bf16 v[28:31], v[60:63], v[88:91], v[28:31]
  v_mfma_f32_16x16x32_bf16 v[32:35], v[60:63], v[92:95], v[32:35]
  ds_read_b128 v[144:147], v18 offset:3072
  v_mfma_f32_16x16x32_bf16 v[36:39], v[60:63], v[96:99], v[36:39]
  ds_read_b128 v[148:151], v18 offset:3584
  v_mfma_f32_16x16x32_bf16 v[40:43], v[60:63], v[100:103], v[40:43]
  v_mfma_f32_16x16x32_bf16 v[44:47], v[60:63], v[104:107], v[44:47]
  ds_read2_b32 v[72:73], v14 offset0:48 offset1:49
  v_mfma_f32_16x16x32_bf16 v[48:51], v[60:63], v[108:111], v[48:51]
  v_mfma_f32_16x16x32_bf16 v[52:55], v[60:63], v[112:115], v[52:55]
  ds_read2_b32 v[74:75], v14 offset0:50 offset1:51
  s_waitcnt lgkmcnt(12)
  v_mfma_f32_16x16x32_bf16 v[32:35], v[64:67], v[88:91], v[32:35]
  ds_read2_b32 v[76:77], v14 offset0:176 offset1:177
  v_mfma_f32_16x16x32_bf16 v[36:39], v[64:67], v[92:95], v[36:39]
  v_mfma_f32_16x16x32_bf16 v[40:43], v[64:67], v[96:99], v[40:43]
  ds_read2_b32 v[78:79], v14 offset0:178 offset1:179
  v_mfma_f32_16x16x32_bf16 v[44:47], v[64:67], v[100:103], v[44:47]
  ds_read2_b32 v[80:81], v15 offset0:48 offset1:49
  v_mfma_f32_16x16x32_bf16 v[48:51], v[64:67], v[104:107], v[48:51]
  v_mfma_f32_16x16x32_bf16 v[52:55], v[64:67], v[108:111], v[52:55]
  ds_read2_b32 v[82:83], v15 offset0:50 offset1:51
  s_waitcnt lgkmcnt(14)
  v_mfma_f32_16x16x32_bf16 v[36:39], v[68:71], v[88:91], v[36:39]
  ds_read2_b32 v[84:85], v15 offset0:176 offset1:177
  v_mfma_f32_16x16x32_bf16 v[40:43], v[68:71], v[92:95], v[40:43]
  v_mfma_f32_16x16x32_bf16 v[44:47], v[68:71], v[96:99], v[44:47]
  ds_read2_b32 v[86:87], v15 offset0:178 offset1:179
  v_mfma_f32_16x16x32_bf16 v[48:51], v[68:71], v[100:103], v[48:51]
  v_mfma_f32_16x16x32_bf16 v[52:55], v[68:71], v[104:107], v[52:55]
  s_waitcnt lgkmcnt(6)
  s_cmp_lt_u32 s5, 24
  s_cbranch_scc1 Lsk24
  s_barrier
Lsk24:
  v_mfma_f32_16x16x32_bf16 v[24:27], v[72:75], v[120:123], v[24:27]
  v_add_u32 v14, s94, v14
  v_add_u32 v15, s94, v15
  v_add_u32 v16, s93, v16
  v_add_u32 v17, s93, v17
  v_add_u32 v18, s92, v18
  v_mfma_f32_16x16x32_bf16 v[28:31], v[72:75], v[124:127], v[28:31]
  ds_read_b128 v[88:91], v18 offset:192
  v_mfma_f32_16x16x32_bf16 v[32:35], v[72:75], v[128:131], v[32:35]
  ds_read_b128 v[92:95], v18 offset:704
  s_waitcnt lgkmcnt(6)
  v_mfma_f32_16x16x32_bf16 v[28:31], v[76:79], v[120:123], v[28:31]
  ds_read_b128 v[96:99], v18 offset:1216
  v_mfma_f32_16x16x32_bf16 v[32:35], v[76:79], v[124:127], v[32:35]
  ds_read_b128 v[100:103], v18 offset:1728
  v_mfma_f32_16x16x32_bf16 v[36:39], v[72:75], v[132:135], v[36:39]
  ds_read_b128 v[104:107], v18 offset:2240
  v_cvt_pk_bf16_f32 v152, v24, v25
  v_cvt_pk_bf16_f32 v153, v26, v27
  s_waitcnt lgkmcnt(7)
  v_mfma_f32_16x16x32_bf16 v[32:35], v[80:83], v[120:123], v[32:35]
  ds_write_b64 v20, v[152:153] offset:0
  v_mfma_f32_16x16x32_bf16 v[36:39], v[76:79], v[128:131], v[36:39]
  ds_read_b128 v[108:111], v18 offset:2752
  v_mfma_f32_16x16x32_bf16 v[40:43], v[72:75], v[136:139], v[40:43]
  v_cvt_pk_bf16_f32 v154, v28, v29
  v_cvt_pk_bf16_f32 v155, v30, v31
  v_mfma_f32_16x16x32_bf16 v[36:39], v[80:83], v[124:127], v[36:39]
  ds_write_b64 v20, v[154:155] offset:512
  v_mfma_f32_16x16x32_bf16 v[40:43], v[76:79], v[132:135], v[40:43]
  ds_read_b128 v[112:115], v18 offset:3264
  s_waitcnt lgkmcnt(9)
  v_mfma_f32_16x16x32_bf16 v[36:39], v[84:87], v[120:123], v[36:39]
  ds_read_b128 v[116:119], v18 offset:3776
  v_cvt_pk_bf16_f32 v152, v32, v33
  v_cvt_pk_bf16_f32 v153, v34, v35
  v_mfma_f32_16x16x32_bf16 v[40:43], v[80:83], v[128:131], v[40:43]
  ds_write_b64 v20, v[152:153] offset:1024
  v_mfma_f32_16x16x32_bf16 v[44:47], v[72:75], v[140:143], v[44:47]
  ds_read2_b32 v[56:57], v14 offset0:0 offset1:1
  v_mfma_f32_16x16x32_bf16 v[40:43], v[84:87], v[124:127], v[40:43]
  ds_read2_b32 v[58:59], v14 offset0:2 offset1:3
  v_mfma_f32_16x16x32_bf16 v[44:47], v[76:79], v[136:139], v[44:47]
  ds_read2_b32 v[60:61], v14 offset0:128 offset1:129
  v_mfma_f32_16x16x32_bf16 v[48:51], v[72:75], v[144:147], v[48:51]
  v_cvt_pk_bf16_f32 v154, v36, v37
  v_cvt_pk_bf16_f32 v155, v38, v39
  v_mfma_f32_16x16x32_bf16 v[44:47], v[80:83], v[132:135], v[44:47]
  ds_write_b64 v20, v[154:155] offset:1536
  v_mfma_f32_16x16x32_bf16 v[48:51], v[76:79], v[140:143], v[48:51]
  ds_read2_b32 v[62:63], v14 offset0:130 offset1:131
  v_mfma_f32_16x16x32_bf16 v[44:47], v[84:87], v[128:131], v[44:47]
  ds_read2_b32 v[64:65], v15 offset0:0 offset1:1
  v_cvt_pk_bf16_f32 v152, v40, v41
  v_cvt_pk_bf16_f32 v153, v42, v43
  v_mfma_f32_16x16x32_bf16 v[48:51], v[80:83], v[136:139], v[48:51]
  ds_write_b64 v20, v[152:153] offset:2048
  v_mfma_f32_16x16x32_bf16 v[52:55], v[72:75], v[148:151], v[52:55]
  ds_read2_b32 v[66:67], v15 offset0:2 offset1:3
  v_mfma_f32_16x16x32_bf16 v[48:51], v[84:87], v[132:135], v[48:51]
  ds_read2_b32 v[68:69], v15 offset0:128 offset1:129
  v_mfma_f32_16x16x32_bf16 v[52:55], v[76:79], v[144:147], v[52:55]
  ds_read2_b32 v[70:71], v15 offset0:130 offset1:131
  v_mfma_f32_16x16x32_bf16 v[52:55], v[80:83], v[140:143], v[52:55]
  v_cvt_pk_bf16_f32 v154, v44, v45
  v_cvt_pk_bf16_f32 v155, v46, v47
  v_mfma_f32_16x16x32_bf16 v[52:55], v[84:87], v[136:139], v[52:55]
  ds_write_b64 v20, v[154:155] offset:2560
  v_cvt_pk_bf16_f32 v152, v48, v49
  v_cvt_pk_bf16_f32 v153, v50, v51
  ds_write_b64 v20, v[152:153] offset:3072
  s_nop 3
  v_cvt_pk_bf16_f32 v154, v52, v53
  v_cvt_pk_bf16_f32 v155, v54, v55
  ds_write_b64 v20, v[154:155] offset:3584
  s_cmp_lt_u32 s5, 24
  s_cbranch_scc1 L_V4
  s_waitcnt lgkmcnt(11)
  v_mfma_f32_16x16x32_bf16 v[24:27], v[56:59], v[88:91], 0
  ds_read_b128 v[156:159], v18 offset:176
  v_mfma_f32_16x16x32_bf16 v[28:31], v[56:59], v[92:95], 0
  ds_read_b128 v[160:163], v18 offset:688
  v_mfma_f32_16x16x32_bf16 v[32:35], v[56:59], v[96:99], 0
  ds_read_b128 v[164:167], v18 offset:1200
  v_mfma_f32_16x16x32_bf16 v[36:39], v[56:59], v[100:103], 0
  ds_read_b128 v[168:171], v18 offset:1712
  v_mfma_f32_16x16x32_bf16 v[40:43], v[56:59], v[104:107], 0
  ds_read2_b32 v[172:173], v16 offset0:0 offset1:1
  v_mfma_f32_16x16x32_bf16 v[44:47], v[56:59], v[108:111], 0
  ds_read2_b32 v[174:175], v16 offset0:2 offset1:3
  v_mfma_f32_16x16x32_bf16 v[48:51], v[56:59], v[112:115], 0
  ds_read_b128 v[120:123], v18 offset:128
  v_mfma_f32_16x16x32_bf16 v[52:55], v[56:59], v[116:119], 0
  ds_read_b128 v[124:127], v18 offset:640
  s_waitcnt lgkmcnt(15)
  v_mfma_f32_16x16x32_bf16 v[28:31], v[60:63], v[88:91], v[28:31]
  v_mfma_f32_16x16x32_bf16 v[32:35], v[60:63], v[92:95], v[32:35]
  ds_read_b128 v[128:131], v18 offset:1152
  v_mfma_f32_16x16x32_bf16 v[36:39], v[60:63], v[96:99], v[36:39]
  ds_read_b128 v[132:135], v18 offset:1664
  v_mfma_f32_16x16x32_bf16 v[40:43], v[60:63], v[100:103], v[40:43]
  ds_read_b128 v[136:139], v18 offset:2176
  v_mfma_f32_16x16x32_bf16 v[44:47], v[60:63], v[104:107], v[44:47]
  ds_read_b128 v[140:143], v18 offset:2688
  v_mfma_f32_16x16x32_bf16 v[48:51], v[60:63], v[108:111], v[48:51]
  ds_read_b128 v[144:147], v18 offset:3200
  v_mfma_f32_16x16x32_bf16 v[52:55], v[60:63], v[112:115], v[52:55]
  ds_read_b128 v[148:151], v18 offset:3712
  s_waitcnt lgkmcnt(15)
  v_mfma_f32_16x16x32_bf16 v[32:35], v[64:67], v[88:91], v[32:35]
  ds_read2_b32 v[72:73], v14 offset0:16 offset1:17
  v_mfma_f32_16x16x32_bf16 v[36:39], v[64:67], v[92:95], v[36:39]
  v_mfma_f32_16x16x32_bf16 v[40:43], v[64:67], v[96:99], v[40:43]
  ds_read2_b32 v[74:75], v14 offset0:18 offset1:19
  v_mfma_f32_16x16x32_bf16 v[44:47], v[64:67], v[100:103], v[44:47]
  ds_read2_b32 v[76:77], v14 offset0:144 offset1:145
  v_mfma_f32_16x16x32_bf16 v[48:51], v[64:67], v[104:107], v[48:51]
  ds_read2_b32 v[78:79], v14 offset0:146 offset1:147
  v_mfma_f32_16x16x32_bf16 v[52:55], v[64:67], v[108:111], v[52:55]
  ds_read2_b32 v[80:81], v15 offset0:16 offset1:17
  s_waitcnt lgkmcnt(15)
  v_mfma_f32_16x16x32_bf16 v[36:39], v[68:71], v[88:91], v[36:39]
  ds_read2_b32 v[82:83], v15 offset0:18 offset1:19
  v_mfma_f32_16x16x32_bf16 v[40:43], v[68:71], v[92:95], v[40:43]
  ds_read2_b32 v[84:85], v15 offset0:144 offset1:145
  v_mfma_f32_16x16x32_bf16 v[44:47], v[68:71], v[96:99], v[44:47]
  ds_read2_b32 v[86:87], v15 offset0:146 offset1:147
  v_mfma_f32_16x16x32_bf16 v[48:51], v[68:71], v[100:103], v[48:51]
  v_mfma_f32_16x16x32_bf16 v[52:55], v[68:71], v[104:107], v[52:55]
  s_cmp_lg_u32 s77, 0
  s_cbranch_scc1 Lsk25
  v_mfma_f32_16x16x32_bf16 v[192:195], v[88:91], v[4:7], 0
  s_waitcnt lgkmcnt(15)
  v_mfma_f32_16x16x32_bf16 v[196:199], v[156:159], v[8:11], 0
  s_waitcnt lgkmcnt(15)
  v_mfma_f32_16x16x32_bf16 v[40:43], v[172:175], v[88:91], v[40:43]
  v_mfma_f32_16x16x32_bf16 v[200:203], v[92:95], v[4:7], 0
  v_mfma_f32_16x16x32_bf16 v[204:207], v[160:163], v[8:11], 0
  v_mfma_f32_16x16x32_bf16 v[44:47], v[172:175], v[92:95], v[44:47]
  v_mfma_f32_16x16x32_bf16 v[208:211], v[96:99], v[4:7], 0
  v_mfma_f32_16x16x32_bf16 v[212:215], v[164:167], v[8:11], 0
  v_mfma_f32_16x16x32_bf16 v[48:51], v[172:175], v[96:99], v[48:51]
  v_mfma_f32_16x16x32_bf16 v[216:219], v[100:103], v[4:7], 0
  v_mfma_f32_16x16x32_bf16 v[220:223], v[168:171], v[8:11], 0
  v_mfma_f32_16x16x32_bf16 v[52:55], v[172:175], v[100:103], v[52:55]
Lsk25:
  s_waitcnt lgkmcnt(0)
  s_barrier
  v_mfma_f32_16x16x32_bf16 v[24:27], v[72:75], v[120:123], v[24:27]
  ds_read2_b32 v[188:189], v17 offset0:51 offset1:50
  v_mfma_f32_16x16x32_bf16 v[28:31], v[72:75], v[124:127], v[28:31]
  ds_read2_b32 v[190:191], v17 offset0:49 offset1:48
  v_mfma_f32_16x16x32_bf16 v[32:35], v[72:75], v[128:131], v[32:35]
  ds_read2_b32 v[184:185], v17 offset0:35 offset1:34
  v_mfma_f32_16x16x32_bf16 v[36:39], v[72:75], v[132:135], v[36:39]
  ds_read2_b32 v[186:187], v17 offset0:33 offset1:32
  v_mfma_f32_16x16x32_bf16 v[40:43], v[72:75], v[136:139], v[40:43]
  ds_read2_b32 v[180:181], v17 offset0:19 offset1:18
  v_mfma_f32_16x16x32_bf16 v[44:47], v[72:75], v[140:143], v[44:47]
  ds_read2_b32 v[182:183], v17 offset0:17 offset1:16
  v_mfma_f32_16x16x32_bf16 v[48:51], v[72:75], v[144:147], v[48:51]
  ds_read2_b32 v[176:177], v17 offset0:3 offset1:2
  v_cvt_pk_bf16_f32 v156, v192, v196
  v_mfma_f32_16x16x32_bf16 v[52:55], v[72:75], v[148:151], v[52:55]
  ds_read2_b32 v[178:179], v17 offset0:1 offset1:0
  v_cvt_pk_bf16_f32 v157, v193, v197
  v_mfma_f32_16x16x32_bf16 v[28:31], v[76:79], v[120:123], v[28:31]
  ds_read_b128 v[88:91], v18 offset:64
  v_cvt_pk_bf16_f32 v158, v194, v198
  v_mfma_f32_16x16x32_bf16 v[32:35], v[76:79], v[124:127], v[32:35]
  ds_read_b128 v[92:95], v18 offset:576
  v_cvt_pk_bf16_f32 v159, v195, v199
  v_mfma_f32_16x16x32_bf16 v[36:39], v[76:79], v[128:131], v[36:39]
  ds_read_b128 v[96:99], v18 offset:1088
  v_cvt_pk_bf16_f32 v160, v200, v204
  v_mfma_f32_16x16x32_bf16 v[40:43], v[76:79], v[132:135], v[40:43]
  ds_read_b128 v[100:103], v18 offset:1600
  v_cvt_pk_bf16_f32 v161, v201, v205
  v_mfma_f32_16x16x32_bf16 v[44:47], v[76:79], v[136:139], v[44:47]
  ds_read_b128 v[104:107], v18 offset:2112
  v_cvt_pk_bf16_f32 v162, v202, v206
  v_mfma_f32_16x16x32_bf16 v[48:51], v[76:79], v[140:143], v[48:51]
  ds_read_b128 v[108:111], v18 offset:2624
  v_cvt_pk_bf16_f32 v163, v203, v207
  v_mfma_f32_16x16x32_bf16 v[52:55], v[76:79], v[144:147], v[52:55]
  ds_read_b128 v[112:115], v18 offset:3136
  v_cvt_pk_bf16_f32 v164, v208, v212
  v_mfma_f32_16x16x32_bf16 v[32:35], v[80:83], v[120:123], v[32:35]
  ds_read_b128 v[116:119], v18 offset:3648
  v_cvt_pk_bf16_f32 v165, v209, v213
  v_mfma_f32_16x16x32_bf16 v[36:39], v[80:83], v[124:127], v[36:39]
  ds_read2_b32 v[56:57], v14 offset0:32 offset1:33
  v_cvt_pk_bf16_f32 v166, v210, v214
  v_mfma_f32_16x16x32_bf16 v[40:43], v[80:83], v[128:131], v[40:43]
  ds_read2_b32 v[58:59], v14 offset0:34 offset1:35
  v_cvt_pk_bf16_f32 v167, v211, v215
  v_mfma_f32_16x16x32_bf16 v[44:47], v[80:83], v[132:135], v[44:47]
  ds_read2_b32 v[60:61], v14 offset0:160 offset1:161
  v_cvt_pk_bf16_f32 v168, v216, v220
  v_mfma_f32_16x16x32_bf16 v[48:51], v[80:83], v[136:139], v[48:51]
  ds_read2_b32 v[62:63], v14 offset0:162 offset1:163
  v_cvt_pk_bf16_f32 v169, v217, v221
  v_mfma_f32_16x16x32_bf16 v[52:55], v[80:83], v[140:143], v[52:55]
  ds_read2_b32 v[64:65], v15 offset0:32 offset1:33
  v_cvt_pk_bf16_f32 v170, v218, v222
  v_mfma_f32_16x16x32_bf16 v[36:39], v[84:87], v[120:123], v[36:39]
  ds_read2_b32 v[66:67], v15 offset0:34 offset1:35
  v_cvt_pk_bf16_f32 v171, v219, v223
  v_mfma_f32_16x16x32_bf16 v[40:43], v[84:87], v[124:127], v[40:43]
  ds_read2_b32 v[68:69], v15 offset0:160 offset1:161
  v_mfma_f32_16x16x32_bf16 v[44:47], v[84:87], v[128:131], v[44:47]
  ds_read2_b32 v[70:71], v15 offset0:162 offset1:163
  v_mfma_f32_16x16x32_bf16 v[48:51], v[84:87], v[132:135], v[48:51]
  v_mfma_f32_16x16x32_bf16 v[52:55], v[84:87], v[136:139], v[52:55]
  s_waitcnt lgkmcnt(6)
  s_cmp_lg_u32 s77, 0
  s_cbranch_scc1 Lsk26
  v_mfma_f32_16x16x32_bf16 v[40:43], v[156:159], v[176:179], v[40:43]
  v_mfma_f32_16x16x32_bf16 v[44:47], v[160:163], v[176:179], v[44:47]
  v_mfma_f32_16x16x32_bf16 v[48:51], v[164:167], v[176:179], v[48:51]
  v_mfma_f32_16x16x32_bf16 v[52:55], v[168:171], v[176:179], v[52:55]
  v_mfma_f32_16x16x32_bf16 v[44:47], v[156:159], v[180:183], v[44:47]
  v_mfma_f32_16x16x32_bf16 v[48:51], v[160:163], v[180:183], v[48:51]
  v_mfma_f32_16x16x32_bf16 v[52:55], v[164:167], v[180:183], v[52:55]
  v_mfma_f32_16x16x32_bf16 v[48:51], v[156:159], v[184:187], v[48:51]
  v_mfma_f32_16x16x32_bf16 v[52:55], v[160:163], v[184:187], v[52:55]
  v_mfma_f32_16x16x32_bf16 v[52:55], v[156:159], v[188:191], v[52:55]
Lsk26:
  v_mfma_f32_16x16x32_bf16 v[24:27], v[56:59], v[88:91], v[24:27]
  ds_read_b128 v[120:123], v18 offset:0
  v_mfma_f32_16x16x32_bf16 v[28:31], v[56:59], v[92:95], v[28:31]
  ds_read_b128 v[124:127], v18 offset:512
  v_mfma_f32_16x16x32_bf16 v[32:35], v[56:59], v[96:99], v[32:35]
  v_mfma_f32_16x16x32_bf16 v[36:39], v[56:59], v[100:103], v[36:39]
  ds_read_b128 v[128:131], v18 offset:1024
  v_mfma_f32_16x16x32_bf16 v[40:43], v[56:59], v[104:107], v[40:43]
  ds_read_b128 v[132:135], v18 offset:1536
  v_mfma_f32_16x16x32_bf16 v[44:47], v[56:59], v[108:111], v[44:47]
  v_mfma_f32_16x16x32_bf16 v[48:51], v[56:59], v[112:115], v[48:51]
  ds_read_b128 v[136:139], v18 offset:2048
  v_mfma_f32_16x16x32_bf16 v[52:55], v[56:59], v[116:119], v[52:55]
  ds_read_b128 v[140:143], v18 offset:2560
  s_waitcnt lgkmcnt(10)
  v_mfma_f32_16x16x32_bf16 v[28:31], v[60:63], v[88:91], v[28:31]
  v_mfma_f32_16x16x32_bf16 v[32:35], v[60:63], v[92:95], v[32:35]
  ds_read_b128 v[144:147], v18 offset:3072
  v_mfma_f32_16x16x32_bf16 v[36:39], v[60:63], v[96:99], v[36:39]
  ds_read_b128 v[148:151], v18 offset:3584
  v_mfma_f32_16x16x32_bf16 v[40:43], v[60:63], v[100:103], v[40:43]
  v_mfma_f32_16x16x32_bf16 v[44:47], v[60:63], v[104:107], v[44:47]
  ds_read2_b32 v[72:73], v14 offset0:48 offset1:49
  v_mfma_f32_16x16x32_bf16 v[48:51], v[60:63], v[108:111], v[48:51]
  v_mfma_f32_16x16x32_bf16 v[52:55], v[60:63], v[112:115], v[52:55]
  ds_read2_b32 v[74:75], v14 offset0:50 offset1:51
  s_waitcnt lgkmcnt(12)
  v_mfma_f32_16x16x32_bf16 v[32:35], v[64:67], v[88:91], v[32:35]
  ds_read2_b32 v[76:77], v14 offset0:176 offset1:177
  v_mfma_f32_16x16x32_bf16 v[36:39], v[64:67], v[92:95], v[36:39]
  v_mfma_f32_16x16x32_bf16 v[40:43], v[64:67], v[96:99], v[40:43]
  ds_read2_b32 v[78:79], v14 offset0:178 offset1:179
  v_mfma_f32_16x16x32_bf16 v[44:47], v[64:67], v[100:103], v[44:47]
  ds_read2_b32 v[80:81], v15 offset0:48 offset1:49
  v_mfma_f32_16x16x32_bf16 v[48:51], v[64:67], v[104:107], v[48:51]
  v_mfma_f32_16x16x32_bf16 v[52:55], v[64:67], v[108:111], v[52:55]
  ds_read2_b32 v[82:83], v15 offset0:50 offset1:51
  s_waitcnt lgkmcnt(14)
  v_mfma_f32_16x16x32_bf16 v[36:39], v[68:71], v[88:91], v[36:39]
  ds_read2_b32 v[84:85], v15 offset0:176 offset1:177
  v_mfma_f32_16x16x32_bf16 v[40:43], v[68:71], v[92:95], v[40:43]
  v_mfma_f32_16x16x32_bf16 v[44:47], v[68:71], v[96:99], v[44:47]
  ds_read2_b32 v[86:87], v15 offset0:178 offset1:179
  v_mfma_f32_16x16x32_bf16 v[48:51], v[68:71], v[100:103], v[48:51]
  v_mfma_f32_16x16x32_bf16 v[52:55], v[68:71], v[104:107], v[52:55]
  s_waitcnt lgkmcnt(6)
  v_mfma_f32_16x16x32_bf16 v[24:27], v[72:75], v[120:123], v[24:27]
  v_mfma_f32_16x16x32_bf16 v[28:31], v[72:75], v[124:127], v[28:31]
  v_mfma_f32_16x16x32_bf16 v[32:35], v[72:75], v[128:131], v[32:35]
  s_waitcnt lgkmcnt(4)
  v_mfma_f32_16x16x32_bf16 v[28:31], v[76:79], v[120:123], v[28:31]
  v_mfma_f32_16x16x32_bf16 v[32:35], v[76:79], v[124:127], v[32:35]
  v_mfma_f32_16x16x32_bf16 v[36:39], v[72:75], v[132:135], v[36:39]
  s_nop 1
  ds_write_b128 v19, v[24:27] offset:0
  s_waitcnt lgkmcnt(3)
  v_mfma_f32_16x16x32_bf16 v[32:35], v[80:83], v[120:123], v[32:35]
  v_mfma_f32_16x16x32_bf16 v[36:39], v[76:79], v[128:131], v[36:39]
  v_mfma_f32_16x16x32_bf16 v[40:43], v[72:75], v[136:139], v[40:43]
  ds_write_b128 v19, v[28:31] offset:1024
  v_mfma_f32_16x16x32_bf16 v[36:39], v[80:83], v[124:127], v[36:39]
  v_mfma_f32_16x16x32_bf16 v[40:43], v[76:79], v[132:135], v[40:43]
  s_waitcnt lgkmcnt(2)
  v_mfma_f32_16x16x32_bf16 v[36:39], v[84:87], v[120:123], v[36:39]
  s_nop 0
  ds_write_b128 v19, v[32:35] offset:2048
  v_mfma_f32_16x16x32_bf16 v[40:43], v[80:83], v[128:131], v[40:43]
  v_mfma_f32_16x16x32_bf16 v[44:47], v[72:75], v[140:143], v[44:47]
  v_mfma_f32_16x16x32_bf16 v[40:43], v[84:87], v[124:127], v[40:43]
  v_mfma_f32_16x16x32_bf16 v[44:47], v[76:79], v[136:139], v[44:47]
  v_mfma_f32_16x16x32_bf16 v[48:51], v[72:75], v[144:147], v[48:51]
  s_nop 0
  ds_write_b128 v19, v[36:39] offset:3072
  v_mfma_f32_16x16x32_bf16 v[44:47], v[80:83], v[132:135], v[44:47]
  v_mfma_f32_16x16x32_bf16 v[48:51], v[76:79], v[140:143], v[48:51]
  v_mfma_f32_16x16x32_bf16 v[44:47], v[84:87], v[128:131], v[44:47]
  s_nop 0
  ds_write_b128 v19, v[40:43] offset:4096
  v_mfma_f32_16x16x32_bf16 v[48:51], v[80:83], v[136:139], v[48:51]
  v_mfma_f32_16x16x32_bf16 v[52:55], v[72:75], v[148:151], v[52:55]
  v_mfma_f32_16x16x32_bf16 v[48:51], v[84:87], v[132:135], v[48:51]
  v_mfma_f32_16x16x32_bf16 v[52:55], v[76:79], v[144:147], v[52:55]
  v_mfma_f32_16x16x32_bf16 v[52:55], v[80:83], v[140:143], v[52:55]
  s_nop 0
  ds_write_b128 v19, v[44:47] offset:5120
  v_mfma_f32_16x16x32_bf16 v[52:55], v[84:87], v[136:139], v[52:55]
  s_nop 2
  ds_write_b128 v19, v[48:51] offset:6144
  s_nop 3
  ds_write_b128 v19, v[52:55] offset:7168
  s_waitcnt lgkmcnt(0)
  s_barrier
  s_endpgm
L_V4:
  s_setprio 0
  s_waitcnt lgkmcnt(0)
  s_lshl_b32 s6, s76, 12
  s_add_u32 s6, s6, 37632
  s_add_u32 s7, s88, s76
  s_lshl_b32 s7, s7, 12
  s_add_u32 s7, s7, 6291456
  v_bfe_u32 v22, v1, 3, 1
  v_xor_b32 v22, v22, v1
  v_lshl_add_u32 v21, v22, 4, s6
  v_lshlrev_b32_e64 v22, 4, v1
  ds_read_b128 v[24:27], v21 offset:0
  ds_read_b128 v[28:31], v21 offset:1024
  ds_read_b128 v[32:35], v21 offset:2048
  ds_read_b128 v[36:39], v21 offset:3072
  s_waitcnt lgkmcnt(3)
  buffer_store_dwordx4 v[24:27], v22, s[60:63], s7 offen offset:0 sc1
  s_waitcnt lgkmcnt(2)
  buffer_store_dwordx4 v[28:31], v22, s[60:63], s7 offen offset:1024 sc1
  s_waitcnt lgkmcnt(1)
  buffer_store_dwordx4 v[32:35], v22, s[60:63], s7 offen offset:2048 sc1
  s_waitcnt lgkmcnt(0)
  buffer_store_dwordx4 v[36:39], v22, s[60:63], s7 offen offset:3072 sc1
  s_branch L_A2
L_CK:
  s_add_u32 s90, s88, s76
  s_add_u32 s91, s88, s78
  s_add_u32 s91, s91, 4
  s_min_u32 s91, s91, 575
  v_lshlrev_b32_e64 v198, 4, v1
  s_mul_i32 s92, s5, 5
  s_add_u32 s92, s92, s76
  v_mul_u32_u24 v221, 2304, v1
  v_xor_b32 v220, 3, v1
  v_lshlrev_b32_e64 v220, 2, v220
  s_sub_u32 s93, s5, 18
  s_lshl_b32 s93, s93, 2
  s_add_u32 s93, s93, s76
  s_mov_b32 s64, 0x05040100
  s_mov_b32 s65, 0x07060302
  s_waitcnt lgkmcnt(0)
  s_mov_b64 s[56:57], s[16:17]
  s_cmp_lt_u32 s5, 24
  s_cbranch_scc1 L_K4
  s_lshl_b32 s7, s91, 8
  s_lshl_b32 s8, s77, 7
  s_add_u32 s7, s7, s8
  v_lshl_add_u32 v238, v1, 1, s7
  global_load_ushort v232, v238, s[18:19] offset:0
  global_load_ushort v233, v238, s[20:21] offset:0
  global_load_ushort v234, v238, s[22:23] offset:0
  global_load_ushort v235, v238, s[24:25] offset:0
  s_lshl_b32 s7, s91, 1
  v_mov_b32_e64 v238, s7
  global_load_ushort v236, v238, s[26:27] offset:0
  s_lshl_b32 s7, s91, 1
  v_mov_b32 v238, s7
  global_load_ushort v197, v238, s[28:29] offset:0
  s_add_u32 s6, s92, 0
  s_and_b32 s6, s6, 15
  s_mul_i32 s7, s6, 73728
  s_add_u32 s7, s7, s88
  s_lshl_b32 s7, s7, 1
  buffer_load_dwordx3 v[204:206], v221, s[56:59], s7 offen offset:0
  s_add_u32 s6, s92, 0
  s_and_b32 s6, s6, 15
  s_mul_i32 s7, s6, 73728
  s_add_u32 s7, s7, s88
  s_lshl_b32 s7, s7, 1
  buffer_load_dwordx3 v[208:210], v221, s[56:59], s7 offen offset:1152
  s_waitcnt lgkmcnt(0)
  v_lshlrev_b32 v3, 2, v1
  s_mul_i32 s8, s5, 43
  s_lshr_b32 s8, s8, 8
  s_mul_i32 s9, s8, 6
  s_sub_u32 s12, s5, s9
  s_lshl_b32 s11, s4, 2
  s_add_u32 s11, s11, s8
  s_and_b32 s13, s12, 1
  s_mul_i32 s13, s13, 0
  s_mul_i32 s8, s8, 0
  s_add_u32 s13, s13, s8
  s_add_u32 s13, s13, s4
  s_mul_i32 s8, s13, 57
  s_lshr_b32 s8, s8, 9
  s_mul_i32 s8, s8, 9
  s_sub_u32 s13, s13, s8
  s_mov_b64 s[60:61], s[54:55]
  s_mov_b32 s62, 16777216
  s_mov_b32 s63, 0x20000
  s_cmp_eq_u32 s78, 0
  s_cselect_b32 s72, s40, s42
  s_cselect_b32 s73, s41, s43
  s_mov_b32 s74, 663552
  s_mov_b32 s75, 0x20000
  s_mov_b32 s80, s50
  s_and_b32 s81, s51, 0xffff
  s_mov_b32 s82, 4718592
  s_mov_b32 s83, 0x20000
  s_setprio 2
  v_lshl_add_u32 v246, v1, 6, s89
  v_bfe_u32 v247, v1, 1, 2
  v_lshlrev_b32 v247, 4, v247
  v_add_u32 v240, v246, v247
  v_xor_b32 v248, 16, v247
  v_add_u32 v241, v246, v248
  v_xor_b32 v248, 32, v247
  v_add_u32 v242, v246, v248
  v_xor_b32 v248, 48, v247
  v_add_u32 v243, v246, v248
  v_lshrrev_b32 v246, 5, v1
  v_lshl_add_u32 v246, v246, 12, s89
  v_bfe_u32 v247, v1, 2, 2
  v_lshl_add_u32 v246, v247, 6, v246
  v_and_b32_e64 v247, 1, v1
  v_lshl_add_u32 v246, v247, 3, v246
  v_bfe_u32 v247, v1, 3, 2
  v_bfe_u32 v248, v1, 1, 1
  v_xor_b32_e64 v247, v247, v248
  v_lshl_add_u32 v244, v247, 4, v246
  v_xor_b32_e64 v247, 2, v247
  v_lshl_add_u32 v245, v247, 4, v246
  v_add_u32 v245, 256, v245
  s_mul_i32 s9, s78, 4800
  s_add_u32 s9, s9, 63232
  s_add_u32 s6, s9, 32
  v_and_b32 v251, 31, v1
  v_lshrrev_b32_e64 v250, 5, v1
  v_lshl_add_u32 v249, v251, 4, s6
  v_lshl_add_u32 v246, v250, 3, v249
  v_lshl_add_u32 v247, v250, 9, v249
  s_add_u32 s6, s9, 4544
  v_lshrrev_b32_e64 v251, 1, v251
  v_lshl_add_u32 v249, v251, 2, s6
  v_lshl_add_u32 v248, v250, 7, v249
  v_mov_b32 v20, 0
  v_mov_b32 v21, 0
  v_mov_b32 v22, 0
  v_mov_b32 v23, 0
  s_mul_i32 s6, s76, 4608
  s_mul_i32 s7, s78, 4608
  s_add_u32 s7, s7, 53504
  v_mov_b32 v24, s6
  v_mov_b32 v25, s7
  v_cmp_gt_u32 vcc, 32, v1
  s_nop 1
  v_cndmask_b32 v24, v25, v24, vcc
  v_add_u32 v24, v24, v198
  ds_write_b128 v24, v[20:23]
  s_cmp_lg_u32 s77, 0
  s_cselect_b64 s[84:85], s[42:43], s[40:41]
  s_mov_b32 s86, 663552
  s_mov_b32 s87, 0x20000
  s_sub_u32 s9, s93, 24
  s_lshr_b32 s9, s9, 1
  s_add_u32 s8, s9, 0
  s_mul_i32 s6, s8, 57
  s_lshr_b32 s6, s6, 9
  s_mul_i32 s7, s6, 9
  s_sub_u32 s7, s8, s7
  s_lshl_b32 s7, s7, 6
  s_cmp_ge_u32 s6, 5
  s_cselect_b32 s7, 1024, s7
  s_add_u32 s6, s6, s4
  s_add_u32 s6, s6, 4
  v_add_u32 v20, s7, v1
  v_mul_u32_u24 v21, 683, v20
  v_lshrrev_b32_e64 v21, 16, v21
  v_mul_u32_u24 v20, 1152, v20
  v_and_b32_e64 v22, 1, v21
  v_mad_u32_u24 v21, v22, 0, s6
  v_mul_u32_u24 v22, 57, v21
  v_lshrrev_b32 v22, 9, v22
  v_mul_u32_u24 v22, 9, v22
  v_sub_u32 v22, v21, v22
  v_lshl_add_u32 v200, v22, 7, v20
  s_add_u32 s8, s9, 16
  s_mul_i32 s6, s8, 57
  s_lshr_b32 s6, s6, 9
  s_mul_i32 s7, s6, 9
  s_sub_u32 s7, s8, s7
  s_lshl_b32 s7, s7, 6
  s_cmp_ge_u32 s6, 5
  s_cselect_b32 s7, 1024, s7
  s_add_u32 s6, s6, s4
  s_add_u32 s6, s6, 4
  v_add_u32 v20, s7, v1
  v_mul_u32_u24 v21, 683, v20
  v_lshrrev_b32_e64 v21, 16, v21
  v_mul_u32_u24 v20, 1152, v20
  v_and_b32_e64 v22, 1, v21
  v_mad_u32_u24 v21, v22, 0, s6
  v_mul_u32_u24 v22, 57, v21
  v_lshrrev_b32 v22, 9, v22
  v_mul_u32_u24 v22, 9, v22
  v_sub_u32 v22, v21, v22
  v_lshl_add_u32 v201, v22, 7, v20
  s_add_u32 s8, s9, 32
  s_mul_i32 s6, s8, 57
  s_lshr_b32 s6, s6, 9
  s_mul_i32 s7, s6, 9
  s_sub_u32 s7, s8, s7
  s_lshl_b32 s7, s7, 6
  s_cmp_ge_u32 s6, 5
  s_cselect_b32 s7, 1024, s7
  s_add_u32 s6, s6, s4
  s_add_u32 s6, s6, 4
  v_add_u32 v20, s7, v1
  v_mul_u32_u24 v21, 683, v20
  v_lshrrev_b32_e64 v21, 16, v21
  v_mul_u32_u24 v20, 1152, v20
  v_and_b32_e64 v22, 1, v21
  v_mad_u32_u24 v21, v22, 0, s6
  v_mul_u32_u24 v22, 57, v21
  v_lshrrev_b32 v22, 9, v22
  v_mul_u32_u24 v22, 9, v22
  v_sub_u32 v22, v21, v22
  v_lshl_add_u32 v202, v22, 7, v20
  s_waitcnt vmcnt(3)
  v_lshlrev_b32 v237, 16, v236
  v_mul_f32 v237, 0x3fb8aa3b, v237
  v_exp_f32 v237, v237
  s_nop 0
  v_cvt_pk_bf16_f32 v237, 0, v237
  s_waitcnt vmcnt(2)
  v_lshlrev_b32 v197, 16, v197
  v_lshlrev_b32 v232, 16, v232
  v_lshlrev_b32 v233, 16, v233
  v_lshlrev_b32 v234, 16, v234
  v_lshlrev_b32 v235, 16, v235
  v_mul_f32 v20, 0x3fb8aa3b, v232
  v_exp_f32 v20, v20
  v_mul_f32 v21, v237, v233
  v_cvt_pk_bf16_f32 v20, 0, v20
  v_mul_f32 v21, 0.15915494, v21
  v_mul_f32 v20, v237, v20
  v_add_f32_e64 v22, v237, v237
  v_mul_f32 v20, 0xbfb8aa3b, v20
  v_mul_f32 v30, v22, v234
  v_mul_f32 v31, v22, v235
  v_exp_f32 v22, v20
  v_fract_f32 v23, v21
  v_cos_f32 v24, v23
  v_sin_f32 v25, v23
  v_mul_f32 v24, v24, v22
  v_mul_f32 v25, v25, v22
  v_mul_f32 v22, 0x43800000, v20
  v_mul_f32 v23, 0x43800000, v21
  v_exp_f32 v22, v22
  v_fract_f32 v23, v23
  v_cos_f32 v28, v23
  v_sin_f32 v29, v23
  v_mul_f32 v28, v28, v22
  v_mul_f32 v29, v29, v22
  v_mul_f32 v22, 0x41000000, v20
  v_mul_f32 v23, 0x41000000, v21
  v_exp_f32 v22, v22
  v_fract_f32 v23, v23
  v_cos_f32 v26, v23
  v_sin_f32 v27, v23
  v_mul_f32 v26, v26, v22
  v_mul_f32 v27, v27, v22
  v_pk_mul_f32 v[32:33], v[30:31], v[24:25] op_sel_hi:[1,0]
  v_pk_fma_f32 v[32:33], v[30:31], v[24:25], v[32:33] op_sel:[1,1,0] op_sel_hi:[0,1,1] neg_lo:[1,0,0]
  v_pk_mul_f32 v[34:35], v[32:33], v[24:25] op_sel_hi:[1,0]
  v_pk_fma_f32 v[34:35], v[32:33], v[24:25], v[34:35] op_sel:[1,1,0] op_sel_hi:[0,1,1] neg_lo:[1,0,0]
  v_pk_mul_f32 v[36:37], v[34:35], v[24:25] op_sel_hi:[1,0]
  s_waitcnt vmcnt(1)
  s_add_u32 s6, s92, 4
  s_and_b32 s6, s6, 15
  s_mul_i32 s7, s6, 73728
  s_add_u32 s7, s7, s88
  s_lshl_b32 s7, s7, 1
  buffer_load_dwordx3 v[212:214], v221, s[56:59], s7 offen offset:0
  s_nop 0
  v_pk_fma_f32 v[36:37], v[34:35], v[24:25], v[36:37] op_sel:[1,1,0] op_sel_hi:[0,1,1] neg_lo:[1,0,0]
  v_pk_mul_f32 v[38:39], v[36:37], v[24:25] op_sel_hi:[1,0]
  v_pk_fma_f32 v[38:39], v[36:37], v[24:25], v[38:39] op_sel:[1,1,0] op_sel_hi:[0,1,1] neg_lo:[1,0,0]
  v_pk_mul_f32 v[40:41], v[38:39], v[24:25] op_sel_hi:[1,0]
  v_pk_fma_f32 v[40:41], v[38:39], v[24:25], v[40:41] op_sel:[1,1,0] op_sel_hi:[0,1,1] neg_lo:[1,0,0]
  v_pk_mul_f32 v[42:43], v[40:41], v[24:25] op_sel_hi:[1,0]
  v_pk_fma_f32 v[42:43], v[40:41], v[24:25], v[42:43] op_sel:[1,1,0] op_sel_hi:[0,1,1] neg_lo:[1,0,0]
  v_pk_mul_f32 v[44:45], v[42:43], v[24:25] op_sel_hi:[1,0]
  v_pk_fma_f32 v[44:45], v[42:43], v[24:25], v[44:45] op_sel:[1,1,0] op_sel_hi:[0,1,1] neg_lo:[1,0,0]
  v_cvt_pk_bf16_f32 v88, v30, v32
  v_cvt_pk_bf16_f32 v89, v34, v36
  v_cvt_pk_bf16_f32 v90, v38, v40
  v_cvt_pk_bf16_f32 v91, v42, v44
  v_cvt_pk_bf16_f32 v92, -v31, -v33
  v_cvt_pk_bf16_f32 v93, -v35, -v37
  v_cvt_pk_bf16_f32 v94, -v39, -v41
  v_cvt_pk_bf16_f32 v95, -v43, -v45
  ds_write_b128 v240, v[88:91]
  v_pk_mul_f32 v[46:47], v[44:45], v[24:25] op_sel_hi:[1,0]
  v_pk_fma_f32 v[46:47], v[44:45], v[24:25], v[46:47] op_sel:[1,1,0] op_sel_hi:[0,1,1] neg_lo:[1,0,0]
  v_pk_mul_f32 v[48:49], v[30:31], v[28:29] op_sel_hi:[1,0]
  v_pk_fma_f32 v[48:49], v[30:31], v[28:29], v[48:49] op_sel:[1,1,0] op_sel_hi:[0,1,1] neg_lo:[1,0,0]
  v_pk_mul_f32 v[50:51], v[34:35], v[28:29] op_sel_hi:[1,0]
  v_pk_fma_f32 v[50:51], v[34:35], v[28:29], v[50:51] op_sel:[1,1,0] op_sel_hi:[0,1,1] neg_lo:[1,0,0]
  v_pk_mul_f32 v[52:53], v[38:39], v[28:29] op_sel_hi:[1,0]
  v_pk_fma_f32 v[52:53], v[38:39], v[28:29], v[52:53] op_sel:[1,1,0] op_sel_hi:[0,1,1] neg_lo:[1,0,0]
  v_pk_mul_f32 v[54:55], v[42:43], v[28:29] op_sel_hi:[1,0]
  v_pk_fma_f32 v[54:55], v[42:43], v[28:29], v[54:55] op_sel:[1,1,0] op_sel_hi:[0,1,1] neg_lo:[1,0,0]
  ds_write_b128 v240, v[92:95] offset:4096
  v_pk_mul_f32 v[56:57], v[46:47], v[28:29] op_sel_hi:[1,0]
  v_pk_fma_f32 v[56:57], v[46:47], v[28:29], v[56:57] op_sel:[1,1,0] op_sel_hi:[0,1,1] neg_lo:[1,0,0]
  v_cvt_pk_bf16_f32 v96, v38, v48
  v_cvt_pk_bf16_f32 v97, v50, v52
  v_cvt_pk_bf16_f32 v98, v46, v52
  v_cvt_pk_bf16_f32 v99, v54, v56
  v_cvt_pk_bf16_f32 v100, -v39, -v49
  v_cvt_pk_bf16_f32 v101, -v51, -v53
  v_cvt_pk_bf16_f32 v102, -v47, -v53
  v_cvt_pk_bf16_f32 v103, -v55, -v57
  ds_write_b128 v241, v[96:99]
  v_pk_mul_f32 v[58:59], v[48:49], v[28:29] op_sel_hi:[1,0]
  v_pk_fma_f32 v[58:59], v[48:49], v[28:29], v[58:59] op_sel:[1,1,0] op_sel_hi:[0,1,1] neg_lo:[1,0,0]
  v_pk_mul_f32 v[60:61], v[52:53], v[28:29] op_sel_hi:[1,0]
  v_pk_fma_f32 v[60:61], v[52:53], v[28:29], v[60:61] op_sel:[1,1,0] op_sel_hi:[0,1,1] neg_lo:[1,0,0]
  v_pk_mul_f32 v[62:63], v[56:57], v[28:29] op_sel_hi:[1,0]
  v_pk_fma_f32 v[62:63], v[56:57], v[28:29], v[62:63] op_sel:[1,1,0] op_sel_hi:[0,1,1] neg_lo:[1,0,0]
  s_waitcnt vmcnt(1)
  s_add_u32 s6, s92, 4
  s_and_b32 s6, s6, 15
  s_mul_i32 s7, s6, 73728
  s_add_u32 s7, s7, s88
  s_lshl_b32 s7, s7, 1
  buffer_load_dwordx3 v[216:218], v221, s[56:59], s7 offen offset:1152
  s_add_u32 s6, s92, 0
  s_and_b32 s6, s6, 15
  s_lshl_b32 s6, s6, 8
  v_add_u32_e64 v249, s6, v220
  v_perm_b32 v224, v204, v208, s64
  v_perm_b32 v225, v204, v208, s65
  v_perm_b32 v226, v205, v209, s64
  v_perm_b32 v227, v205, v209, s65
  v_perm_b32 v228, v206, v210, s64
  v_perm_b32 v229, v206, v210, s65
  ds_write_b32 v249, v224 offset:512
  ds_write_b32 v249, v225 offset:5120
  ds_write_b32 v249, v226 offset:9728
  ds_write_b32 v249, v227 offset:14336
  ds_write_b32 v249, v228 offset:54528
  ds_write_b32 v249, v229 offset:59136
  v_pk_mul_f32 v[64:65], v[58:59], v[28:29] op_sel_hi:[1,0]
  v_pk_fma_f32 v[64:65], v[58:59], v[28:29], v[64:65] op_sel:[1,1,0] op_sel_hi:[0,1,1] neg_lo:[1,0,0]
  v_pk_mul_f32 v[66:67], v[60:61], v[28:29] op_sel_hi:[1,0]
  v_pk_fma_f32 v[66:67], v[60:61], v[28:29], v[66:67] op_sel:[1,1,0] op_sel_hi:[0,1,1] neg_lo:[1,0,0]
  ds_write_b128 v241, v[100:103] offset:4096
  v_pk_mul_f32 v[68:69], v[62:63], v[28:29] op_sel_hi:[1,0]
  v_pk_fma_f32 v[68:69], v[62:63], v[28:29], v[68:69] op_sel:[1,1,0] op_sel_hi:[0,1,1] neg_lo:[1,0,0]
  v_pk_mul_f32 v[70:71], v[64:65], v[28:29] op_sel_hi:[1,0]
  v_pk_fma_f32 v[70:71], v[64:65], v[28:29], v[70:71] op_sel:[1,1,0] op_sel_hi:[0,1,1] neg_lo:[1,0,0]
  v_pk_mul_f32 v[72:73], v[68:69], v[28:29] op_sel_hi:[1,0]
  v_pk_fma_f32 v[72:73], v[68:69], v[28:29], v[72:73] op_sel:[1,1,0] op_sel_hi:[0,1,1] neg_lo:[1,0,0]
  v_pk_mul_f32 v[74:75], v[70:71], v[28:29] op_sel_hi:[1,0]
  v_pk_fma_f32 v[74:75], v[70:71], v[28:29], v[74:75] op_sel:[1,1,0] op_sel_hi:[0,1,1] neg_lo:[1,0,0]
  v_pk_mul_f32 v[76:77], v[72:73], v[28:29] op_sel_hi:[1,0]
  v_pk_fma_f32 v[76:77], v[72:73], v[28:29], v[76:77] op_sel:[1,1,0] op_sel_hi:[0,1,1] neg_lo:[1,0,0]
  v_pk_mul_f32 v[78:79], v[74:75], v[28:29] op_sel_hi:[1,0]
  v_pk_fma_f32 v[78:79], v[74:75], v[28:29], v[78:79] op_sel:[1,1,0] op_sel_hi:[0,1,1] neg_lo:[1,0,0]
  v_pk_mul_f32 v[80:81], v[76:77], v[28:29] op_sel_hi:[1,0]
  v_pk_fma_f32 v[80:81], v[76:77], v[28:29], v[80:81] op_sel:[1,1,0] op_sel_hi:[0,1,1] neg_lo:[1,0,0]
  v_pk_mul_f32 v[82:83], v[78:79], v[28:29] op_sel_hi:[1,0]
  v_pk_fma_f32 v[82:83], v[78:79], v[28:29], v[82:83] op_sel:[1,1,0] op_sel_hi:[0,1,1] neg_lo:[1,0,0]
  v_pk_mul_f32 v[84:85], v[80:81], v[28:29] op_sel_hi:[1,0]
  v_pk_fma_f32 v[84:85], v[80:81], v[28:29], v[84:85] op_sel:[1,1,0] op_sel_hi:[0,1,1] neg_lo:[1,0,0]
  v_cvt_pk_bf16_f32 v88, v58, v60
  v_cvt_pk_bf16_f32 v89, v62, v70
  v_cvt_pk_bf16_f32 v90, v64, v66
  v_cvt_pk_bf16_f32 v91, v68, v78
  v_cvt_pk_bf16_f32 v92, -v59, -v61
  v_cvt_pk_bf16_f32 v93, -v63, -v71
  v_cvt_pk_bf16_f32 v94, -v65, -v67
  v_cvt_pk_bf16_f32 v95, -v69, -v79
  ds_write_b128 v242, v[88:91]
  v_cvt_pk_bf16_f32 v96, v72, v74
  v_cvt_pk_bf16_f32 v97, v76, v76
  v_cvt_pk_bf16_f32 v98, v80, v82
  v_cvt_pk_bf16_f32 v99, v84, v84
  v_cvt_pk_bf16_f32 v100, -v73, -v75
  v_cvt_pk_bf16_f32 v101, -v77, -v77
  v_cvt_pk_bf16_f32 v102, -v81, -v83
  v_cvt_pk_bf16_f32 v103, -v85, -v85
  v_pk_mul_f32 v[34:35], v[26:27], v[26:27] op_sel_hi:[1,0]
  v_pk_fma_f32 v[34:35], v[26:27], v[26:27], v[34:35] op_sel:[1,1,0] op_sel_hi:[0,1,1] neg_lo:[1,0,0]
  ds_write_b128 v242, v[92:95] offset:4096
  v_pk_mul_f32 v[36:37], v[34:35], v[26:27] op_sel_hi:[1,0]
  v_pk_fma_f32 v[36:37], v[34:35], v[26:27], v[36:37] op_sel:[1,1,0] op_sel_hi:[0,1,1] neg_lo:[1,0,0]
  v_pk_mul_f32 v[38:39], v[36:37], v[26:27] op_sel_hi:[1,0]
  s_waitcnt vmcnt(1)
  s_add_u32 s6, s92, 8
  s_and_b32 s6, s6, 15
  s_mul_i32 s7, s6, 73728
  s_add_u32 s7, s7, s88
  s_lshl_b32 s7, s7, 1
  buffer_load_dwordx3 v[204:206], v221, s[56:59], s7 offen offset:0
  s_nop 0
  v_pk_fma_f32 v[38:39], v[36:37], v[26:27], v[38:39] op_sel:[1,1,0] op_sel_hi:[0,1,1] neg_lo:[1,0,0]
  v_pk_mul_f32 v[40:41], v[38:39], v[26:27] op_sel_hi:[1,0]
  v_pk_fma_f32 v[40:41], v[38:39], v[26:27], v[40:41] op_sel:[1,1,0] op_sel_hi:[0,1,1] neg_lo:[1,0,0]
  v_pk_mul_f32 v[42:43], v[40:41], v[26:27] op_sel_hi:[1,0]
  v_pk_fma_f32 v[42:43], v[40:41], v[26:27], v[42:43] op_sel:[1,1,0] op_sel_hi:[0,1,1] neg_lo:[1,0,0]
  v_pk_mul_f32 v[44:45], v[42:43], v[26:27] op_sel_hi:[1,0]
  v_pk_fma_f32 v[44:45], v[42:43], v[26:27], v[44:45] op_sel:[1,1,0] op_sel_hi:[0,1,1] neg_lo:[1,0,0]
  ds_write_b128 v243, v[96:99]
  v_cvt_pk_bf16_f32 v88, 1.0, v26
  v_cvt_pk_bf16_f32 v89, v34, v36
  v_cvt_pk_bf16_f32 v90, v38, v40
  v_cvt_pk_bf16_f32 v91, v42, v44
  v_cvt_pk_bf16_f32 v92, 0, v27
  v_cvt_pk_bf16_f32 v93, v35, v37
  v_cvt_pk_bf16_f32 v94, v39, v41
  v_cvt_pk_bf16_f32 v95, v43, v45
  v_pk_mul_f32 v[46:47], v[44:45], v[26:27] op_sel_hi:[1,0]
  v_pk_fma_f32 v[46:47], v[44:45], v[26:27], v[46:47] op_sel:[1,1,0] op_sel_hi:[0,1,1] neg_lo:[1,0,0]
  ds_write_b128 v243, v[100:103] offset:4096
  ds_read_b64_tr_b16 v[104:105], v244 offset:0
  ds_read_b64_tr_b16 v[106:107], v245 offset:0
  ds_read_b64_tr_b16 v[108:109], v244 offset:512
  ds_read_b64_tr_b16 v[110:111], v245 offset:512
  ds_read_b64_tr_b16 v[112:113], v244 offset:1024
  ds_read_b64_tr_b16 v[114:115], v245 offset:1024
  ds_read_b64_tr_b16 v[116:117], v244 offset:1536
  ds_read_b64_tr_b16 v[118:119], v245 offset:1536
  v_pk_mul_f32 v[30:31], v[46:47], v[26:27] op_sel_hi:[1,0]
  v_pk_fma_f32 v[30:31], v[46:47], v[26:27], v[30:31] op_sel:[1,1,0] op_sel_hi:[0,1,1] neg_lo:[1,0,0]
  v_pk_mul_f32 v[32:33], v[30:31], v[26:27] op_sel_hi:[1,0]
  v_pk_fma_f32 v[32:33], v[30:31], v[26:27], v[32:33] op_sel:[1,1,0] op_sel_hi:[0,1,1] neg_lo:[1,0,0]
  v_pk_mul_f32 v[34:35], v[32:33], v[26:27] op_sel_hi:[1,0]
  v_pk_fma_f32 v[34:35], v[32:33], v[26:27], v[34:35] op_sel:[1,1,0] op_sel_hi:[0,1,1] neg_lo:[1,0,0]
  v_pk_mul_f32 v[36:37], v[34:35], v[26:27] op_sel_hi:[1,0]
  v_pk_fma_f32 v[36:37], v[34:35], v[26:27], v[36:37] op_sel:[1,1,0] op_sel_hi:[0,1,1] neg_lo:[1,0,0]
  v_pk_mul_f32 v[38:39], v[36:37], v[26:27] op_sel_hi:[1,0]
  v_pk_fma_f32 v[38:39], v[36:37], v[26:27], v[38:39] op_sel:[1,1,0] op_sel_hi:[0,1,1] neg_lo:[1,0,0]
  ds_read_b64_tr_b16 v[120:121], v244 offset:2048
  ds_read_b64_tr_b16 v[122:123], v245 offset:2048
  ds_read_b64_tr_b16 v[124:125], v244 offset:2560
  ds_read_b64_tr_b16 v[126:127], v245 offset:2560
  ds_read_b64_tr_b16 v[128:129], v244 offset:3072
  ds_read_b64_tr_b16 v[130:131], v245 offset:3072
  ds_read_b64_tr_b16 v[132:133], v244 offset:3584
  ds_read_b64_tr_b16 v[134:135], v245 offset:3584
  v_pk_mul_f32 v[40:41], v[38:39], v[26:27] op_sel_hi:[1,0]
  v_pk_fma_f32 v[40:41], v[38:39], v[26:27], v[40:41] op_sel:[1,1,0] op_sel_hi:[0,1,1] neg_lo:[1,0,0]
  v_pk_mul_f32 v[42:43], v[40:41], v[26:27] op_sel_hi:[1,0]
  v_pk_fma_f32 v[42:43], v[40:41], v[26:27], v[42:43] op_sel:[1,1,0] op_sel_hi:[0,1,1] neg_lo:[1,0,0]
  v_cvt_pk_bf16_f32 v96, v46, v30
  v_cvt_pk_bf16_f32 v97, v32, v34
  v_cvt_pk_bf16_f32 v98, v36, v38
  v_cvt_pk_bf16_f32 v99, v40, v42
  v_cvt_pk_bf16_f32 v100, v47, v31
  v_cvt_pk_bf16_f32 v101, v33, v35
  ds_write_b128 v240, v[88:91]
  v_cvt_pk_bf16_f32 v102, v37, v39
  v_cvt_pk_bf16_f32 v103, v41, v43
  v_pk_mul_f32 v[44:45], v[42:43], v[26:27] op_sel_hi:[1,0]
  v_pk_fma_f32 v[44:45], v[42:43], v[26:27], v[44:45] op_sel:[1,1,0] op_sel_hi:[0,1,1] neg_lo:[1,0,0]
  v_pk_mul_f32 v[46:47], v[44:45], v[26:27] op_sel_hi:[1,0]
  v_pk_fma_f32 v[46:47], v[44:45], v[26:27], v[46:47] op_sel:[1,1,0] op_sel_hi:[0,1,1] neg_lo:[1,0,0]
  s_waitcnt vmcnt(1)
  s_add_u32 s6, s92, 8
  s_and_b32 s6, s6, 15
  s_mul_i32 s7, s6, 73728
  s_add_u32 s7, s7, s88
  s_lshl_b32 s7, s7, 1
  buffer_load_dwordx3 v[208:210], v221, s[56:59], s7 offen offset:1152
  s_add_u32 s6, s92, 4
  s_and_b32 s6, s6, 15
  s_lshl_b32 s6, s6, 8
  v_add_u32_e64 v249, s6, v220
  v_perm_b32 v224, v212, v216, s64
  v_perm_b32 v225, v212, v216, s65
  v_perm_b32 v226, v213, v217, s64
  v_perm_b32 v227, v213, v217, s65
  v_perm_b32 v228, v214, v218, s64
  v_perm_b32 v229, v214, v218, s65
  ds_write_b32 v249, v224 offset:512
  ds_write_b32 v249, v225 offset:5120
  ds_write_b32 v249, v226 offset:9728
  ds_write_b32 v249, v227 offset:14336
  ds_write_b32 v249, v228 offset:54528
  ds_write_b32 v249, v229 offset:59136
  v_pk_mul_f32 v[30:31], v[46:47], v[26:27] op_sel_hi:[1,0]
  v_pk_fma_f32 v[30:31], v[46:47], v[26:27], v[30:31] op_sel:[1,1,0] op_sel_hi:[0,1,1] neg_lo:[1,0,0]
  v_pk_mul_f32 v[32:33], v[30:31], v[26:27] op_sel_hi:[1,0]
  v_pk_fma_f32 v[32:33], v[30:31], v[26:27], v[32:33] op_sel:[1,1,0] op_sel_hi:[0,1,1] neg_lo:[1,0,0]
  ds_write_b128 v240, v[92:95] offset:4096
  v_pk_mul_f32 v[34:35], v[32:33], v[26:27] op_sel_hi:[1,0]
  v_pk_fma_f32 v[34:35], v[32:33], v[26:27], v[34:35] op_sel:[1,1,0] op_sel_hi:[0,1,1] neg_lo:[1,0,0]
  v_pk_mul_f32 v[36:37], v[34:35], v[26:27] op_sel_hi:[1,0]
  v_pk_fma_f32 v[36:37], v[34:35], v[26:27], v[36:37] op_sel:[1,1,0] op_sel_hi:[0,1,1] neg_lo:[1,0,0]
  v_pk_mul_f32 v[38:39], v[36:37], v[26:27] op_sel_hi:[1,0]
  v_pk_fma_f32 v[38:39], v[36:37], v[26:27], v[38:39] op_sel:[1,1,0] op_sel_hi:[0,1,1] neg_lo:[1,0,0]
  v_pk_mul_f32 v[40:41], v[38:39], v[26:27] op_sel_hi:[1,0]
  v_pk_fma_f32 v[40:41], v[38:39], v[26:27], v[40:41] op_sel:[1,1,0] op_sel_hi:[0,1,1] neg_lo:[1,0,0]
  v_cvt_pk_bf16_f32 v88, v44, v46
  v_cvt_pk_bf16_f32 v89, v30, v32
  ds_write_b128 v241, v[96:99]
  v_cvt_pk_bf16_f32 v90, v34, v36
  v_cvt_pk_bf16_f32 v91, v38, v40
  v_cvt_pk_bf16_f32 v92, v45, v47
  v_cvt_pk_bf16_f32 v93, v31, v33
  v_cvt_pk_bf16_f32 v94, v35, v37
  v_cvt_pk_bf16_f32 v95, v39, v41
  v_pk_mul_f32 v[42:43], v[40:41], v[26:27] op_sel_hi:[1,0]
  v_pk_fma_f32 v[42:43], v[40:41], v[26:27], v[42:43] op_sel:[1,1,0] op_sel_hi:[0,1,1] neg_lo:[1,0,0]
  v_pk_mul_f32 v[44:45], v[42:43], v[26:27] op_sel_hi:[1,0]
  v_pk_fma_f32 v[44:45], v[42:43], v[26:27], v[44:45] op_sel:[1,1,0] op_sel_hi:[0,1,1] neg_lo:[1,0,0]
  ds_write_b128 v241, v[100:103] offset:4096
  v_pk_mul_f32 v[46:47], v[44:45], v[26:27] op_sel_hi:[1,0]
  v_pk_fma_f32 v[46:47], v[44:45], v[26:27], v[46:47] op_sel:[1,1,0] op_sel_hi:[0,1,1] neg_lo:[1,0,0]
  v_pk_mul_f32 v[30:31], v[46:47], v[26:27] op_sel_hi:[1,0]
  v_pk_fma_f32 v[30:31], v[46:47], v[26:27], v[30:31] op_sel:[1,1,0] op_sel_hi:[0,1,1] neg_lo:[1,0,0]
  v_pk_mul_f32 v[32:33], v[30:31], v[26:27] op_sel_hi:[1,0]
  v_pk_fma_f32 v[32:33], v[30:31], v[26:27], v[32:33] op_sel:[1,1,0] op_sel_hi:[0,1,1] neg_lo:[1,0,0]
  v_pk_mul_f32 v[34:35], v[32:33], v[26:27] op_sel_hi:[1,0]
  v_pk_fma_f32 v[34:35], v[32:33], v[26:27], v[34:35] op_sel:[1,1,0] op_sel_hi:[0,1,1] neg_lo:[1,0,0]
  v_pk_mul_f32 v[36:37], v[34:35], v[26:27] op_sel_hi:[1,0]
  v_pk_fma_f32 v[36:37], v[34:35], v[26:27], v[36:37] op_sel:[1,1,0] op_sel_hi:[0,1,1] neg_lo:[1,0,0]
  ds_write_b128 v242, v[88:91]
  v_pk_mul_f32 v[38:39], v[36:37], v[26:27] op_sel_hi:[1,0]
  v_pk_fma_f32 v[38:39], v[36:37], v[26:27], v[38:39] op_sel:[1,1,0] op_sel_hi:[0,1,1] neg_lo:[1,0,0]
  v_cvt_pk_bf16_f32 v96, v42, v44
  v_cvt_pk_bf16_f32 v97, v46, v30
  v_cvt_pk_bf16_f32 v98, v32, v34
  v_cvt_pk_bf16_f32 v99, v36, v38
  v_cvt_pk_bf16_f32 v100, v43, v45
  v_cvt_pk_bf16_f32 v101, v47, v31
  v_cvt_pk_bf16_f32 v102, v33, v35
  s_waitcnt vmcnt(1)
  s_add_u32 s6, s92, 12
  s_and_b32 s6, s6, 15
  s_mul_i32 s7, s6, 73728
  s_add_u32 s7, s7, s88
  s_lshl_b32 s7, s7, 1
  buffer_load_dwordx3 v[212:214], v221, s[56:59], s7 offen offset:0
  v_cvt_pk_bf16_f32 v103, v37, v39
  ds_write_b128 v242, v[92:95] offset:4096
  ds_write_b128 v243, v[96:99]
  ds_write_b128 v243, v[100:103] offset:4096
  ds_read_b64_tr_b16 v[136:137], v244 offset:0
  ds_read_b64_tr_b16 v[138:139], v245 offset:0
  ds_read_b64_tr_b16 v[140:141], v244 offset:512
  ds_read_b64_tr_b16 v[142:143], v245 offset:512
  ds_read_b64_tr_b16 v[144:145], v244 offset:1024
  ds_read_b64_tr_b16 v[146:147], v245 offset:1024
  ds_read_b64_tr_b16 v[148:149], v244 offset:1536
  ds_read_b64_tr_b16 v[150:151], v245 offset:1536
  ds_read_b64_tr_b16 v[152:153], v244 offset:2048
  ds_read_b64_tr_b16 v[154:155], v245 offset:2048
  ds_read_b64_tr_b16 v[156:157], v244 offset:2560
  ds_read_b64_tr_b16 v[158:159], v245 offset:2560
  ds_read_b64_tr_b16 v[160:161], v244 offset:3072
  ds_read_b64_tr_b16 v[162:163], v245 offset:3072
  ds_read_b64_tr_b16 v[164:165], v244 offset:3584
  ds_read_b64_tr_b16 v[166:167], v245 offset:3584
  s_waitcnt lgkmcnt(14)
  v_mfma_f32_32x32x16_bf16 v[4:19], v[104:107], v[136:139], 0
  s_waitcnt lgkmcnt(12)
  v_mfma_f32_32x32x16_bf16 v[4:19], v[108:111], v[140:143], v[4:19]
  s_waitcnt lgkmcnt(10)
  v_mfma_f32_32x32x16_bf16 v[4:19], v[112:115], v[144:147], v[4:19]
  s_waitcnt lgkmcnt(8)
  v_mfma_f32_32x32x16_bf16 v[4:19], v[116:119], v[148:151], v[4:19]
  s_waitcnt lgkmcnt(6)
  v_mfma_f32_32x32x16_bf16 v[4:19], v[120:123], v[152:155], v[4:19]
  s_waitcnt lgkmcnt(4)
  v_mfma_f32_32x32x16_bf16 v[4:19], v[124:127], v[156:159], v[4:19]
  s_waitcnt lgkmcnt(2)
  v_mfma_f32_32x32x16_bf16 v[4:19], v[128:131], v[160:163], v[4:19]
  s_waitcnt lgkmcnt(0)
  v_mfma_f32_32x32x16_bf16 v[4:19], v[132:135], v[164:167], v[4:19]
  v_add_u32_e64 v20, s89, v198
  s_nop 10
  ds_write_b128 v20, v[4:7] offset:0
  ds_write_b128 v20, v[8:11] offset:1024
  ds_write_b128 v20, v[12:15] offset:2048
  ds_write_b128 v20, v[16:19] offset:3072
  s_waitcnt vmcnt(1)
  s_add_u32 s6, s92, 12
  s_and_b32 s6, s6, 15
  s_mul_i32 s7, s6, 73728
  s_add_u32 s7, s7, s88
  s_lshl_b32 s7, s7, 1
  buffer_load_dwordx3 v[216:218], v221, s[56:59], s7 offen offset:1152
  s_add_u32 s6, s92, 8
  s_and_b32 s6, s6, 15
  s_lshl_b32 s6, s6, 8
  v_add_u32_e64 v21, s6, v220
  v_perm_b32 v224, v204, v208, s64
  v_perm_b32 v225, v204, v208, s65
  v_perm_b32 v226, v205, v209, s64
  v_perm_b32 v227, v205, v209, s65
  v_perm_b32 v228, v206, v210, s64
  v_perm_b32 v229, v206, v210, s65
  ds_write_b32 v21, v224 offset:512
  ds_write_b32 v21, v225 offset:5120
  ds_write_b32 v21, v226 offset:9728
  ds_write_b32 v21, v227 offset:14336
  ds_write_b32 v21, v228 offset:54528
  ds_write_b32 v21, v229 offset:59136
  s_waitcnt vmcnt(1)
  buffer_load_dword v2, v200, s[84:87], 0 offen
  s_waitcnt vmcnt(1)
  buffer_load_dword v2, v201, s[84:87], 0 offen
  s_add_u32 s6, s92, 12
  s_and_b32 s6, s6, 15
  s_lshl_b32 s6, s6, 8
  v_add_u32 v21, s6, v220
  v_perm_b32 v224, v212, v216, s64
  v_perm_b32 v225, v212, v216, s65
  v_perm_b32 v226, v213, v217, s64
  v_perm_b32 v227, v213, v217, s65
  v_perm_b32 v228, v214, v218, s64
  v_perm_b32 v229, v214, v218, s65
  ds_write_b32 v21, v224 offset:512
  ds_write_b32 v21, v225 offset:5120
  ds_write_b32 v21, v226 offset:9728
  ds_write_b32 v21, v227 offset:14336
  ds_write_b32 v21, v228 offset:54528
  ds_write_b32 v21, v229 offset:59136
  s_setprio 0
  s_waitcnt lgkmcnt(0)
  s_barrier
  v_mov_b32 v24, -1
  v_mov_b32 v25, -1
  v_mov_b32 v26, -1
  v_mov_b32 v27, -1
  s_lshl_b32 s6, s90, 12
  s_add_u32 s6, s6, 6291456
  s_lshl_b32 s7, s91, 12
  s_lshl_b32 s8, s77, 11
  s_add_u32 s7, s7, s8
  s_add_u32 s7, s7, 6291456
  buffer_store_dwordx4 v[24:27], v198, s[60:63], s6 offen offset:0 sc1
  buffer_store_dwordx4 v[24:27], v198, s[60:63], s6 offen offset:1024 sc1
  buffer_store_dwordx4 v[24:27], v198, s[60:63], s6 offen offset:2048 sc1
  buffer_store_dwordx4 v[24:27], v198, s[60:63], s6 offen offset:3072 sc1
  buffer_store_dwordx4 v[24:27], v198, s[60:63], s7 offen offset:0 sc1
  buffer_store_dwordx4 v[24:27], v198, s[60:63], s7 offen offset:1024 sc1
  v_and_b32 v199, 63, v3
  global_load_dword v199, v199, s[52:53] sc1
  buffer_load_dword v2, v202, s[84:87], 0 offen
  s_xor_b32 s6, s3, 1
  s_lshl_b32 s6, s6, 13
  s_add_u32 s6, s6, 90112
  v_add_u32_e64 v20, s6, v198
  ds_read_b128 v[24:27], v20 offset:0
  ds_read_b128 v[28:31], v20 offset:1024
  ds_read_b128 v[32:35], v20 offset:2048
  ds_read_b128 v[36:39], v20 offset:3072
  s_waitcnt lgkmcnt(3)
  v_add_f32 v4, v4, v24
  v_add_f32 v5, v5, v25
  v_add_f32 v6, v6, v26
  v_add_f32 v7, v7, v27
  s_waitcnt lgkmcnt(2)
  v_add_f32 v8, v8, v28
  v_add_f32 v9, v9, v29
  v_add_f32 v10, v10, v30
  v_add_f32 v11, v11, v31
  s_waitcnt lgkmcnt(1)
  v_add_f32 v12, v12, v32
  v_add_f32 v13, v13, v33
  v_add_f32 v14, v14, v34
  v_add_f32 v15, v15, v35
  s_waitcnt lgkmcnt(0)
  v_add_f32 v16, v16, v36
  v_add_f32 v17, v17, v37
  v_add_f32 v18, v18, v38
  s_mov_b64 exec, 1
  v_add_f32 v4, v4, v197
  s_mov_b64 exec, -1
  s_cmp_lg_u32 s77, 0
  s_cbranch_scc1 L_ke1
  v_mov_b32 v40, 0
  v_mov_b32 v41, 0
  v_mov_b32 v42, 0
  v_mov_b32 v43, 0
  v_add_u32 v44, -32, v246
  s_mov_b64 exec, 15
  ds_write_b128 v44, v[40:43] offset:0
  ds_write_b128 v44, v[40:43] offset:2080
  ds_write_b128 v44, v[40:43] offset:4480
  s_mov_b64 exec, -1
  v_cvt_pk_bf16_f32 v40, v4, v5
  v_cvt_pk_bf16_f32 v41, v6, v7
  v_cvt_pk_bf16_f32 v42, v9, v9
  v_cvt_pk_bf16_f32 v43, v10, v11
  v_cvt_pk_bf16_f32 v44, v12, v12
  v_cvt_pk_bf16_f32 v45, v12, v13
  v_cvt_pk_bf16_f32 v46, v13, v13
  v_cvt_pk_bf16_f32 v47, v14, v14
  v_cvt_pk_bf16_f32 v50, v15, 0
  v_cvt_pk_bf16_f32 v48, v15, v15
  v_cvt_pk_bf16_f32 v49, v15, v15
  v_cvt_pk_bf16_f32 v52, v15, v16
  v_cvt_pk_bf16_f32 v53, v17, v18
  ds_write_b64 v246, v[40:41] offset:0
  ds_write_b64 v246, v[42:43] offset:512
  ds_write_b128 v247, v[44:47] offset:1024
  s_mov_b64 exec, 1
  ds_write_b64 v246, v[48:49] offset:2048
  ds_write_b32 v246, v50 offset:2056
  s_not_b64 exec, s[100:101]
  ds_write2_b32 v248, v52, v53 offset0:0 offset1:16
  s_mov_b64 exec, -1
  s_branch L_ke2
L_ke1:
  v_mov_b32 v40, 0
  v_mov_b32 v41, 0
  v_mov_b32 v42, 0
  v_mov_b32 v43, 0
  v_add_u32 v44, -32, v246
  s_mov_b64 exec, 15
  ds_write_b128 v44, v[40:43] offset:2240
  ds_write_b128 v44, v[40:43] offset:4320
  s_mov_b64 exec, -1
  v_cvt_pk_bf16_f32 v40, v5, v6
  v_cvt_pk_bf16_f32 v41, v7, v8
  v_cvt_pk_bf16_f32 v42, v9, v10
  v_cvt_pk_bf16_f32 v43, v11, v11
  v_cvt_pk_bf16_f32 v44, v12, v12
  v_cvt_pk_bf16_f32 v45, v13, v13
  v_cvt_pk_bf16_f32 v46, v13, v14
  v_cvt_pk_bf16_f32 v47, v14, v14
  v_cvt_pk_bf16_f32 v50, 0, v4
  v_add_u32_e64 v51, -4, v246
  v_cvt_pk_bf16_f32 v48, v15, v15
  v_cvt_pk_bf16_f32 v49, v15, v15
  ds_write_b64 v246, v[40:41] offset:2240
  ds_write_b64 v246, v[42:43] offset:2752
  ds_write_b128 v247, v[44:47] offset:3264
  s_mov_b64 exec, 1
  ds_write_b64 v246, v[48:49] offset:4288
  ds_write_b32 v51, v50 offset:2240
  s_mov_b64 exec, -1
L_ke2:
  v_mul_u32_u24 v40, 576, v1
  v_add_u32 v40, s90, v40
  v_mov_b32 v41, 1
  s_mul_i32 s6, s77, 576
  s_add_u32 s6, s6, s91
  v_writelane_b32 v40, s6, 2
  v_lshlrev_b32 v40, 2, v40
  s_waitcnt vmcnt(1)
  v_cmp_ne_u32 vcc, 1, v199
  s_nop 0
  s_cbranch_vccnz Len29
Lok27:
  s_mov_b32 s6, 147456
  s_mov_b64 exec, 7
  buffer_store_dword v41, v40, s[60:63], s6 offen sc1
  s_mov_b64 exec, -1
  s_waitcnt lgkmcnt(0)
  s_barrier
  s_lshl_b32 s7, s77, 11
  s_lshl_b32 s92, s91, 12
  s_add_u32 s92, s92, s7
  s_add_u32 s92, s92, 6291456
  v_lshrrev_b32 v7, 1, v1
  v_lshlrev_b32 v7, 6, v7
  s_lshl_b32 s6, s78, 14
  s_lshl_b32 s7, s77, 12
  s_add_u32 s6, s6, s7
  s_add_u32 s6, s6, 90112
  v_add_u32 v7, s6, v7
  v_and_b32 v8, 1, v1
  v_lshlrev_b32_e64 v8, 1, v8
  v_bfe_u32 v4, v1, 2, 2
  v_xor_b32_e64 v8, v8, v4
  v_lshl_add_u32 v4, v8, 4, v7
  v_xor_b32_e64 v8, 1, v8
  v_lshl_add_u32 v5, v8, 4, v7
  s_barrier
  s_lshl_b32 s6, s76, 12
  s_add_u32 s6, s6, 37632
  s_add_u32 s7, s88, s76
  s_lshl_b32 s7, s7, 12
  s_add_u32 s7, s7, 6291456
  v_bfe_u32 v8, v1, 3, 1
  v_xor_b32_e64 v8, v8, v1
  v_lshl_add_u32 v7, v8, 4, s6
  v_lshlrev_b32_e64 v8, 4, v1
  ds_read_b128 v[12:15], v7 offset:0
  ds_read_b128 v[16:19], v7 offset:1024
  ds_read_b128 v[20:23], v7 offset:2048
  ds_read_b128 v[24:27], v7 offset:3072
  s_waitcnt lgkmcnt(3)
  buffer_store_dwordx4 v[12:15], v8, s[60:63], s7 offen offset:0 sc1
  s_waitcnt lgkmcnt(2)
  buffer_store_dwordx4 v[16:19], v8, s[60:63], s7 offen offset:1024 sc1
  s_waitcnt lgkmcnt(1)
  buffer_store_dwordx4 v[20:23], v8, s[60:63], s7 offen offset:2048 sc1
  s_waitcnt lgkmcnt(0)
  buffer_store_dwordx4 v[24:27], v8, s[60:63], s7 offen offset:3072 sc1
  s_barrier
  ds_read_b128 v[8:11], v4 offset:0
  ds_read_b128 v[12:15], v5 offset:0
  ds_read_b128 v[16:19], v4 offset:8192
  ds_read_b128 v[20:23], v5 offset:8192
  ds_read_b128 v[24:27], v4 offset:2048
  ds_read_b128 v[28:31], v5 offset:2048
  ds_read_b128 v[32:35], v4 offset:10240
  ds_read_b128 v[36:39], v5 offset:10240
  s_waitcnt lgkmcnt(5)
  v_pk_add_f32 v[8:9], v[8:9], v[16:17]
  v_cvt_pk_bf16_f32 v40, v8, v9
  v_pk_add_f32 v[10:11], v[10:11], v[18:19]
  v_cvt_pk_bf16_f32 v41, v10, v11
  s_waitcnt lgkmcnt(4)
  s_nop 0
  v_pk_add_f32 v[12:13], v[12:13], v[20:21]
  v_cvt_pk_bf16_f32 v42, v12, v13
  v_pk_add_f32 v[14:15], v[14:15], v[22:23]
  v_cvt_pk_bf16_f32 v43, v14, v15
  buffer_store_dwordx4 v[40:43], v198, s[60:63], s92 offen offset:0 sc1
  s_waitcnt lgkmcnt(1)
  s_nop 0
  v_pk_add_f32 v[24:25], v[24:25], v[32:33]
  v_cvt_pk_bf16_f32 v44, v24, v25
  v_pk_add_f32 v[26:27], v[26:27], v[34:35]
  v_cvt_pk_bf16_f32 v45, v26, v27
  s_waitcnt lgkmcnt(0)
  s_nop 0
  v_pk_add_f32 v[28:29], v[28:29], v[36:37]
  v_cvt_pk_bf16_f32 v46, v28, v29
  v_pk_add_f32 v[30:31], v[30:31], v[38:39]
  v_cvt_pk_bf16_f32 v47, v30, v31
  buffer_store_dwordx4 v[44:47], v198, s[60:63], s92 offen offset:1024 sc1
  s_endpgm
L_K4:
  s_add_u32 s6, s92, 0
  s_and_b32 s6, s6, 15
  s_mul_i32 s7, s6, 73728
  s_add_u32 s7, s7, s88
  s_lshl_b32 s7, s7, 1
  buffer_load_dwordx2 v[204:205], v221, s[56:59], s7 offen offset:0
  s_add_u32 s6, s92, 0
  s_and_b32 s6, s6, 15
  s_mul_i32 s7, s6, 73728
  s_add_u32 s7, s7, s88
  s_lshl_b32 s7, s7, 1
  buffer_load_dwordx2 v[208:209], v221, s[56:59], s7 offen offset:1152
  s_waitcnt lgkmcnt(0)
  v_lshlrev_b32_e64 v3, 2, v1
  s_mul_i32 s8, s5, 43
  s_lshr_b32 s8, s8, 8
  s_mul_i32 s9, s8, 6
  s_sub_u32 s12, s5, s9
  s_lshl_b32 s11, s4, 2
  s_add_u32 s11, s11, s8
  s_and_b32 s13, s12, 1
  s_mul_i32 s13, s13, 0
  s_mul_i32 s8, s8, 0
  s_add_u32 s13, s13, s8
  s_add_u32 s13, s13, s4
  s_mul_i32 s8, s13, 57
  s_lshr_b32 s8, s8, 9
  s_mul_i32 s8, s8, 9
  s_sub_u32 s13, s13, s8
  s_mov_b64 s[60:61], s[54:55]
  s_mov_b32 s62, 16777216
  s_mov_b32 s63, 0x20000
  s_cmp_eq_u32 s78, 0
  s_cselect_b32 s72, s40, s42
  s_cselect_b32 s73, s41, s43
  s_mov_b32 s74, 663552
  s_mov_b32 s75, 0x20000
  s_mov_b32 s80, s50
  s_and_b32 s81, s51, 0xffff
  s_mov_b32 s82, 4718592
  s_mov_b32 s83, 0x20000
  v_mov_b32 v232, 0
  v_mov_b32 v233, 0
  v_mov_b32 v234, 0
  v_mov_b32 v235, 0
  s_mul_i32 s6, s76, 4608
  s_mul_i32 s7, s78, 4608
  s_add_u32 s7, s7, 53504
  v_mov_b32 v236, s6
  v_mov_b32 v237, s7
  v_cmp_gt_u32 vcc, 32, v1
  s_nop 1
  v_cndmask_b32 v236, v237, v236, vcc
  v_add_u32 v236, v236, v198
  ds_write_b128 v236, v[232:235]
  s_mov_b32 s94, s92
  s_mov_b32 s91, s93
  v_lshrrev_b32 v232, 4, v1
  v_and_b32 v233, 7, v1
  v_xor_b32 v232, v232, v233
  v_lshrrev_b32 v233, 3, v1
  v_mul_u32_u24 v233, 3456, v233
  v_lshl_add_u32 v230, v232, 4, v233
  v_xor_b32_e64 v232, 4, v232
  v_lshl_add_u32 v231, v232, 4, v233
  s_mul_i32 s93, s12, 110592
  s_mul_i32 s6, s77, 55296
  s_add_u32 s93, s93, s6
  s_mul_i32 s92, s76, 6144
  s_mul_i32 s6, s76, 6144
  v_and_b32 v238, 15, v1
  v_lshrrev_b32 v239, 1, v238
  v_lshlrev_b32 v238, 7, v238
  v_add_u32 v238, s6, v238
  v_lshrrev_b32 v232, 4, v1
  v_xor_b32_e64 v239, v239, v232
  v_lshl_add_u32 v232, v239, 4, v238
  v_xor_b32_e64 v233, 64, v232
  v_add_u32 v234, 0x10000, v232
  v_add_u32 v235, 0x10000, v233
  v_add_u32 v236, 0x20000, v232
  v_add_u32 v237, 0x20000, v233
  s_lshl_b32 s95, s11, 1
  s_add_u32 s95, s95, s78
  s_mul_i32 s95, s95, 36864
  s_mul_i32 s6, s12, 192
  s_mul_i32 s7, s77, 96
  s_add_u32 s6, s6, s7
  s_add_u32 s95, s95, s6
  v_and_b32_e64 v239, 15, v1
  v_mad_u32_u24 v238, v239, 6, s6
  global_load_ushort v44, v238, s[46:47] offset:0
  global_load_ushort v45, v238, s[46:47] offset:2
  global_load_ushort v46, v238, s[46:47] offset:4
  v_mad_u32_u24 v238, v239, 6, s92
  v_lshrrev_b32_e64 v239, 4, v1
  v_mul_u32_u24 v239, 384, v239
  v_add_u32 v50, v238, v239
  v_add_u32 v238, 0, v1
  v_mul_u32_u24 v239, 0x2aab, v238
  v_lshrrev_b32_e64 v239, 16, v239
  v_mul_u32_u24 v239, 1056, v239
  v_lshl_add_u32 v47, v238, 4, v239
  v_add_u32_e64 v238, 64, v1
  v_mul_u32_u24 v239, 0x2aab, v238
  v_lshrrev_b32_e64 v239, 16, v239
  v_mul_u32_u24 v239, 1056, v239
  v_lshl_add_u32 v48, v238, 4, v239
  v_add_u32 v238, 128, v1
  v_mul_u32_u24 v239, 0x2aab, v238
  v_lshrrev_b32_e64 v239, 16, v239
  v_mul_u32_u24 v239, 1056, v239
  v_lshl_add_u32 v49, v238, 4, v239
  v_mov_b32 v4, 0
  v_mov_b32 v5, 0
  v_mov_b32 v6, 0
  v_mov_b32 v7, 0
  v_mov_b32 v8, 0
  v_mov_b32 v9, 0
  v_mov_b32 v10, 0
  v_mov_b32 v11, 0
  v_mov_b32 v12, 0
  v_mov_b32 v13, 0
  v_mov_b32 v14, 0
  v_mov_b32 v15, 0
  v_mov_b32 v16, 0
  v_mov_b32 v17, 0
  v_mov_b32 v18, 0
  v_mov_b32 v19, 0
  v_mov_b32 v20, 0
  v_mov_b32 v21, 0
  v_mov_b32 v22, 0
  v_mov_b32 v23, 0
  v_mov_b32 v24, 0
  v_mov_b32 v25, 0
  v_mov_b32 v26, 0
  v_mov_b32_e64 v27, 0
  s_waitcnt vmcnt(4)
  s_add_u32 s6, s94, 4
  s_and_b32 s6, s6, 15
  s_mul_i32 s7, s6, 73728
  s_add_u32 s7, s7, s88
  s_lshl_b32 s7, s7, 1
  buffer_load_dwordx2 v[212:213], v221, s[56:59], s7 offen offset:0
  s_waitcnt vmcnt(4)
  s_add_u32 s6, s94, 4
  s_and_b32 s6, s6, 15
  s_mul_i32 s7, s6, 73728
  s_add_u32 s7, s7, s88
  s_lshl_b32 s7, s7, 1
  buffer_load_dwordx2 v[216:217], v221, s[56:59], s7 offen offset:1152
  s_add_u32 s6, s94, 0
  s_and_b32 s6, s6, 15
  s_lshl_b32 s6, s6, 8
  v_add_u32_e64 v238, s6, v220
  v_perm_b32 v224, v204, v208, s64
  v_perm_b32 v225, v204, v208, s65
  v_perm_b32 v226, v205, v209, s64
  v_perm_b32 v227, v205, v209, s65
  ds_write_b32 v238, v224 offset:512
  ds_write_b32 v238, v225 offset:5120
  ds_write_b32 v238, v226 offset:9728
  ds_write_b32 v238, v227 offset:14336
  s_waitcnt vmcnt(1)
  s_add_u32 s6, s94, 8
  s_and_b32 s6, s6, 15
  s_mul_i32 s7, s6, 73728
  s_add_u32 s7, s7, s88
  s_lshl_b32 s7, s7, 1
  buffer_load_dwordx2 v[204:205], v221, s[56:59], s7 offen offset:0
  s_waitcnt vmcnt(1)
  s_add_u32 s6, s94, 8
  s_and_b32 s6, s6, 15
  s_mul_i32 s7, s6, 73728
  s_add_u32 s7, s7, s88
  s_lshl_b32 s7, s7, 1
  buffer_load_dwordx2 v[208:209], v221, s[56:59], s7 offen offset:1152
  s_add_u32 s6, s94, 4
  s_and_b32 s6, s6, 15
  s_lshl_b32 s6, s6, 8
  v_add_u32 v238, s6, v220
  v_perm_b32 v224, v212, v216, s64
  v_perm_b32 v225, v212, v216, s65
  v_perm_b32 v226, v213, v217, s64
  v_perm_b32 v227, v213, v217, s65
  ds_write_b32 v238, v224 offset:512
  ds_write_b32 v238, v225 offset:5120
  ds_write_b32 v238, v226 offset:9728
  ds_write_b32 v238, v227 offset:14336
  s_waitcnt vmcnt(1)
  s_add_u32 s6, s94, 12
  s_and_b32 s6, s6, 15
  s_mul_i32 s7, s6, 73728
  s_add_u32 s7, s7, s88
  s_lshl_b32 s7, s7, 1
  buffer_load_dwordx2 v[212:213], v221, s[56:59], s7 offen offset:0
  s_waitcnt vmcnt(1)
  s_add_u32 s6, s94, 12
  s_and_b32 s6, s6, 15
  s_mul_i32 s7, s6, 73728
  s_add_u32 s7, s7, s88
  s_lshl_b32 s7, s7, 1
  buffer_load_dwordx2 v[216:217], v221, s[56:59], s7 offen offset:1152
  s_add_u32 s6, s94, 8
  s_and_b32 s6, s6, 15
  s_lshl_b32 s6, s6, 8
  v_add_u32 v238, s6, v220
  v_perm_b32 v224, v204, v208, s64
  v_perm_b32 v225, v204, v208, s65
  v_perm_b32 v226, v205, v209, s64
  v_perm_b32 v227, v205, v209, s65
  ds_write_b32 v238, v224 offset:512
  ds_write_b32 v238, v225 offset:5120
  ds_write_b32 v238, v226 offset:9728
  ds_write_b32 v238, v227 offset:14336
  s_waitcnt vmcnt(1)
  s_lshl_b32 s14, s13, 7
  s_add_u32 m0, s92, 65536
  s_nop 0
  buffer_load_dwordx4 v47, s[56:59], s95 offen lds
  s_add_u32 m0, s92, 66560
  s_nop 0
  buffer_load_dwordx4 v48, s[56:59], s95 offen lds
  s_add_u32 m0, s92, 67584
  s_nop 0
  buffer_load_dwordx4 v49, s[56:59], s95 offen lds
  s_add_u32 s6, s93, s14
  s_add_u32 m0, s92, 139264
  s_add_u32 s7, s6, 0
  buffer_load_dwordx4 v230, s[72:75], s7 offen lds
  s_add_u32 m0, s92, 140288
  s_add_u32 s7, s6, 27648
  buffer_load_dwordx4 v231, s[72:75], s7 offen lds
  s_add_u32 m0, s92, 141312
  s_add_u32 s7, s6, 1152
  buffer_load_dwordx4 v230, s[72:75], s7 offen lds
  s_add_u32 m0, s92, 142336
  s_add_u32 s7, s6, 28800
  buffer_load_dwordx4 v231, s[72:75], s7 offen lds
  s_add_u32 m0, s92, 143360
  s_add_u32 s7, s6, 2304
  buffer_load_dwordx4 v230, s[72:75], s7 offen lds
  s_add_u32 m0, s92, 144384
  s_add_u32 s7, s6, 29952
  buffer_load_dwordx4 v231, s[72:75], s7 offen lds
  s_add_u32 s14, s14, 128
  s_cmp_ge_u32 s14, 1152
  s_cselect_b32 s14, 0, s14
  s_waitcnt vmcnt(9)
  s_add_u32 s6, s94, 12
  s_and_b32 s6, s6, 15
  s_lshl_b32 s6, s6, 8
  v_add_u32_e64 v238, s6, v220
  v_perm_b32 v224, v212, v216, s64
  v_perm_b32 v225, v212, v216, s65
  v_perm_b32 v226, v213, v217, s64
  v_perm_b32 v227, v213, v217, s65
  ds_write_b32 v238, v224 offset:512
  ds_write_b32 v238, v225 offset:5120
  ds_write_b32 v238, v226 offset:9728
  ds_write_b32 v238, v227 offset:14336
  s_waitcnt lgkmcnt(0)
  s_barrier
  s_setprio 0
  v_mov_b32 v240, -1
  v_mov_b32 v241, -1
  v_mov_b32 v242, -1
  v_mov_b32 v243, -1
  s_lshl_b32 s6, s90, 12
  s_add_u32 s6, s6, 6291456
  s_lshl_b32 s7, s91, 12
  s_lshl_b32 s8, s77, 11
  s_add_u32 s7, s7, s8
  s_add_u32 s7, s7, 6291456
  buffer_store_dwordx4 v[240:243], v198, s[60:63], s6 offen offset:0 sc1
  buffer_store_dwordx4 v[240:243], v198, s[60:63], s6 offen offset:1024 sc1
  buffer_store_dwordx4 v[240:243], v198, s[60:63], s6 offen offset:2048 sc1
  buffer_store_dwordx4 v[240:243], v198, s[60:63], s6 offen offset:3072 sc1
  v_and_b32 v199, 63, v3
  global_load_dword v199, v199, s[52:53] sc1
  s_add_u32 s6, s93, s14
  s_add_u32 m0, s92, 114688
  s_add_u32 s7, s6, 0
  buffer_load_dwordx4 v230, s[72:75], s7 offen lds
  s_add_u32 m0, s92, 115712
  s_add_u32 s7, s6, 27648
  buffer_load_dwordx4 v231, s[72:75], s7 offen lds
  s_add_u32 m0, s92, 116736
  s_add_u32 s7, s6, 1152
  buffer_load_dwordx4 v230, s[72:75], s7 offen lds
  s_add_u32 m0, s92, 117760
  s_add_u32 s7, s6, 28800
  buffer_load_dwordx4 v231, s[72:75], s7 offen lds
  s_add_u32 m0, s92, 118784
  s_add_u32 s7, s6, 2304
  buffer_load_dwordx4 v230, s[72:75], s7 offen lds
  s_add_u32 m0, s92, 119808
  s_add_u32 s7, s6, 29952
  buffer_load_dwordx4 v231, s[72:75], s7 offen lds
  s_add_u32 s14, s14, 128
  s_cmp_ge_u32 s14, 1152
  s_cselect_b32 s14, 0, s14
  v_mul_u32_u24 v238, 576, v1
  v_add_u32 v238, s90, v238
  v_mov_b32 v239, 1
  v_lshlrev_b32 v238, 2, v238
  s_waitcnt vmcnt(6)
  v_cmp_ne_u32 vcc, 1, v199
  s_nop 0
  s_cbranch_vccnz Len32
Lok30:
  s_mov_b32 s6, 147456
  s_mov_b64 exec, 3
  buffer_store_dword v239, v238, s[60:63], s6 offen sc1
  s_mov_b64 exec, -1
  s_add_u32 s6, s93, s14
  s_add_u32 m0, s92, 90112
  s_add_u32 s7, s6, 0
  buffer_load_dwordx4 v230, s[72:75], s7 offen lds
  s_add_u32 m0, s92, 91136
  s_add_u32 s7, s6, 27648
  buffer_load_dwordx4 v231, s[72:75], s7 offen lds
  s_add_u32 m0, s92, 92160
  s_add_u32 s7, s6, 1152
  buffer_load_dwordx4 v230, s[72:75], s7 offen lds
  s_add_u32 m0, s92, 93184
  s_add_u32 s7, s6, 28800
  buffer_load_dwordx4 v231, s[72:75], s7 offen lds
  s_add_u32 m0, s92, 94208
  s_add_u32 s7, s6, 2304
  buffer_load_dwordx4 v230, s[72:75], s7 offen lds
  s_add_u32 m0, s92, 95232
  s_add_u32 s7, s6, 29952
  buffer_load_dwordx4 v231, s[72:75], s7 offen lds
  s_add_u32 s14, s14, 128
  s_cmp_ge_u32 s14, 1152
  s_cselect_b32 s14, 0, s14
  v_add_u32 v50, 65536, v50
  ds_read_u16_d16_hi v4, v50 offset:0
  ds_read_u16_d16_hi v5, v50 offset:96
  ds_read_u16_d16_hi v6, v50 offset:192
  ds_read_u16_d16_hi v7, v50 offset:288
  ds_read_u16_d16_hi v8, v50 offset:2
  ds_read_u16_d16_hi v9, v50 offset:98
  ds_read_u16_d16_hi v10, v50 offset:194
  ds_read_u16_d16_hi v11, v50 offset:290
  ds_read_u16_d16_hi v12, v50 offset:4
  ds_read_u16_d16_hi v13, v50 offset:100
  ds_read_u16_d16_hi v14, v50 offset:196
  ds_read_u16_d16_hi v15, v50 offset:292
  ds_read_u16_d16_hi v16, v50 offset:1536
  ds_read_u16_d16_hi v17, v50 offset:1632
  ds_read_u16_d16_hi v18, v50 offset:1728
  ds_read_u16_d16_hi v19, v50 offset:1824
  ds_read_u16_d16_hi v20, v50 offset:1538
  ds_read_u16_d16_hi v21, v50 offset:1634
  ds_read_u16_d16_hi v22, v50 offset:1730
  ds_read_u16_d16_hi v23, v50 offset:1826
  ds_read_u16_d16_hi v24, v50 offset:1540
  ds_read_u16_d16_hi v25, v50 offset:1636
  ds_read_u16_d16_hi v26, v50 offset:1732
  ds_read_u16_d16_hi v27, v50 offset:1828
  s_waitcnt lgkmcnt(0)
  s_add_u32 s6, s93, s14
  s_add_u32 m0, s92, 65536
  s_add_u32 s7, s6, 0
  buffer_load_dwordx4 v230, s[72:75], s7 offen lds
  s_add_u32 m0, s92, 66560
  s_add_u32 s7, s6, 27648
  buffer_load_dwordx4 v231, s[72:75], s7 offen lds
  s_add_u32 m0, s92, 67584
  s_add_u32 s7, s6, 1152
  buffer_load_dwordx4 v230, s[72:75], s7 offen lds
  s_add_u32 m0, s92, 68608
  s_add_u32 s7, s6, 28800
  buffer_load_dwordx4 v231, s[72:75], s7 offen lds
  s_add_u32 m0, s92, 69632
  s_add_u32 s7, s6, 2304
  buffer_load_dwordx4 v230, s[72:75], s7 offen lds
  s_add_u32 m0, s92, 70656
  s_add_u32 s7, s6, 29952
  buffer_load_dwordx4 v231, s[72:75], s7 offen lds
  s_add_u32 s14, s14, 128
  s_cmp_ge_u32 s14, 1152
  s_cselect_b32 s14, 0, s14
  ds_read_b128 v[52:55], v236 offset:8192
  ds_read_b128 v[56:59], v236 offset:10240
  ds_read_b128 v[60:63], v236 offset:12288
  ds_read_b128 v[64:67], v237 offset:8192
  ds_read_b128 v[68:71], v237 offset:10240
  ds_read_b128 v[72:75], v237 offset:12288
  s_waitcnt lgkmcnt(0)
  s_add_u32 s6, s93, s14
  s_add_u32 m0, s92, 139264
  s_add_u32 s7, s6, 0
  buffer_load_dwordx4 v230, s[72:75], s7 offen lds
  s_add_u32 m0, s92, 140288
  s_add_u32 s7, s6, 27648
  buffer_load_dwordx4 v231, s[72:75], s7 offen lds
  s_add_u32 m0, s92, 141312
  s_add_u32 s7, s6, 1152
  buffer_load_dwordx4 v230, s[72:75], s7 offen lds
  s_add_u32 m0, s92, 142336
  s_add_u32 s7, s6, 28800
  buffer_load_dwordx4 v231, s[72:75], s7 offen lds
  s_add_u32 m0, s92, 143360
  s_add_u32 s7, s6, 2304
  buffer_load_dwordx4 v230, s[72:75], s7 offen lds
  s_add_u32 m0, s92, 144384
  s_add_u32 s7, s6, 29952
  buffer_load_dwordx4 v231, s[72:75], s7 offen lds
  s_add_u32 s14, s14, 128
  s_cmp_ge_u32 s14, 1152
  s_cselect_b32 s14, 0, s14
  s_barrier
  s_mov_b32 s94, s14
  s_add_u32 s14, s14, 128
  s_cmp_ge_u32 s14, 1152
  s_cselect_b32 s14, 0, s14
  s_waitcnt vmcnt(19)
  ds_read_b128 v[76:79], v234 offset:49152
  ds_read_b128 v[80:83], v234 offset:51200
  ds_read_b128 v[84:87], v234 offset:53248
  ds_read_b128 v[88:91], v235 offset:49152
  ds_read_b128 v[92:95], v235 offset:51200
  ds_read_b128 v[96:99], v235 offset:53248
  s_waitcnt lgkmcnt(0)
  s_add_u32 s6, s93, s14
  s_add_u32 m0, s92, 114688
  s_add_u32 s7, s6, 0
  buffer_load_dwordx4 v230, s[72:75], s7 offen lds
  s_add_u32 m0, s92, 115712
  s_add_u32 s7, s6, 27648
  buffer_load_dwordx4 v231, s[72:75], s7 offen lds
  s_add_u32 m0, s92, 116736
  s_add_u32 s7, s6, 1152
  buffer_load_dwordx4 v230, s[72:75], s7 offen lds
  s_add_u32 m0, s92, 117760
  s_add_u32 s7, s6, 28800
  buffer_load_dwordx4 v231, s[72:75], s7 offen lds
  s_add_u32 m0, s92, 118784
  s_add_u32 s7, s6, 2304
  buffer_load_dwordx4 v230, s[72:75], s7 offen lds
  s_add_u32 m0, s92, 119808
  s_add_u32 s7, s6, 29952
  buffer_load_dwordx4 v231, s[72:75], s7 offen lds
  s_add_u32 s14, s14, 128
  s_cmp_ge_u32 s14, 1152
  s_cselect_b32 s14, 0, s14
  s_waitcnt vmcnt(18)
  ds_read_b128 v[100:103], v234 offset:24576
  ds_read_b128 v[104:107], v234 offset:26624
  ds_read_b128 v[108:111], v234 offset:28672
  ds_read_b128 v[112:115], v235 offset:24576
  ds_read_b128 v[116:119], v235 offset:26624
  ds_read_b128 v[120:123], v235 offset:28672
  s_waitcnt lgkmcnt(0)
  s_add_u32 s6, s93, s14
  s_add_u32 m0, s92, 90112
  s_add_u32 s7, s6, 0
  buffer_load_dwordx4 v230, s[72:75], s7 offen lds
  s_add_u32 m0, s92, 91136
  s_add_u32 s7, s6, 27648
  buffer_load_dwordx4 v231, s[72:75], s7 offen lds
  s_add_u32 m0, s92, 92160
  s_add_u32 s7, s6, 1152
  buffer_load_dwordx4 v230, s[72:75], s7 offen lds
  s_add_u32 m0, s92, 93184
  s_add_u32 s7, s6, 28800
  buffer_load_dwordx4 v231, s[72:75], s7 offen lds
  s_add_u32 m0, s92, 94208
  s_add_u32 s7, s6, 2304
  buffer_load_dwordx4 v230, s[72:75], s7 offen lds
  s_add_u32 m0, s92, 95232
  s_add_u32 s7, s6, 29952
  buffer_load_dwordx4 v231, s[72:75], s7 offen lds
  s_add_u32 s14, s14, 128
  s_cmp_ge_u32 s14, 1152
  s_cselect_b32 s14, 0, s14
  s_waitcnt vmcnt(18)
  ds_read_b128 v[124:127], v234 offset:0
  ds_read_b128 v[128:131], v234 offset:2048
  ds_read_b128 v[132:135], v234 offset:4096
  ds_read_b128 v[136:139], v235 offset:0
  ds_read_b128 v[140:143], v235 offset:2048
  ds_read_b128 v[144:147], v235 offset:4096
  s_waitcnt lgkmcnt(0)
  s_add_u32 s6, s93, s14
  s_add_u32 m0, s92, 65536
  s_add_u32 s7, s6, 0
  buffer_load_dwordx4 v230, s[72:75], s7 offen lds
  s_add_u32 m0, s92, 66560
  s_add_u32 s7, s6, 27648
  buffer_load_dwordx4 v231, s[72:75], s7 offen lds
  s_add_u32 m0, s92, 67584
  s_add_u32 s7, s6, 1152
  buffer_load_dwordx4 v230, s[72:75], s7 offen lds
  s_add_u32 m0, s92, 68608
  s_add_u32 s7, s6, 28800
  buffer_load_dwordx4 v231, s[72:75], s7 offen lds
  s_add_u32 m0, s92, 69632
  s_add_u32 s7, s6, 2304
  buffer_load_dwordx4 v230, s[72:75], s7 offen lds
  s_add_u32 m0, s92, 70656
  s_add_u32 s7, s6, 29952
  buffer_load_dwordx4 v231, s[72:75], s7 offen lds
  s_add_u32 s14, s14, 128
  s_cmp_ge_u32 s14, 1152
  s_cselect_b32 s14, 0, s14
  s_waitcnt vmcnt(18)
  ds_read_b128 v[148:151], v236 offset:8192
  ds_read_b128 v[152:155], v236 offset:10240
  ds_read_b128 v[156:159], v236 offset:12288
  ds_read_b128 v[160:163], v237 offset:8192
  ds_read_b128 v[164:167], v237 offset:10240
  ds_read_b128 v[168:171], v237 offset:12288
  s_waitcnt lgkmcnt(0)
  s_mov_b32 s14, s94
  s_add_u32 s6, s93, s14
  s_add_u32 m0, s92, 139264
  s_add_u32 s7, s6, 0
  buffer_load_dwordx4 v230, s[72:75], s7 offen lds
  s_add_u32 m0, s92, 140288
  s_add_u32 s7, s6, 27648
  buffer_load_dwordx4 v231, s[72:75], s7 offen lds
  s_add_u32 m0, s92, 141312
  s_add_u32 s7, s6, 1152
  buffer_load_dwordx4 v230, s[72:75], s7 offen lds
  s_add_u32 m0, s92, 142336
  s_add_u32 s7, s6, 28800
  buffer_load_dwordx4 v231, s[72:75], s7 offen lds
  s_add_u32 m0, s92, 143360
  s_add_u32 s7, s6, 2304
  buffer_load_dwordx4 v230, s[72:75], s7 offen lds
  s_add_u32 m0, s92, 144384
  s_add_u32 s7, s6, 29952
  buffer_load_dwordx4 v231, s[72:75], s7 offen lds
  s_add_u32 s14, s14, 128
  s_cmp_ge_u32 s14, 1152
  s_cselect_b32 s14, 0, s14
  s_setprio 0
  s_waitcnt vmcnt(0)
  ds_read_b128 v[172:175], v236 offset:8192
  ds_read_b128 v[176:179], v236 offset:10240
  ds_read_b128 v[180:183], v236 offset:12288
  ds_read_b128 v[184:187], v237 offset:8192
  ds_read_b128 v[188:191], v237 offset:10240
  ds_read_b128 v[192:195], v237 offset:12288
  s_waitcnt lgkmcnt(0)
  s_lshr_b32 s8, s11, 1
  s_mul_i32 s8, s8, 4608
  s_and_b32 s7, s11, 1
  s_lshl_b32 s7, s7, 8
  s_add_u32 s8, s8, s7
  s_add_u32 s8, s8, 156160
  s_add_u32 s9, s8, 4096
  s_cmp_lg_u32 s76, 0
  s_cbranch_scc1 Lq033
  buffer_load_dword v28, v3, s[60:63], s8 offen offset:0 sc1
  buffer_load_dword v29, v3, s[60:63], s8 offen offset:512 sc1
  buffer_load_dword v30, v3, s[60:63], s8 offen offset:1024 sc1
  buffer_load_dword v31, v3, s[60:63], s8 offen offset:1536 sc1
  buffer_load_dword v32, v3, s[60:63], s8 offen offset:2048 sc1
  buffer_load_dword v33, v3, s[60:63], s8 offen offset:2560 sc1
  buffer_load_dword v34, v3, s[60:63], s8 offen offset:3072 sc1
  buffer_load_dword v35, v3, s[60:63], s8 offen offset:3584 sc1
  buffer_load_dword v36, v3, s[60:63], s9 offen offset:0 sc1
Lq033:
  s_waitcnt lgkmcnt(0)
  v_bfe_u32 v212, v1, 1, 1
  v_lshrrev_b32 v213, 4, v1
  v_lshlrev_b32_e64 v213, 3, v213
  v_bfe_u32 v214, v1, 2, 2
  v_add_u32_e64 v213, v213, v214
  v_lshl_add_u32 v213, v212, 2, v213
  v_lshlrev_b32_e64 v213, 4, v213
  v_lshl_add_u32 v213, v212, 10, v213
  v_and_b32_e64 v212, 1, v1
  v_lshl_add_u32 v213, v212, 3, v213
  s_mul_i32 s6, s78, 8704
  v_add_u32 v228, s6, v213
  v_xor_b32 v229, 64, v228
  v_xor_b32 v230, 512, v228
  v_xor_b32 v231, 512, v229
  v_add_u32 v232, 139264, v228
  v_add_u32 v233, 139264, v229
  v_add_u32 v234, 139264, v230
  v_add_u32 v235, 139264, v231
  s_mul_i32 s6, s76, 6144
  s_add_u32 s6, s6, 90112
  v_lshl_add_u32 v236, v1, 4, s6
  s_xor_b32 s6, s76, 2
  s_mul_i32 s6, s6, 6144
  s_add_u32 s6, s6, 90112
  v_lshl_add_u32 v237, v1, 4, s6
  s_lshl_b32 s6, s78, 7
  s_add_u32 s6, s6, 159744
  v_lshrrev_b32_e64 v212, 4, v1
  v_lshl_add_u32 v238, v212, 4, s6
  v_mul_u32_u24 v242, 9216, v212
  v_and_b32_e64 v213, 15, v1
  v_mad_u32_u24 v242, v213, 12, v242
  s_lshl_b32 s91, s11, 1
  s_add_u32 s91, s91, s78
  s_mul_i32 s91, s91, 73728
  s_mul_i32 s7, s12, 384
  s_add_u32 s91, s91, s7
  s_mul_i32 s7, s77, 192
  s_add_u32 s91, s91, s7
  s_mul_i32 s6, s77, 6144
  s_add_u32 s6, s6, 114688
  s_lshl_b32 s7, s78, 2
  v_lshrrev_b32 v214, 5, v1
  v_add_u32_e64 v214, s7, v214
  v_bfe_u32 v212, v1, 3, 1
  v_mul_u32_u24 v212, 12288, v212
  v_bfe_u32 v213, v1, 4, 1
  v_lshlrev_b32_e64 v213, 3, v213
  v_add3_u32 v212, v212, v213, s6
  v_and_b32 v213, 7, v1
  v_mul_u32_u24 v213, 3, v213
  v_add_u32_e64 v215, 0, v213
  v_bfe_u32 v216, v215, 1, 1
  v_and_or_b32 v216, v215, 4, v216
  v_xor_b32_e64 v216, v216, v214
  v_lshl_add_u32 v215, v215, 7, v212
  v_lshl_add_u32 v239, v216, 4, v215
  v_add_u32_e64 v215, 1, v213
  v_bfe_u32 v216, v215, 1, 1
  v_and_or_b32 v216, v215, 4, v216
  v_xor_b32_e64 v216, v216, v214
  v_lshl_add_u32 v215, v215, 7, v212
  v_lshl_add_u32 v240, v216, 4, v215
  v_add_u32_e64 v215, 2, v213
  v_bfe_u32 v216, v215, 1, 1
  v_and_or_b32 v216, v215, 4, v216
  v_xor_b32_e64 v216, v216, v214
  v_lshl_add_u32 v215, v215, 7, v212
  v_lshl_add_u32 v241, v216, 4, v215
  s_mul_i32 s6, s76, 6144
  v_and_b32 v218, 15, v1
  v_lshrrev_b32 v219, 1, v218
  v_lshlrev_b32 v218, 7, v218
  v_add_u32 v218, s6, v218
  v_lshrrev_b32 v212, 4, v1
  v_xor_b32 v219, v219, v212
  v_lshl_add_u32 v212, v219, 4, v218
  v_xor_b32_e64 v213, 64, v212
  v_add_u32 v214, 0x10000, v212
  v_add_u32 v215, 0x10000, v213
  v_add_u32 v216, 0x20000, v212
  v_add_u32 v217, 0x20000, v213
  v_mov_b32 v244, v214
  v_mov_b32_e64 v245, v215
  s_add_u32 s16, s91, 0
  s_add_u32 s17, s91, 4608
  s_add_u32 s18, s91, 36864
  s_add_u32 s19, s91, 41472
  s_barrier
  s_branch L_B2
L_lb_cold:
  s_mov_b32 s10, 65536
L_lb_lp:
  s_mov_b32 s6, 0
  buffer_load_dwordx4 v[244:247], v35, s[84:87], 0 offen sc1
  buffer_load_dwordx4 v[240:243], v34, s[84:87], 0 offen sc1
  buffer_load_dwordx4 v[236:239], v33, s[84:87], 0 offen sc1
  buffer_load_dwordx4 v[232:235], v32, s[84:87], 0 offen sc1
  buffer_load_dwordx4 v[228:231], v31, s[84:87], 0 offen sc1
  buffer_load_dwordx4 v[224:227], v30, s[84:87], 0 offen sc1
  buffer_load_dwordx4 v[220:223], v29, s[84:87], 0 offen sc1
  buffer_load_dwordx4 v[216:219], v28, s[84:87], 0 offen sc1
  s_waitcnt vmcnt(0)
  v_max_u32_e64 v214, v216, v217
  v_max3_u32 v214, v218, v219, v214
  v_max3_u32 v214, v220, v221, v214
  v_max3_u32 v214, v222, v223, v214
  v_max3_u32 v214, v224, v225, v214
  v_max3_u32 v214, v226, v227, v214
  v_max3_u32 v214, v228, v229, v214
  v_max3_u32 v214, v230, v231, v214
  v_max3_u32 v214, v232, v233, v214
  v_max3_u32 v214, v234, v235, v214
  v_max3_u32 v214, v236, v237, v214
  v_max3_u32 v214, v238, v239, v214
  v_max3_u32 v214, v240, v241, v214
  v_max3_u32 v214, v242, v243, v214
  v_max3_u32 v214, v244, v245, v214
  v_max3_u32 v214, v246, v247, v214
  v_cmp_eq_u32_e64 vcc, -1, v214
  s_nop 0
  s_cmp_lg_u64 vcc, 0
  s_cselect_b32 s6, 1, 0
  s_cmp_eq_u32 s6, 0
  s_cbranch_scc1 L_lb_done
  s_waitcnt vmcnt(0)
  s_sub_u32 s10, s10, 1
  s_cmp_lg_u32 s10, 0
  s_cbranch_scc1 L_lb_lp
L_lb_done:
  s_waitcnt vmcnt(0)
  v_pk_fma_f32 v[202:203], v[244:245], v[54:55], v[246:247] op_sel_hi:[1,0,1]
  v_pk_fma_f32 v[202:203], v[244:245], v[54:55], v[202:203] op_sel:[1,1,0] op_sel_hi:[0,1,1] neg_lo:[1,0,0]
  v_pk_fma_f32 v[208:209], v[202:203], v[54:55], v[240:241] op_sel_hi:[1,0,1]
  v_pk_fma_f32 v[208:209], v[202:203], v[54:55], v[208:209] op_sel:[1,1,0] op_sel_hi:[0,1,1] neg_lo:[1,0,0]
  v_pk_fma_f32 v[202:203], v[208:209], v[54:55], v[242:243] op_sel_hi:[1,0,1]
  v_pk_fma_f32 v[202:203], v[208:209], v[54:55], v[202:203] op_sel:[1,1,0] op_sel_hi:[0,1,1] neg_lo:[1,0,0]
  v_pk_fma_f32 v[208:209], v[202:203], v[54:55], v[236:237] op_sel_hi:[1,0,1]
  v_pk_fma_f32 v[208:209], v[202:203], v[54:55], v[208:209] op_sel:[1,1,0] op_sel_hi:[0,1,1] neg_lo:[1,0,0]
  v_pk_fma_f32 v[202:203], v[208:209], v[54:55], v[238:239] op_sel_hi:[1,0,1]
  v_pk_fma_f32 v[202:203], v[208:209], v[54:55], v[202:203] op_sel:[1,1,0] op_sel_hi:[0,1,1] neg_lo:[1,0,0]
  v_pk_fma_f32 v[208:209], v[202:203], v[54:55], v[232:233] op_sel_hi:[1,0,1]
  v_pk_fma_f32 v[208:209], v[202:203], v[54:55], v[208:209] op_sel:[1,1,0] op_sel_hi:[0,1,1] neg_lo:[1,0,0]
  v_pk_fma_f32 v[202:203], v[208:209], v[54:55], v[234:235] op_sel_hi:[1,0,1]
  v_pk_fma_f32 v[202:203], v[208:209], v[54:55], v[202:203] op_sel:[1,1,0] op_sel_hi:[0,1,1] neg_lo:[1,0,0]
  v_pk_fma_f32 v[208:209], v[202:203], v[54:55], v[228:229] op_sel_hi:[1,0,1]
  v_pk_fma_f32 v[208:209], v[202:203], v[54:55], v[208:209] op_sel:[1,1,0] op_sel_hi:[0,1,1] neg_lo:[1,0,0]
  v_pk_fma_f32 v[202:203], v[208:209], v[54:55], v[230:231] op_sel_hi:[1,0,1]
  v_pk_fma_f32 v[202:203], v[208:209], v[54:55], v[202:203] op_sel:[1,1,0] op_sel_hi:[0,1,1] neg_lo:[1,0,0]
  v_pk_fma_f32 v[208:209], v[202:203], v[54:55], v[224:225] op_sel_hi:[1,0,1]
  v_pk_fma_f32 v[208:209], v[202:203], v[54:55], v[208:209] op_sel:[1,1,0] op_sel_hi:[0,1,1] neg_lo:[1,0,0]
  v_pk_fma_f32 v[202:203], v[208:209], v[54:55], v[226:227] op_sel_hi:[1,0,1]
  v_pk_fma_f32 v[202:203], v[208:209], v[54:55], v[202:203] op_sel:[1,1,0] op_sel_hi:[0,1,1] neg_lo:[1,0,0]
  v_pk_fma_f32 v[208:209], v[202:203], v[54:55], v[220:221] op_sel_hi:[1,0,1]
  v_pk_fma_f32 v[208:209], v[202:203], v[54:55], v[208:209] op_sel:[1,1,0] op_sel_hi:[0,1,1] neg_lo:[1,0,0]
  v_pk_fma_f32 v[202:203], v[208:209], v[54:55], v[222:223] op_sel_hi:[1,0,1]
  v_pk_fma_f32 v[202:203], v[208:209], v[54:55], v[202:203] op_sel:[1,1,0] op_sel_hi:[0,1,1] neg_lo:[1,0,0]
  v_pk_fma_f32 v[208:209], v[202:203], v[54:55], v[216:217] op_sel_hi:[1,0,1]
  v_pk_fma_f32 v[208:209], v[202:203], v[54:55], v[208:209] op_sel:[1,1,0] op_sel_hi:[0,1,1] neg_lo:[1,0,0]
  v_pk_fma_f32 v[202:203], v[208:209], v[54:55], v[218:219] op_sel_hi:[1,0,1]
  v_pk_fma_f32 v[202:203], v[208:209], v[54:55], v[202:203] op_sel:[1,1,0] op_sel_hi:[0,1,1] neg_lo:[1,0,0]
  v_mov_b32 v206, v202
  v_mov_b32_e64 v207, v203
  s_nop 3
  s_branch L_lb_ok
Len4:
  s_nop 7
  s_nop 7
  s_waitcnt vmcnt(0) lgkmcnt(0)
  s_mov_b32 s10, 65536
Llp3:
  s_sleep 4
  s_lshr_b32 s6, s11, 4
  s_mul_i32 s6, s6, 2304
  s_mul_i32 s7, s12, 384
  s_add_u32 s6, s6, s7
  s_mul_i32 s7, s77, 192
  s_add_u32 s6, s6, s7
  s_add_u32 s6, s6, 147456
  v_min_u32 v233, 47, v1
  v_lshlrev_b32 v233, 2, v233
  buffer_load_dword v232, v233, s[60:63], s6 offen sc1
  s_waitcnt vmcnt(0)
  v_cmp_ne_u32_e64 vcc, 1, v232
  s_waitcnt lgkmcnt(0)
  s_cbranch_vccz Lok2
  s_sub_u32 s10, s10, 1
  s_cmp_lg_u32 s10, 0
  s_cbranch_scc1 Llp3
  s_branch Lok2
Len7:
  s_nop 7
  s_nop 7
  s_waitcnt vmcnt(0) lgkmcnt(0)
  s_mov_b32 s10, 65536
Llp6:
  s_sleep 1
  buffer_load_dword v202, v203, s[60:63], s88 offen sc1
  s_waitcnt vmcnt(0)
  v_cmp_ne_u32 vcc, 1, v202
  s_waitcnt lgkmcnt(0)
  s_cbranch_vccz Lok5
  s_sub_u32 s10, s10, 1
  s_cmp_lg_u32 s10, 0
  s_cbranch_scc1 Llp6
  s_branch Lok5
Len10:
  s_nop 7
  s_nop 7
  s_waitcnt vmcnt(0) lgkmcnt(0)
  s_mov_b32 s10, 65536
Llp9:
  s_sleep 2
  s_add_u32 m0, s92, 0
  s_add_u32 s7, s90, 0
  buffer_load_dwordx4 v200, s[60:63], s7 offen sc1 lds
  s_add_u32 m0, s92, 1024
  s_add_u32 s7, s90, 32768
  buffer_load_dwordx4 v200, s[60:63], s7 offen sc1 lds
  s_add_u32 m0, s92, 2048
  s_add_u32 s7, s90, 65536
  buffer_load_dwordx4 v200, s[60:63], s7 offen sc1 lds
  s_waitcnt vmcnt(0)
  ds_read_b128 v[204:207], v220 offset:0
  ds_read_b128 v[208:211], v220 offset:1024
  ds_read_b128 v[212:215], v220 offset:2048
  s_waitcnt lgkmcnt(2)
  v_max_u32 v202, v204, v205
  v_max3_u32 v202, v206, v207, v202
  s_waitcnt lgkmcnt(1)
  v_max3_u32 v202, v208, v209, v202
  v_max3_u32 v202, v210, v211, v202
  s_waitcnt lgkmcnt(0)
  v_max3_u32 v202, v212, v213, v202
  v_max3_u32 v202, v214, v215, v202
  v_cmp_eq_u32 vcc, -1, v202
  s_waitcnt lgkmcnt(0)
  s_cbranch_vccz Lok8
  s_sub_u32 s10, s10, 1
  s_cmp_lg_u32 s10, 0
  s_cbranch_scc1 Llp9
  s_branch Lok8
Len16:
  s_nop 7
  s_nop 7
  s_waitcnt vmcnt(0) lgkmcnt(0)
  s_mov_b32 s10, 65536
Llp15:
  s_sleep 8
  v_and_b32 v232, 63, v3
  global_load_dword v232, v232, s[52:53] sc1
  s_waitcnt vmcnt(0)
  v_cmp_ne_u32_e64 vcc, 1, v232
  s_waitcnt lgkmcnt(0)
  s_cbranch_vccz Lok14
  s_sub_u32 s10, s10, 1
  s_cmp_lg_u32 s10, 0
  s_cbranch_scc1 Llp15
  s_branch Lok14
Len21:
  s_nop 7
  s_nop 7
  s_waitcnt vmcnt(0) lgkmcnt(0)
  s_mov_b32 s10, 65536
Llp20:
  s_sleep 4
  buffer_load_dword v28, v3, s[60:63], s8 offen offset:0 sc1
  buffer_load_dword v29, v3, s[60:63], s8 offen offset:512 sc1
  buffer_load_dword v30, v3, s[60:63], s8 offen offset:1024 sc1
  buffer_load_dword v31, v3, s[60:63], s8 offen offset:1536 sc1
  buffer_load_dword v32, v3, s[60:63], s8 offen offset:2048 sc1
  buffer_load_dword v33, v3, s[60:63], s8 offen offset:2560 sc1
  buffer_load_dword v34, v3, s[60:63], s8 offen offset:3072 sc1
  buffer_load_dword v35, v3, s[60:63], s8 offen offset:3584 sc1
  buffer_load_dword v36, v3, s[60:63], s9 offen offset:0 sc1
  s_waitcnt vmcnt(0)
  v_max3_u32 v37, v28, v29, v30
  v_max3_u32 v37, v31, v32, v37
  v_max3_u32 v37, v33, v34, v37
  v_max3_u32 v37, v35, v36, v37
  v_cmp_eq_u32 vcc, -1, v37
  s_waitcnt lgkmcnt(0)
  s_cbranch_vccz Lok19
  s_sub_u32 s10, s10, 1
  s_cmp_lg_u32 s10, 0
  s_cbranch_scc1 Llp20
  s_branch Lok19
Len29:
  s_nop 7
  s_nop 7
  s_waitcnt vmcnt(0) lgkmcnt(0)
  s_mov_b32 s10, 65536
Llp28:
  s_sleep 8
  v_and_b32 v199, 63, v3
  global_load_dword v199, v199, s[52:53] sc1
  s_waitcnt vmcnt(0)
  v_cmp_ne_u32_e64 vcc, 1, v199
  s_waitcnt lgkmcnt(0)
  s_cbranch_vccz Lok27
  s_sub_u32 s10, s10, 1
  s_cmp_lg_u32 s10, 0
  s_cbranch_scc1 Llp28
  s_branch Lok27
Len32:
  s_nop 7
  s_nop 7
  s_waitcnt vmcnt(0) lgkmcnt(0)
  s_mov_b32 s10, 65536
Llp31:
  s_sleep 8
  v_and_b32 v199, 63, v3
  global_load_dword v199, v199, s[52:53] sc1
  s_waitcnt vmcnt(0)
  v_cmp_ne_u32 vcc, 1, v199
  s_waitcnt lgkmcnt(0)
  s_cbranch_vccz Lok30
  s_sub_u32 s10, s10, 1
  s_cmp_lg_u32 s10, 0
  s_cbranch_scc1 Llp31
  s_branch Lok30
L_codeend:
  s_endpgm
.section .rodata,"a"
.p2align 6
.amdhsa_kernel gated_mix__ssm_conv_s4d__ssm_conv_s5__prompt_kernel
  .amdhsa_next_free_vgpr 256
  .amdhsa_next_free_sgpr 102
  .amdhsa_accum_offset 256
  .amdhsa_group_segment_fixed_size 0
  .amdhsa_kernarg_size 160
  .amdhsa_user_sgpr_count 2
  .amdhsa_user_sgpr_kernarg_segment_ptr 1
  .amdhsa_system_sgpr_workgroup_id_x 1
.end_amdhsa_kernel
```
